```python
import torch

def _softmax(x, axis=-1):
    return torch.softmax(x, dim=axis)
def _gelu(x):
    return torch.nn.functional.gelu(x, approximate="tanh")
def _silu(x):
    return torch.nn.functional.silu(x)
def _sigmoid(x):
    return torch.sigmoid(x)
def _layernorm(x, axis=-1, eps=1e-5):
    m = x.mean(dim=axis, keepdim=True)
    v = x.var(dim=axis, keepdim=True, unbiased=False)
    return (x - m) / torch.sqrt(v + eps)
def _scatter_add(tgt, idx, src, axis=0):
    return tgt.clone().index_add_(axis, idx, src)
def _segment_sum(src, seg, n):
    out = torch.zeros((n,) + src.shape[1:], dtype=src.dtype)
    return out.index_add_(0, seg, src)
def _pad(x, pw):
    flat = tuple(v for pair in reversed(pw) for v in pair)
    return torch.nn.functional.pad(x, flat)

kernel_name = 'parallel_sum__sliding_block__glu_gated_bilinear__prompt'

def setup_inputs():

    _w = (lambda a: (lambda t: t.to(torch.bfloat16) if t.is_floating_point() else t)(torch.as_tensor(a)))
    def _A_setup():
        B, S, D = 1, 2048, 512
        return {
            "x": _w((lambda *s: torch.randn(*s, dtype=torch.bfloat16) * 0.05)(B, S, D)),
            "wqkv": _w((lambda *s: torch.randn(*s, dtype=torch.bfloat16) * 0.05)(D, 3 * D)),
            "wo": _w((lambda *s: torch.randn(*s, dtype=torch.bfloat16) * 0.05)(D, D)),
        }
    _A_in = _A_setup()

    def _B_setup():
        B, S, D, F = 1, 2048, 512, 1792
        return {
            "x": _w((lambda *s: torch.randn(*s, dtype=torch.bfloat16) * 0.05)(B, S, D)),
            "w_gate": _w((lambda *s: torch.randn(*s, dtype=torch.bfloat16) * 0.8)(D, F) * (D ** -0.5)),
            "w_up": _w((lambda *s: torch.randn(*s, dtype=torch.bfloat16) * 0.8)(D, F) * (D ** -0.5)),
            "w_down": _w((lambda *s: torch.randn(*s, dtype=torch.bfloat16) * 0.8)(F, D) * (F ** -0.5)),
        }
    _B_in = _B_setup()

    return {
        "A_x": _A_in["x"],
        "A_wqkv": _A_in["wqkv"],
        "A_wo": _A_in["wo"],
        "B_x": _B_in["x"],
        "B_w_gate": _B_in["w_gate"],
        "B_w_up": _B_in["w_up"],
        "B_w_down": _B_in["w_down"],
    }

def reference(A_x, A_wqkv, A_wo, B_x, B_w_gate, B_w_up, B_w_down):
    def _A_ref(x, wqkv, wo):
        B, S, D = x.shape
        H = 32; Dh = D // H; W = 256
        qkv = (lambda x, *d: x.permute(*d))((x @ wqkv).reshape(B, S, 3, H, Dh), 2, 0, 3, 1, 4)
        q, k, v = qkv[0], qkv[1], qkv[2]
        scores = torch.einsum("bhqd,bhkd->bhqk", q, k) * (Dh ** -0.5)
        idx = torch.arange(S)
        mask = (idx[:, None] - idx[None, :] >= 0) & (idx[:, None] - idx[None, :] < W)
        scores = torch.where(mask[None, None], scores, -1e9)
        p = _softmax(scores, axis=-1)
        o = torch.einsum("bhqk,bhkd->bhqd", p, v)
        return (lambda x, *d: x.permute(*d))(o, 0, 2, 1, 3).reshape(B, S, D) @ wo

    def _B_ref(x, w_gate, w_up, w_down):
        g = torch.einsum("bsd,df->bsf", x, w_gate)
        u = torch.einsum("bsd,df->bsf", x, w_up)
        h = g * u
        return torch.einsum("bsf,fd->bsd", h, w_down)

    x = A_x
    xn = _layernorm(x, axis=-1)
    return x + _A_ref(xn, A_wqkv, A_wo) + _B_ref(xn, B_w_gate, B_w_up, B_w_down)
```

```asm
; @launch grid=(256,1,1) block=(256,1,1) lds=163840
.amdgcn_target "amdgcn-amd-amdhsa--gfx950"
.text
.p2align 12
.globl parallel_sum__sliding_block__glu_gated_bilinear__prompt_kernel
.p2align 8
.type parallel_sum__sliding_block__glu_gated_bilinear__prompt_kernel,@function
parallel_sum__sliding_block__glu_gated_bilinear__prompt_kernel:
    s_cmp_ge_u32 s2, 256
    s_cbranch_scc1 parallel_sum__sliding_block__glu_gated_bilinear__prompt_kernel_end
    s_load_dwordx2 s[4:5], s[0:1], 0
    s_load_dwordx2 s[16:17], s[0:1], 8
    s_load_dwordx2 s[8:9], s[0:1], 32
    s_load_dwordx2 s[12:13], s[0:1], 40
    s_load_dwordx2 s[20:21], s[0:1], 72
    s_load_dwordx2 s[36:37], s[0:1], 64
    s_load_dwordx2 s[24:25], s[0:1], 48
    s_load_dwordx2 s[28:29], s[0:1], 16
    s_load_dwordx2 s[32:33], s[0:1], 56
    v_lshrrev_b32 v22, 6, v0
    v_and_b32 v1, 63, v0
    s_and_b32 s69, s2, 7
    s_lshr_b32 s67, s2, 3
    v_readfirstlane_b32 s40, v22
    s_and_b32 s49, s67, 7
    s_lshr_b32 s45, s69, 1
    s_lshr_b32 s72, s67, 3
    v_lshrrev_b32 v22, 3, v1
    v_and_b32 v23, 7, v1
    v_lshrrev_b32 v24, 4, v1
    s_and_b32 s70, s69, 1
    s_lshl3_add_u32 s70, s70, s49
    s_lshl2_add_u32 s73, s70, s40
    s_lshl2_add_u32 s74, s45, s72
    s_lshl_b32 s41, s40, 11
    s_lshl_b32 s42, s40, 12
    s_lshl4_add_u32 s51, s70, s74
    s_lshl_b32 s51, s51, 13
    s_add_u32 s51, s51, s41
    v_lshlrev_b32 v2, 4, v1
    v_xor_b32 v25, v23, v24
    v_lshlrev_b32 v25, 4, v25
    v_lshl_add_u32 v7, v22, 10, v25
    s_lshl_b32 s70, s73, 15
    v_add_u32 v7, s70, v7
    v_xor_b32 v8, 64, v7
    v_add_u32 v8, 7168, v8
    s_lshl_b32 s70, s49, 2
    s_bfm_b32 s71, s70, 0
    s_and_b32 s3, s71, 0x76543210
    s_andn2_b32 s71, 0x07654321, s71
    s_or_b32 s3, s3, s71
    s_and_b32 s43, s3, 15
    s_lshr_b32 s3, s3, 4
    s_lshl_b32 s3, s3, 8
    s_or_b32 s43, s43, s3
    s_lshl_b32 s3, s49, 4
    s_or_b32 s43, s43, s3
    v_and_b32 v25, 1, v24
    v_lshlrev_b32 v25, 2, v25
    v_xor_b32 v25, v23, v25
    v_lshlrev_b32 v25, 4, v25
    s_lshl_b32 s70, s40, 4
    v_add_u32 v23, s70, v22
    s_lshr_b32 s70, s72, 1
    s_lshl_b32 s70, s70, 10
    s_lshl_b32 s71, s45, 8
    s_add_u32 s70, s70, s71
    s_and_b32 s71, s72, 1
    s_lshl_b32 s71, s71, 7
    s_add_u32 s70, s70, s71
    v_mul_u32_u24 v24, 3072, v23
    v_add3_u32 v3, v24, v25, s70
    v_add_u32 v4, 23552, v3
    s_mul_i32 s70, s45, 896
    s_lshl_b32 s71, s72, 7
    s_add_u32 s70, s70, s71
    v_mul_u32_u24 v24, 3584, v23
    v_add3_u32 v5, v24, v25, s70
    v_add_u32 v6, 27648, v5
    s_lshr_b32 s75, s67, 2
    s_lshl_b32 s70, s75, 7
    v_lshl_add_u32 v9, v22, 10, v25
    v_add_u32 v9, s70, v9
    v_add_u32 v10, 7168, v9
    s_mov_b32 s6, 2097152
    s_mov_b32 s7, 0x00020000
    s_mov_b32 s18, 1572864
    s_mov_b32 s19, 0x00020000
    s_mov_b32 s10, 1835008
    s_mov_b32 s11, 0x00020000
    s_mov_b32 s14, 1837056
    s_mov_b32 s15, 0x00020000
    s_mov_b32 s22, 20971520
    s_mov_b32 s23, 0x00020000
    s_mov_b32 s38, 256
    s_mov_b32 s39, 0x00020000
    s_mov_b32 s26, 1835008
    s_mov_b32 s27, 0x00020000
    s_mov_b32 s30, 524288
    s_mov_b32 s31, 0x00020000
    s_mov_b32 s34, 2097152
    s_mov_b32 s35, 0x00020000
    s_add_u32 m0, s42, 114688
    s_bfe_u32 s46, s43, 0x30000
    s_lshl_b32 s46, s46, 7
    s_waitcnt lgkmcnt(0)
    buffer_load_dwordx4 v[192:195], v2, s[4:7], s51 offen
    buffer_load_dwordx4 v[196:199], v2, s[4:7], s51 offen offset:1024
    buffer_load_dwordx4 v7, s[4:7], s46 offen offset:0 lds
    buffer_load_dwordx4 v8, s[4:7], s46 offen offset:1024 lds
    s_add_u32 s46, s46, 14336
    buffer_load_dwordx4 v7, s[4:7], s46 offen offset:2048 lds
    buffer_load_dwordx4 v8, s[4:7], s46 offen offset:3072 lds
    s_sub_u32 s12, s12, 2048
    s_subb_u32 s13, s13, 0
    s_add_u32 m0, s41, 0
    s_bfe_u32 s48, s43, 0x30000
    s_mul_i32 s47, s48, 196608
    buffer_load_dwordx4 v3, s[16:19], s47 offen offset:0 lds
    buffer_load_dwordx4 v4, s[16:19], s47 offen offset:1024 lds
    s_cmp_eq_u32 s72, 3
    s_cbranch_scc1 parallel_sum__sliding_block__glu_gated_bilinear__prompt_kernel_O
    s_add_u32 m0, s42, 8192
    s_mul_i32 s48, s48, 229376
    buffer_load_dwordx4 v5, s[8:11], s48 offen offset:0 lds
    buffer_load_dwordx4 v6, s[8:11], s48 offen offset:1024 lds
    buffer_load_dwordx4 v5, s[12:15], s48 offen offset:2048 lds
    buffer_load_dwordx4 v6, s[12:15], s48 offen offset:3072 lds
    s_lshl_b32 s70, s40, 4
    s_add_u32 s70, s70, s2
    s_cmp_ge_u32 s70, 16
    s_cbranch_scc1 parallel_sum__sliding_block__glu_gated_bilinear__prompt_kernel_nnG
    s_memrealtime s[76:77]
    s_waitcnt lgkmcnt(0)
    s_mul_i32 s70, s77, 0x9e3779b1
    s_xor_b32 s70, s70, s76
    s_or_b32 s70, s70, 1
    v_mov_b32 v228, s70
    v_mov_b32 v229, 0
    s_mov_b64 exec, 1
    buffer_atomic_cmpswap v[228:229], off, s[36:39], 0 sc1
    s_mov_b64 exec, -1
parallel_sum__sliding_block__glu_gated_bilinear__prompt_kernel_nnG:
    s_bitcmp1_b32 s40, 1
    s_cbranch_scc1 parallel_sum__sliding_block__glu_gated_bilinear__prompt_kernel_wh2G
    s_bitcmp1_b32 s40, 0
    s_cbranch_scc1 parallel_sum__sliding_block__glu_gated_bilinear__prompt_kernel_w2G1_0
    s_branch parallel_sum__sliding_block__glu_gated_bilinear__prompt_kernel_w2G0_0
parallel_sum__sliding_block__glu_gated_bilinear__prompt_kernel_wh2G:
    s_bitcmp1_b32 s40, 0
    s_cbranch_scc1 parallel_sum__sliding_block__glu_gated_bilinear__prompt_kernel_w2G3_0
    s_branch parallel_sum__sliding_block__glu_gated_bilinear__prompt_kernel_w2G2_0
parallel_sum__sliding_block__glu_gated_bilinear__prompt_kernel_wr2G:
    v_lshrrev_b32 v22, 5, v1
    v_bfe_u32 v23, v1, 2, 2
    v_bfe_u32 v24, v1, 4, 1
    v_and_b32 v25, 3, v1
    v_lshlrev_b32 v25, 3, v25
    v_lshl_add_u32 v25, v24, 5, v25
    v_lshl_add_u32 v25, v22, 10, v25
    v_lshl_add_u32 v25, v23, 7, v25
    v_lshrrev_b32 v23, 1, v23
    v_lshl_add_u32 v11, v23, 6, v25
    v_xor_b32 v12, 64, v11
    v_bfe_u32 v23, v1, 1, 3
    v_xor_b32 v23, v23, v22
    v_and_b32 v25, 31, v1
    v_lshlrev_b32 v25, 7, v25
    v_lshl_add_u32 v25, v23, 4, v25
    s_add_u32 s70, s42, 114688
    v_add_u32 v15, s70, v25
    v_xor_b32 v16, 32, v15
    v_xor_b32 v17, 64, v15
    s_add_u32 m0, s42, 131072
    s_bfe_u32 s46, s43, 0x30004
    s_lshl_b32 s46, s46, 7
    buffer_load_dwordx4 v7, s[4:7], s46 offen offset:0 lds
    v_xor_b32 v18, 96, v15
    v_add_u32 v13, 0x10000, v11
    v_add_u32 v14, 0x10000, v12
    v_mov_b32 v224, 0x3f803f80
    v_mov_b32 v225, 0x3f803f80
    v_mov_b32 v226, 0x3f803f80
    v_mov_b32 v227, 0x3f803f80
    v_mov_b32 v200, 0
    v_mov_b32 v201, 0
    v_mov_b32 v202, 0
    v_mov_b32 v203, 0
    s_and_b32 s70, s40, 1
    s_lshl_b32 s70, s70, 6
    v_xor_b32 v238, s70, v11
    s_lshr_b32 s71, s40, 1
    s_lshl_b32 s70, s71, 11
    s_add_u32 s3, s70, 32768
    v_add_u32 v236, s3, v238
    s_add_u32 s3, s70, 98304
    v_add_u32 v237, s3, v238
    buffer_load_dwordx4 v8, s[4:7], s46 offen offset:1024 lds
    s_lshl1_add_u32 s3, s70, 24576
    v_add_u32 v238, s3, v238
    v_and_b32 v242, 0x1f0, v2
    s_add_u32 s3, s42, 147456
    v_add_u32 v243, s3, v242
    v_lshl_add_u32 v244, v22, 12, v242
    v_add_u32 v244, 147456, v244
    v_lshlrev_b32 v245, 4, v22
    s_add_u32 s3, s3, 1024
    v_lshrrev_b32 v246, 2, v242
    v_add_u32 v246, s3, v246
    s_bitcmp1_b32 s74, 1
    s_cselect_b32 s70, 1.0, 0x3eb8aa3b
    v_mov_b32 v29, s70
    s_and_b32 s70, s69, 1
    s_lshl1_add_u32 s53, s74, s70
    s_lshl2_add_u32 s53, s53, s40
    s_lshl_b32 s53, s53, 12
    s_add_u32 s53, s53, 18874368
    s_lshl_b32 s70, s49, 9
    s_add_u32 s46, s46, 14336
    buffer_load_dwordx4 v7, s[4:7], s46 offen offset:2048 lds
    s_add_u32 s52, s53, s70
    s_lshl_b32 s54, s73, 9
    s_add_u32 s54, s54, 19398656
    s_lshr_b32 s51, s51, 6
    s_add_u32 s51, s51, 19398656
    s_mul_i32 s57, s73, 144
    s_lshl3_add_u32 s50, s45, s57
    s_and_b32 s70, s72, 1
    s_lshl2_add_u32 s50, s70, s50
    s_lshl_b32 s55, s70, 12
    s_and_b32 s70, s72, 2
    s_add_u32 s50, s50, s70
    s_lshl_b32 s50, s50, 10
    s_add_u32 s50, s50, 9437184
    s_lshl_b32 s70, s70, 20
    s_add_u32 s55, s55, s70
    s_lshl2_add_u32 s56, s73, s45
    s_lshl_b32 s56, s56, 13
    s_add_u32 s55, s55, s56
    s_add_u32 s55, s55, 1048576
    buffer_load_dwordx4 v8, s[4:7], s46 offen offset:3072 lds
    s_add_u32 s56, s56, 5242880
    s_mul_i32 s70, s45, 28
    s_add_u32 s57, s57, s70
    s_lshl2_add_u32 s57, s72, s57
    s_lshl_b32 s57, s57, 10
    s_add_u32 s57, s57, 9469952
    s_lshl4_add_u32 s58, s73, s74
    s_lshl_b32 s58, s58, 7
    s_add_u32 s58, s58, 19939328
    v_mov_b32 v220, -1
    v_mov_b32 v221, -1
    v_mov_b32 v222, -1
    v_mov_b32 v223, -1
    v_mov_b32 v34, 0
    v_mov_b32 v35, 0
    s_and_b32 s70, s67, 3
    s_lshl2_add_u32 s68, s69, s70
    s_mul_i32 s59, s40, 458752
    s_lshl_b32 s70, s75, 2
    s_mov_b32 s76, 0x10210210
    s_add_u32 m0, s41, 24576
    s_bfe_u32 s48, s43, 0x30004
    s_mul_i32 s47, s48, 196608
    buffer_load_dwordx4 v3, s[16:19], s47 offen offset:0 lds
    s_mov_b32 s77, 0x2102
    s_lshr_b64 s[76:77], s[76:77], s70
    s_and_b32 s44, s76, 0xfff
    s_and_b32 s70, s70, 12
    s_lshr_b32 s70, 0x65436543, s70
    s_and_b32 s70, s70, 0xffff
    s_lshl_b32 s70, s70, 12
    s_or_b32 s44, s44, s70
    s_lshl_b32 s60, s68, 12
    s_add_u32 s60, s60, 19922944
    s_and_b32 s70, s75, 1
    s_lshl_b32 s78, 0x44444444, s70
    s_or_b32 s78, s78, 0x88888888
    s_lshl_b32 s79, 0x55, s70
    s_or_b32 s79, s79, 0x88
    s_lshl_b32 s70, s68, 3
    s_sub_i32 s70, 32, s70
    s_max_i32 s70, s70, 0
    s_lshl_b64 s[76:77], -1, s70
    s_and_b32 s78, s78, s76
    buffer_load_dwordx4 v4, s[16:19], s47 offen offset:1024 lds
    s_bitcmp1_b32 s40, 1
    s_cbranch_scc1 parallel_sum__sliding_block__glu_gated_bilinear__prompt_kernel_wh3G
    s_bitcmp1_b32 s40, 0
    s_cbranch_scc1 parallel_sum__sliding_block__glu_gated_bilinear__prompt_kernel_w3G1_0
    s_branch parallel_sum__sliding_block__glu_gated_bilinear__prompt_kernel_w3G0_0
parallel_sum__sliding_block__glu_gated_bilinear__prompt_kernel_wh3G:
    s_bitcmp1_b32 s40, 0
    s_cbranch_scc1 parallel_sum__sliding_block__glu_gated_bilinear__prompt_kernel_wr3G
    s_branch parallel_sum__sliding_block__glu_gated_bilinear__prompt_kernel_w3G2_0
parallel_sum__sliding_block__glu_gated_bilinear__prompt_kernel_wr3G:
    s_lshl2_add_u32 s71, s75, s40
    s_lshl_b32 s71, s71, 10
    s_lshl_b32 s61, s68, 16
    s_add_u32 s61, s61, s71
    s_add_u32 s61, s61, 1081344
    s_mul_i32 s70, s68, 294912
    s_add_u32 s70, s70, 9437184
    s_add_u32 s64, s70, s71
    s_lshl1_add_u32 s63, s42, s70
    s_mul_i32 s62, s40, 28672
    s_add_u32 s62, s62, s70
    s_add_u32 s62, s62, 32768
    s_lshl_b32 s66, s68, 10
    s_add_u32 s66, s66, 19398656
    s_and_b32 s70, s40, 1
    s_lshl1_add_u32 s65, s68, s70
    s_lshl_b32 s65, s65, 8
    s_add_u32 s65, s65, s75
    s_lshr_b32 s71, s40, 1
    s_lshl1_add_u32 s65, s65, s71
    s_add_u32 m0, s42, 32768
    s_mul_i32 s48, s48, 229376
    buffer_load_dwordx4 v5, s[8:11], s48 offen offset:0 lds
    s_lshl_b32 s65, s65, 6
    s_lshl_b32 s71, s71, 6
    v_bfe_u32 v23, v1, 2, 2
    v_lshl_add_u32 v19, v22, 2, v23
    v_lshlrev_b32 v19, 7, v19
    v_lshrrev_b32 v23, 1, v23
    v_lshl_add_u32 v19, v23, 6, v19
    v_lshl_add_u32 v19, v24, 5, v19
    v_and_b32 v23, 1, v1
    v_lshl_add_u32 v19, v23, 4, v19
    v_bfe_u32 v23, v1, 1, 1
    v_lshl_add_u32 v19, v23, 3, v19
    v_xor_b32 v19, s71, v19
    s_add_u32 s71, s42, 114688
    v_add_u32 v19, s71, v19
    v_xor_b32 v20, 64, v19
    v_add_u32 v26, 2097152, v2
    v_and_b32 v23, 15, v1
    v_lshlrev_b32 v27, 4, v23
    v_lshl_add_u32 v27, v22, 9, v27
    buffer_load_dwordx4 v6, s[8:11], s48 offen offset:1024 lds
    v_lshl_add_u32 v27, v24, 10, v27
    s_mul_i32 s71, s70, 768
    s_sub_u32 s71, 4194304, s71
    v_add_u32 v27, s71, v27
    s_mul_i32 s70, s70, 147456
    s_sub_u32 s71, 147456, s70
    v_add_u32 v30, s70, v2
    v_add_u32 v31, s71, v2
    v_lshlrev_b32 v0, 6, v242
    v_lshl_add_u32 v0, v22, 4, v0
    v_lshrrev_b32 v23, 2, v1
    v_and_b32 v25, 3, v1
    v_lshlrev_b32 v25, 2, v25
    s_lshr_b32 s70, s75, 1
    s_lshl_b32 s70, s70, 4
    v_lshl_add_u32 v28, v23, 6, v25
    v_add_u32 v28, s70, v28
    v_and_b32 v23, 1, v23
    v_lshl_add_u32 v25, v23, 6, v25
    v_lshl_add_u32 v25, v24, 13, v25
    buffer_load_dwordx4 v5, s[12:15], s48 offen offset:2048 lds
    s_lshl4_add_u32 s70, s40, 8704
    v_add_u32 v25, s70, v25
    v_cmp_lt_u32 vcc, 39, v1
    s_nop 1
    v_cndmask_b32 v28, v28, v25, vcc
    v_lshlrev_b32 v28, 5, v28
    s_mov_b32 s67, 1006632960
    v_and_b32 v23, 31, v1
    v_lshlrev_b32 v24, 2, v22
    v_sub_u32 v23, v23, v24
    v_mov_b32 v24, 0xf149f2ca
    v_cmp_le_i32 vcc, 0, v23
    v_cmp_le_i32 s[76:77], 1, v23
    s_nop 0
    v_cndmask_b32 v48, v24, 0, vcc
    v_cndmask_b32 v49, v24, 0, s[76:77]
    v_cmp_le_i32 vcc, 2, v23
    v_cmp_le_i32 s[76:77], 3, v23
    s_nop 0
    v_cndmask_b32 v50, v24, 0, vcc
    v_cndmask_b32 v51, v24, 0, s[76:77]
    v_cmp_le_i32 vcc, 8, v23
    v_cmp_le_i32 s[76:77], 9, v23
    buffer_load_dwordx4 v6, s[12:15], s48 offen offset:3072 lds
    v_cndmask_b32 v52, v24, 0, vcc
    v_cndmask_b32 v53, v24, 0, s[76:77]
    v_cmp_le_i32 vcc, 10, v23
    v_cmp_le_i32 s[76:77], 11, v23
    s_nop 0
    v_cndmask_b32 v54, v24, 0, vcc
    v_cndmask_b32 v55, v24, 0, s[76:77]
    v_cmp_le_i32 vcc, 16, v23
    v_cmp_le_i32 s[76:77], 17, v23
    s_nop 0
    v_cndmask_b32 v56, v24, 0, vcc
    v_cndmask_b32 v57, v24, 0, s[76:77]
    v_cmp_le_i32 vcc, 18, v23
    v_cmp_le_i32 s[76:77], 19, v23
    s_nop 0
    v_cndmask_b32 v58, v24, 0, vcc
    v_cndmask_b32 v59, v24, 0, s[76:77]
    v_cmp_le_i32 vcc, 24, v23
    v_cmp_le_i32 s[76:77], 25, v23
    s_nop 0
    v_cndmask_b32 v60, v24, 0, vcc
    v_cndmask_b32 v61, v24, 0, s[76:77]
    v_cmp_le_i32 vcc, 26, v23
    v_cmp_le_i32 s[76:77], 27, v23
    s_nop 0
    v_cndmask_b32 v62, v24, 0, vcc
    v_cndmask_b32 v63, v24, 0, s[76:77]
    v_lshl_add_u32 v25, v22, 4, s3
    s_waitcnt vmcnt(20)
    v_dot2c_f32_bf16 v200, v224, v192
    v_dot2c_f32_bf16 v201, v192, v192
    v_dot2c_f32_bf16 v202, v224, v196
    v_dot2c_f32_bf16 v203, v196, v196
    v_dot2c_f32_bf16 v200, v224, v193
    v_dot2c_f32_bf16 v201, v193, v193
    v_dot2c_f32_bf16 v202, v224, v197
    v_dot2c_f32_bf16 v203, v197, v197
    v_dot2c_f32_bf16 v200, v224, v194
    v_dot2c_f32_bf16 v201, v194, v194
    v_dot2c_f32_bf16 v202, v224, v198
    v_dot2c_f32_bf16 v203, v198, v198
    v_dot2c_f32_bf16 v200, v224, v195
    v_dot2c_f32_bf16 v201, v195, v195
    v_dot2c_f32_bf16 v202, v224, v199
    v_dot2c_f32_bf16 v203, v199, v199
    s_nop 1
    v_permlane32_swap_b32 v200, v202
    v_permlane32_swap_b32 v201, v203
    v_add_f32 v200, v200, v202
    v_add_f32 v201, v201, v203
    s_nop 1
    v_permlane16_swap_b32 v200, v201
    v_add_f32 v200, v200, v201
    s_nop 1
    v_add_f32_dpp v200, v200, v200 row_ror:8 row_mask:0xf bank_mask:0xf
    s_nop 1
    v_add_f32_dpp v200, v200, v200 row_ror:4 row_mask:0xf bank_mask:0xf
    s_nop 1
    v_add_f32_dpp v200, v200, v200 row_ror:2 row_mask:0xf bank_mask:0xf
    s_nop 1
    v_add_f32_dpp v200, v200, v200 row_ror:1 row_mask:0xf bank_mask:0xf
    v_mov_b32 v201, v200
    s_nop 1
    v_permlane16_swap_b32 v200, v201
    v_mul_f32 v216, 0xbb000000, v200
    v_mul_f32 v201, 0x3b000000, v201
    v_fma_f32 v201, -v216, v216, v201
    v_max_f32 v201, 0, v201
    v_add_f32 v218, 0x3727c5ac, v201
    v_rsq_f32 v217, v218
    s_waitcnt vmcnt(10)
    s_barrier
    ds_read_b128 a[16:19], v15 offset:0
    ds_read_b64_tr_b16 v[64:65], v11 offset:0
    ds_read_b64_tr_b16 v[66:67], v11 offset:512
    ds_read_b64_tr_b16 v[68:69], v12 offset:0
    ds_read_b64_tr_b16 v[70:71], v12 offset:512
    ds_read_b128 a[20:23], v16 offset:0
    ds_read_b64_tr_b16 v[72:73], v11 offset:8192
    ds_read_b64_tr_b16 v[74:75], v11 offset:8704
    ds_read_b64_tr_b16 v[76:77], v12 offset:8192
    ds_read_b64_tr_b16 v[78:79], v12 offset:8704
    ds_read_b128 a[24:27], v17 offset:0
    ds_read_b64_tr_b16 v[80:81], v11 offset:10240
    ds_read_b64_tr_b16 v[82:83], v11 offset:10752
    ds_read_b64_tr_b16 v[84:85], v12 offset:10240
    ds_read_b64_tr_b16 v[86:87], v12 offset:10752
    ds_read_b128 a[28:31], v18 offset:0
    ds_read_b64_tr_b16 v[88:89], v11 offset:2048
    ds_read_b64_tr_b16 v[90:91], v11 offset:2560
    s_waitcnt lgkmcnt(2)
    v_mfma_f32_32x32x16_bf16 v[96:111], v[64:67], a[16:19], 0
    ds_read_b64_tr_b16 v[92:93], v12 offset:2048
    ds_read_b64_tr_b16 v[94:95], v12 offset:2560
    s_add_u32 m0, s42, 147456
    s_bfe_u32 s46, s43, 0x30008
    s_lshl_b32 s46, s46, 7
    v_mfma_f32_32x32x16_bf16 v[112:127], v[68:71], a[16:19], 0
    ds_read_b64_tr_b16 v[64:65], v11 offset:12288
    ds_read_b64_tr_b16 v[66:67], v11 offset:12800
    buffer_load_dwordx4 v7, s[4:7], s46 offen offset:0 lds
    v_mfma_f32_32x32x16_bf16 v[128:143], v[72:75], a[16:19], 0
    ds_read_b64_tr_b16 v[68:69], v12 offset:12288
    ds_read_b64_tr_b16 v[70:71], v12 offset:12800
    buffer_load_dwordx4 v8, s[4:7], s46 offen offset:1024 lds
    s_add_u32 s46, s46, 14336
    v_mfma_f32_32x32x16_bf16 v[144:159], v[76:79], a[16:19], 0
    ds_read_b64_tr_b16 v[72:73], v11 offset:14336
    ds_read_b64_tr_b16 v[74:75], v11 offset:14848
    buffer_load_dwordx4 v7, s[4:7], s46 offen offset:2048 lds
    v_mfma_f32_32x32x16_bf16 v[160:175], v[80:83], a[16:19], 0
    ds_read_b64_tr_b16 v[76:77], v12 offset:14336
    ds_read_b64_tr_b16 v[78:79], v12 offset:14848
    buffer_load_dwordx4 v8, s[4:7], s46 offen offset:3072 lds
    s_add_u32 m0, s41, 49152
    v_mfma_f32_32x32x16_bf16 v[176:191], v[84:87], a[16:19], 0
    ds_read_b64_tr_b16 v[80:81], v11 offset:4096
    ds_read_b64_tr_b16 v[82:83], v11 offset:4608
    s_bfe_u32 s48, s43, 0x30008
    s_mul_i32 s47, s48, 196608
    buffer_load_dwordx4 v3, s[16:19], s47 offen offset:0 lds
    s_waitcnt lgkmcnt(10)
    v_mfma_f32_32x32x16_bf16 v[96:111], v[88:91], a[20:23], v[96:111]
    ds_read_b64_tr_b16 v[84:85], v12 offset:4096
    ds_read_b64_tr_b16 v[86:87], v12 offset:4608
    buffer_load_dwordx4 v4, s[16:19], s47 offen offset:1024 lds
    s_add_u32 m0, s42, 57344
    v_mfma_f32_32x32x16_bf16 v[112:127], v[92:95], a[20:23], v[112:127]
    ds_read_b64_tr_b16 v[88:89], v11 offset:16384
    ds_read_b64_tr_b16 v[90:91], v11 offset:16896
    s_mul_i32 s48, s48, 229376
    buffer_load_dwordx4 v5, s[8:11], s48 offen offset:0 lds
    s_waitcnt lgkmcnt(10)
    v_mfma_f32_32x32x16_bf16 v[128:143], v[64:67], a[20:23], v[128:143]
    ds_read_b64_tr_b16 v[92:93], v12 offset:16384
    ds_read_b64_tr_b16 v[94:95], v12 offset:16896
    buffer_load_dwordx4 v6, s[8:11], s48 offen offset:1024 lds
    v_mfma_f32_32x32x16_bf16 v[144:159], v[68:71], a[20:23], v[144:159]
    ds_read_b64_tr_b16 v[64:65], v11 offset:18432
    ds_read_b64_tr_b16 v[66:67], v11 offset:18944
    buffer_load_dwordx4 v5, s[12:15], s48 offen offset:2048 lds
    s_waitcnt lgkmcnt(10)
    v_mfma_f32_32x32x16_bf16 v[160:175], v[72:75], a[20:23], v[160:175]
    ds_read_b64_tr_b16 v[68:69], v12 offset:18432
    ds_read_b64_tr_b16 v[70:71], v12 offset:18944
    buffer_load_dwordx4 v6, s[12:15], s48 offen offset:3072 lds
    s_add_u32 m0, s42, 97920
    v_mfma_f32_32x32x16_bf16 v[176:191], v[76:79], a[20:23], v[176:191]
    ds_read_b64_tr_b16 v[72:73], v11 offset:6144
    ds_read_b64_tr_b16 v[74:75], v11 offset:6656
    s_bfe_u32 s48, s43, 0x30004
    s_mul_i32 s48, s48, 229376
    buffer_load_dwordx4 v5, s[8:11], s48 offen offset:384 lds
    s_waitcnt lgkmcnt(10)
    v_mfma_f32_32x32x16_bf16 v[96:111], v[80:83], a[24:27], v[96:111]
    ds_read_b64_tr_b16 v[76:77], v12 offset:6144
    ds_read_b64_tr_b16 v[78:79], v12 offset:6656
    buffer_load_dwordx4 v6, s[8:11], s48 offen offset:1408 lds
    v_mfma_f32_32x32x16_bf16 v[112:127], v[84:87], a[24:27], v[112:127]
    ds_read_b64_tr_b16 v[80:81], v11 offset:20480
    ds_read_b64_tr_b16 v[82:83], v11 offset:20992
    buffer_load_dwordx4 v5, s[12:15], s48 offen offset:2432 lds
    s_waitcnt lgkmcnt(10)
    v_mfma_f32_32x32x16_bf16 v[128:143], v[88:91], a[24:27], v[128:143]
    ds_read_b64_tr_b16 v[84:85], v12 offset:20480
    ds_read_b64_tr_b16 v[86:87], v12 offset:20992
    buffer_load_dwordx4 v6, s[12:15], s48 offen offset:3456 lds
    s_add_u32 m0, s42, 114688
    v_mfma_f32_32x32x16_bf16 v[144:159], v[92:95], a[24:27], v[144:159]
    ds_read_b64_tr_b16 v[88:89], v11 offset:22528
    ds_read_b64_tr_b16 v[90:91], v11 offset:23040
    s_bfe_u32 s46, s43, 0x3000c
    s_lshl_b32 s46, s46, 7
    s_waitcnt lgkmcnt(10)
    v_mfma_f32_32x32x16_bf16 v[160:175], v[64:67], a[24:27], v[160:175]
    ds_read_b64_tr_b16 v[92:93], v12 offset:22528
    ds_read_b64_tr_b16 v[94:95], v12 offset:23040
    buffer_load_dwordx4 v7, s[4:7], s46 offen offset:0 lds
    s_waitcnt vmcnt(15)
    s_barrier
    v_mfma_f32_32x32x16_bf16 v[176:191], v[68:71], a[24:27], v[176:191]
    ds_read_b64_tr_b16 v[64:65], v11 offset:24576
    ds_read_b64_tr_b16 v[66:67], v11 offset:25088
    ds_read_b128 a[0:3], v15 offset:16384
    ds_read_b128 a[4:7], v16 offset:16384
    s_waitcnt lgkmcnt(12)
    v_mfma_f32_32x32x16_bf16 v[96:111], v[72:75], a[28:31], v[96:111]
    ds_read_b64_tr_b16 v[68:69], v12 offset:24576
    ds_read_b64_tr_b16 v[70:71], v12 offset:25088
    ds_read_b128 a[8:11], v17 offset:16384
    v_mfma_f32_32x32x16_bf16 v[112:127], v[76:79], a[28:31], v[112:127]
    ds_read_b64_tr_b16 v[72:73], v11 offset:32768
    ds_read_b64_tr_b16 v[74:75], v11 offset:33280
    ds_read_b128 a[12:15], v18 offset:16384
    ds_read_b64_tr_b16 v[192:193], v236 offset:0
    s_waitcnt lgkmcnt(15)
    v_mfma_f32_32x32x16_bf16 v[128:143], v[80:83], a[28:31], v[128:143]
    ds_read_b64_tr_b16 v[76:77], v12 offset:32768
    ds_read_b64_tr_b16 v[78:79], v12 offset:33280
    ds_read_b64_tr_b16 v[194:195], v236 offset:512
    ds_read_b64_tr_b16 v[196:197], v236 offset:4096
    v_mfma_f32_32x32x16_bf16 v[144:159], v[84:87], a[28:31], v[144:159]
    ds_read_b64_tr_b16 v[80:81], v11 offset:34816
    ds_read_b64_tr_b16 v[82:83], v11 offset:35328
    ds_read_b64_tr_b16 v[198:199], v236 offset:4608
    ds_read_b64_tr_b16 v[200:201], v236 offset:8192
    ds_read_b64_tr_b16 v[202:203], v236 offset:8704
    s_waitcnt lgkmcnt(15)
    v_mfma_f32_32x32x16_bf16 v[160:175], v[88:91], a[28:31], v[160:175]
    ds_read_b64_tr_b16 v[84:85], v12 offset:34816
    ds_read_b64_tr_b16 v[86:87], v12 offset:35328
    ds_read_b64_tr_b16 v[204:205], v236 offset:12288
    ds_read_b64_tr_b16 v[206:207], v236 offset:12800
    v_mfma_f32_32x32x16_bf16 v[176:191], v[92:95], a[28:31], v[176:191]
    ds_read_b64_tr_b16 v[88:89], v11 offset:26624
    ds_read_b64_tr_b16 v[90:91], v11 offset:27136
    ds_read_b64_tr_b16 v[208:209], v238 offset:0
    ds_read_b64_tr_b16 v[210:211], v238 offset:512
    ds_read_b64_tr_b16 v[212:213], v238 offset:2048
    s_waitcnt lgkmcnt(15)
    v_mfma_f32_32x32x16_bf16 v[96:111], v[64:67], a[0:3], v[96:111]
    ds_read_b64_tr_b16 v[92:93], v12 offset:26624
    ds_read_b64_tr_b16 v[94:95], v12 offset:27136
    ds_read_b64_tr_b16 v[214:215], v238 offset:2560
    v_mfma_f32_32x32x16_bf16 v[112:127], v[68:71], a[0:3], v[112:127]
    ds_read_b64_tr_b16 v[64:65], v11 offset:36864
    ds_read_b64_tr_b16 v[66:67], v11 offset:37376
    buffer_load_dwordx4 v8, s[4:7], s46 offen offset:1024 lds
    s_add_u32 s46, s46, 14336
    v_mfma_f32_32x32x16_bf16 v[128:143], v[72:75], a[0:3], v[128:143]
    ds_read_b64_tr_b16 v[68:69], v12 offset:36864
    ds_read_b64_tr_b16 v[70:71], v12 offset:37376
    v_mfma_f32_32x32x16_bf16 v[144:159], v[76:79], a[0:3], v[144:159]
    ds_read_b64_tr_b16 v[72:73], v11 offset:38912
    ds_read_b64_tr_b16 v[74:75], v11 offset:39424
    buffer_load_dwordx4 v7, s[4:7], s46 offen offset:2048 lds
    s_waitcnt lgkmcnt(15)
    v_mfma_f32_32x32x16_bf16 v[160:175], v[80:83], a[0:3], v[160:175]
    ds_read_b64_tr_b16 v[76:77], v12 offset:38912
    ds_read_b64_tr_b16 v[78:79], v12 offset:39424
    v_mfma_f32_32x32x16_bf16 v[176:191], v[84:87], a[0:3], v[176:191]
    ds_read_b64_tr_b16 v[80:81], v11 offset:28672
    ds_read_b64_tr_b16 v[82:83], v11 offset:29184
    buffer_load_dwordx4 v8, s[4:7], s46 offen offset:3072 lds
    s_add_u32 m0, s41, 73728
    s_bfe_u32 s48, s43, 0x3000c
    s_waitcnt lgkmcnt(11)
    v_mfma_f32_32x32x16_bf16 v[96:111], v[88:91], a[4:7], v[96:111]
    ds_read_b64_tr_b16 v[84:85], v12 offset:28672
    ds_read_b64_tr_b16 v[86:87], v12 offset:29184
    s_mul_i32 s47, s48, 196608
    s_lshl2_add_u32 s70, s2, s40
    v_mul_u32_u24 v22, 40, v1
    s_mul_i32 s71, s70, 2392
    v_mfma_f32_32x32x16_bf16 v[112:127], v[92:95], a[4:7], v[112:127]
    ds_read_b64_tr_b16 v[88:89], v11 offset:40960
    ds_read_b64_tr_b16 v[90:91], v11 offset:41472
    buffer_load_dword v21, off, s[36:39], 0 sc1
    s_waitcnt lgkmcnt(10)
    v_mfma_f32_32x32x16_bf16 v[128:143], v[64:67], a[4:7], v[128:143]
    ds_read_b64_tr_b16 v[92:93], v12 offset:40960
    ds_read_b64_tr_b16 v[94:95], v12 offset:41472
    buffer_load_dword a248, v22, s[24:27], s71 offen
    s_mul_i32 s70, s70, 684
    v_mul_u32_u24 v23, 12, v1
    v_mfma_f32_32x32x16_bf16 v[144:159], v[68:71], a[4:7], v[144:159]
    ds_read_b64_tr_b16 v[64:65], v11 offset:43008
    ds_read_b64_tr_b16 v[66:67], v11 offset:43520
    buffer_load_dwordx4 v3, s[16:19], s47 offen offset:0 lds
    s_waitcnt lgkmcnt(10)
    v_mfma_f32_32x32x16_bf16 v[160:175], v[72:75], a[4:7], v[160:175]
    ds_read_b64_tr_b16 v[68:69], v12 offset:43008
    ds_read_b64_tr_b16 v[70:71], v12 offset:43520
    buffer_load_dword a249, v23, s[28:31], s70 offen
    v_mfma_f32_32x32x16_bf16 a[128:143], v[224:227], v[192:195], 0
    buffer_load_dwordx4 v4, s[16:19], s47 offen offset:1024 lds
    s_add_u32 m0, s42, 81920
    s_mul_i32 s48, s48, 229376
    s_branch parallel_sum__sliding_block__glu_gated_bilinear__prompt_kernel_ws0
parallel_sum__sliding_block__glu_gated_bilinear__prompt_kernel_w2G0_0:
    s_branch parallel_sum__sliding_block__glu_gated_bilinear__prompt_kernel_wr2G
parallel_sum__sliding_block__glu_gated_bilinear__prompt_kernel_ws0:
    v_mfma_f32_32x32x16_bf16 v[176:191], v[76:79], a[4:7], v[176:191]
    ds_read_b64_tr_b16 v[72:73], v11 offset:30720
    ds_read_b64_tr_b16 v[74:75], v11 offset:31232
    s_waitcnt lgkmcnt(10)
    v_mfma_f32_32x32x16_bf16 v[96:111], v[80:83], a[8:11], v[96:111]
    ds_read_b64_tr_b16 v[76:77], v12 offset:30720
    ds_read_b64_tr_b16 v[78:79], v12 offset:31232
    buffer_load_dwordx4 v5, s[8:11], s48 offen offset:0 lds
    v_mfma_f32_32x32x16_bf16 a[128:143], v[224:227], v[196:199], a[128:143]
    v_mfma_f32_32x32x16_bf16 v[112:127], v[84:87], a[8:11], v[112:127]
    ds_read_b64_tr_b16 v[80:81], v11 offset:45056
    ds_read_b64_tr_b16 v[82:83], v11 offset:45568
    buffer_load_dwordx4 v6, s[8:11], s48 offen offset:1024 lds
    s_waitcnt lgkmcnt(10)
    v_mfma_f32_32x32x16_bf16 v[128:143], v[88:91], a[8:11], v[128:143]
    ds_read_b64_tr_b16 v[84:85], v12 offset:45056
    ds_read_b64_tr_b16 v[86:87], v12 offset:45568
    v_mfma_f32_32x32x16_bf16 a[128:143], v[224:227], v[200:203], a[128:143]
    buffer_load_dwordx4 v5, s[12:15], s48 offen offset:2048 lds
    v_mfma_f32_32x32x16_bf16 v[144:159], v[92:95], a[8:11], v[144:159]
    ds_read_b64_tr_b16 v[88:89], v11 offset:47104
    ds_read_b64_tr_b16 v[90:91], v11 offset:47616
    s_waitcnt lgkmcnt(10)
    v_mfma_f32_32x32x16_bf16 v[160:175], v[64:67], a[8:11], v[160:175]
    ds_read_b64_tr_b16 v[92:93], v12 offset:47104
    ds_read_b64_tr_b16 v[94:95], v12 offset:47616
    buffer_load_dwordx4 v6, s[12:15], s48 offen offset:3072 lds
    s_waitcnt vmcnt(13)
    s_barrier
    v_mfma_f32_32x32x16_bf16 a[128:143], v[224:227], v[204:207], a[128:143]
    ds_read_b128 a[32:35], v15 offset:32768
    ds_read_b128 a[36:39], v16 offset:32768
    ds_read_b128 a[40:43], v17 offset:32768
    s_add_u32 m0, s42, 131072
    s_bfe_u32 s46, s43, 0x30010
    v_mfma_f32_32x32x16_bf16 v[176:191], v[68:71], a[8:11], v[176:191]
    ds_read_b64_tr_b16 v[64:65], v11 offset:49152
    ds_read_b64_tr_b16 v[66:67], v11 offset:49664
    ds_read_b128 a[44:47], v18 offset:32768
    ds_read_b64_tr_b16 v[192:193], v237 offset:0
    s_lshl_b32 s46, s46, 7
    s_waitcnt lgkmcnt(15)
    v_mfma_f32_32x32x16_bf16 v[96:111], v[72:75], a[12:15], v[96:111]
    ds_read_b64_tr_b16 v[68:69], v12 offset:49152
    ds_read_b64_tr_b16 v[70:71], v12 offset:49664
    ds_read_b64_tr_b16 v[194:195], v237 offset:512
    ds_read_b64_tr_b16 v[196:197], v237 offset:4096
    s_waitcnt vmcnt(8)
    v_readfirstlane_b32 s45, v21
    v_mfma_f32_32x32x16_bf16 a[160:175], v[224:227], v[208:211], 0
    ds_read_b64_tr_b16 v[198:199], v237 offset:4608
    ds_read_b64_tr_b16 v[200:201], v237 offset:8192
    ds_read_b64_tr_b16 v[202:203], v237 offset:8704
    ds_read_b64_tr_b16 v[204:205], v237 offset:12288
    ds_read_b64_tr_b16 v[206:207], v237 offset:12800
    s_cmp_eq_u32 s45, 0
    s_cbranch_scc1 parallel_sum__sliding_block__glu_gated_bilinear__prompt_kernel_rnG
parallel_sum__sliding_block__glu_gated_bilinear__prompt_kernel_rnrG:
    v_mfma_f32_32x32x16_bf16 v[112:127], v[76:79], a[12:15], v[112:127]
    ds_read_b64_tr_b16 v[72:73], v11 offset:57344
    ds_read_b64_tr_b16 v[74:75], v11 offset:57856
    buffer_load_dwordx4 v7, s[4:7], s46 offen offset:0 lds
    s_waitcnt lgkmcnt(15)
    v_mfma_f32_32x32x16_bf16 v[128:143], v[80:83], a[12:15], v[128:143]
    ds_read_b64_tr_b16 v[76:77], v12 offset:57344
    ds_read_b64_tr_b16 v[78:79], v12 offset:57856
    v_mov_b32 v219, v21
    v_mov_b32 v231, v21
    v_mfma_f32_32x32x16_bf16 a[160:175], v[224:227], v[212:215], a[160:175]
    buffer_load_dwordx4 v8, s[4:7], s46 offen offset:1024 lds
    s_add_u32 s46, s46, 14336
    v_mfma_f32_32x32x16_bf16 v[144:159], v[84:87], a[12:15], v[144:159]
    ds_read_b64_tr_b16 v[80:81], v11 offset:59392
    ds_read_b64_tr_b16 v[82:83], v11 offset:59904
    s_mov_b32 exec_lo, 1
    s_mov_b32 exec_hi, 1
    buffer_store_dwordx4 v[216:219], v245, s[20:23], s51 offen sc1
    s_mov_b64 exec, -1
    v_mfma_f32_32x32x16_bf16 v[160:175], v[88:91], a[12:15], v[160:175]
    ds_read_b64_tr_b16 v[84:85], v12 offset:59392
    ds_read_b64_tr_b16 v[86:87], v12 offset:59904
    buffer_load_dwordx4 v7, s[4:7], s46 offen offset:2048 lds
    v_mfma_f32_32x32x16_bf16 v[176:191], v[92:95], a[12:15], v[176:191]
    ds_read_b64_tr_b16 v[88:89], v11 offset:51200
    ds_read_b64_tr_b16 v[90:91], v11 offset:51712
    s_waitcnt lgkmcnt(15)
    v_mfma_f32_32x32x16_bf16 v[96:111], v[64:67], a[32:35], v[96:111]
    ds_read_b64_tr_b16 v[92:93], v12 offset:51200
    ds_read_b64_tr_b16 v[94:95], v12 offset:51712
    buffer_load_dwordx4 v8, s[4:7], s46 offen offset:3072 lds
    s_add_u32 m0, s41, 0
    v_mfma_f32_32x32x16_bf16 v[112:127], v[68:71], a[32:35], v[112:127]
    ds_read_b64_tr_b16 v[64:65], v11 offset:61440
    ds_read_b64_tr_b16 v[66:67], v11 offset:61952
    s_bfe_u32 s48, s43, 0x30010
    s_mul_i32 s47, s48, 196608
    s_waitcnt lgkmcnt(10)
    v_mfma_f32_32x32x16_bf16 v[128:143], v[72:75], a[32:35], v[128:143]
    ds_read_b64_tr_b16 v[68:69], v12 offset:61440
    ds_read_b64_tr_b16 v[70:71], v12 offset:61952
    buffer_load_dwordx4 v3, s[16:19], s47 offen offset:0 lds
    v_mfma_f32_32x32x16_bf16 v[144:159], v[76:79], a[32:35], v[144:159]
    ds_read_b64_tr_b16 v[72:73], v11 offset:63488
    ds_read_b64_tr_b16 v[74:75], v11 offset:64000
    s_waitcnt lgkmcnt(10)
    v_mfma_f32_32x32x16_bf16 v[160:175], v[80:83], a[32:35], v[160:175]
    ds_read_b64_tr_b16 v[76:77], v12 offset:63488
    ds_read_b64_tr_b16 v[78:79], v12 offset:64000
    buffer_load_dwordx4 v4, s[16:19], s47 offen offset:1024 lds
    s_add_u32 m0, s42, 8192
    v_mfma_f32_32x32x16_bf16 v[176:191], v[84:87], a[32:35], v[176:191]
    ds_read_b64_tr_b16 v[80:81], v11 offset:53248
    ds_read_b64_tr_b16 v[82:83], v11 offset:53760
    s_mul_i32 s48, s48, 229376
    s_waitcnt lgkmcnt(10)
    v_mfma_f32_32x32x16_bf16 v[96:111], v[88:91], a[36:39], v[96:111]
    ds_read_b64_tr_b16 v[84:85], v12 offset:53248
    ds_read_b64_tr_b16 v[86:87], v12 offset:53760
    buffer_load_dwordx4 v5, s[8:11], s48 offen offset:0 lds
    v_mfma_f32_32x32x16_bf16 v[112:127], v[92:95], a[36:39], v[112:127]
    ds_read_b64_tr_b16 v[88:89], v13 offset:0
    ds_read_b64_tr_b16 v[90:91], v13 offset:512
    s_waitcnt lgkmcnt(10)
    v_mfma_f32_32x32x16_bf16 v[128:143], v[64:67], a[36:39], v[128:143]
    ds_read_b64_tr_b16 v[92:93], v14 offset:0
    ds_read_b64_tr_b16 v[94:95], v14 offset:512
    buffer_load_dwordx4 v6, s[8:11], s48 offen offset:1024 lds
    v_mfma_f32_32x32x16_bf16 a[144:159], v[224:227], v[192:195], 0
    v_mfma_f32_32x32x16_bf16 v[144:159], v[68:71], a[36:39], v[144:159]
    ds_read_b64_tr_b16 v[64:65], v13 offset:2048
    ds_read_b64_tr_b16 v[66:67], v13 offset:2560
    buffer_load_dwordx4 v5, s[12:15], s48 offen offset:2048 lds
    s_waitcnt lgkmcnt(10)
    v_mfma_f32_32x32x16_bf16 v[160:175], v[72:75], a[36:39], v[160:175]
    ds_read_b64_tr_b16 v[68:69], v14 offset:2048
    ds_read_b64_tr_b16 v[70:71], v14 offset:2560
    v_mfma_f32_32x32x16_bf16 a[144:159], v[224:227], v[196:199], a[144:159]
    buffer_load_dwordx4 v6, s[12:15], s48 offen offset:3072 lds
    s_add_u32 m0, s42, 147456
    s_bfe_u32 s46, s43, 0x30014
    s_lshl_b32 s46, s46, 7
    v_mfma_f32_32x32x16_bf16 v[176:191], v[76:79], a[36:39], v[176:191]
    ds_read_b64_tr_b16 v[72:73], v11 offset:55296
    ds_read_b64_tr_b16 v[74:75], v11 offset:55808
    s_waitcnt lgkmcnt(10)
    v_mfma_f32_32x32x16_bf16 v[96:111], v[80:83], a[40:43], v[96:111]
    ds_read_b64_tr_b16 v[76:77], v12 offset:55296
    ds_read_b64_tr_b16 v[78:79], v12 offset:55808
    buffer_load_dwordx4 v7, s[4:7], s46 offen offset:0 lds
    v_mfma_f32_32x32x16_bf16 a[144:159], v[224:227], v[200:203], a[144:159]
    v_mfma_f32_32x32x16_bf16 v[112:127], v[84:87], a[40:43], v[112:127]
    ds_read_b64_tr_b16 v[80:81], v13 offset:4096
    ds_read_b64_tr_b16 v[82:83], v13 offset:4608
    buffer_load_dwordx4 v8, s[4:7], s46 offen offset:1024 lds
    s_add_u32 s46, s46, 14336
    s_waitcnt lgkmcnt(10)
    v_mfma_f32_32x32x16_bf16 v[128:143], v[88:91], a[40:43], v[128:143]
    ds_read_b64_tr_b16 v[84:85], v14 offset:4096
    ds_read_b64_tr_b16 v[86:87], v14 offset:4608
    v_mfma_f32_32x32x16_bf16 a[144:159], v[224:227], v[204:207], a[144:159]
    buffer_load_dwordx4 v7, s[4:7], s46 offen offset:2048 lds
    v_mfma_f32_32x32x16_bf16 v[144:159], v[92:95], a[40:43], v[144:159]
    ds_read_b64_tr_b16 v[88:89], v13 offset:6144
    ds_read_b64_tr_b16 v[90:91], v13 offset:6656
    s_waitcnt lgkmcnt(10)
    v_mfma_f32_32x32x16_bf16 v[160:175], v[64:67], a[40:43], v[160:175]
    ds_read_b64_tr_b16 v[92:93], v14 offset:6144
    ds_read_b64_tr_b16 v[94:95], v14 offset:6656
    buffer_load_dwordx4 v8, s[4:7], s46 offen offset:3072 lds
    s_waitcnt vmcnt(10)
    s_barrier
    v_mfma_f32_32x32x16_bf16 v[176:191], v[68:71], a[40:43], v[176:191]
    ds_read_b64_tr_b16 v[64:65], v13 offset:8192
    ds_read_b64_tr_b16 v[66:67], v13 offset:8704
    ds_read_b128 a[48:51], v15 offset:0
    ds_read_b128 a[52:55], v16 offset:0
    s_add_u32 m0, s41, 24576
    s_bfe_u32 s48, s43, 0x30014
    s_waitcnt lgkmcnt(12)
    v_mfma_f32_32x32x16_bf16 v[96:111], v[72:75], a[44:47], v[96:111]
    ds_read_b64_tr_b16 v[68:69], v14 offset:8192
    ds_read_b64_tr_b16 v[70:71], v14 offset:8704
    ds_read_b128 a[56:59], v17 offset:0
    s_mul_i32 s47, s48, 196608
    v_accvgpr_read_b32 v228, a128
    v_mfma_f32_32x32x16_bf16 v[112:127], v[76:79], a[44:47], v[112:127]
    ds_read_b64_tr_b16 v[72:73], v13 offset:16384
    ds_read_b64_tr_b16 v[74:75], v13 offset:16896
    ds_read_b128 a[60:63], v18 offset:0
    ds_read_b128 a[64:67], v15 offset:16384
    v_accvgpr_read_b32 v229, a144
    v_accvgpr_read_b32 v230, a160
    s_waitcnt lgkmcnt(15)
    v_mfma_f32_32x32x16_bf16 v[128:143], v[80:83], a[44:47], v[128:143]
    ds_read_b64_tr_b16 v[76:77], v14 offset:16384
    ds_read_b64_tr_b16 v[78:79], v14 offset:16896
    ds_read_b128 a[68:71], v16 offset:16384
    v_mfma_f32_32x32x16_bf16 v[144:159], v[84:87], a[44:47], v[144:159]
    ds_read_b64_tr_b16 v[80:81], v13 offset:18432
    ds_read_b64_tr_b16 v[82:83], v13 offset:18944
    ds_read_b128 a[72:75], v17 offset:16384
    ds_read_b128 a[76:79], v18 offset:16384
    s_waitcnt lgkmcnt(15)
    v_mfma_f32_32x32x16_bf16 v[160:175], v[88:91], a[44:47], v[160:175]
    ds_read_b64_tr_b16 v[84:85], v14 offset:18432
    ds_read_b64_tr_b16 v[86:87], v14 offset:18944
    buffer_load_dwordx4 v3, s[16:19], s47 offen offset:0 lds
    v_mfma_f32_32x32x16_bf16 v[176:191], v[92:95], a[44:47], v[176:191]
    ds_read_b64_tr_b16 v[88:89], v13 offset:10240
    ds_read_b64_tr_b16 v[90:91], v13 offset:10752
    buffer_store_dwordx4 v[228:231], v242, s[20:23], s52 offen sc1
    s_waitcnt lgkmcnt(12)
    v_mfma_f32_32x32x16_bf16 v[96:111], v[64:67], a[48:51], v[96:111]
    ds_read_b64_tr_b16 v[92:93], v14 offset:10240
    ds_read_b64_tr_b16 v[94:95], v14 offset:10752
    buffer_load_dwordx4 v4, s[16:19], s47 offen offset:1024 lds
    s_add_u32 m0, s42, 32768
    v_mfma_f32_32x32x16_bf16 v[112:127], v[68:71], a[48:51], v[112:127]
    ds_read_b64_tr_b16 v[64:65], v13 offset:20480
    ds_read_b64_tr_b16 v[66:67], v13 offset:20992
    s_mul_i32 s48, s48, 229376
    s_waitcnt lgkmcnt(13)
    v_mfma_f32_32x32x16_bf16 v[128:143], v[72:75], a[48:51], v[128:143]
    ds_read_b64_tr_b16 v[68:69], v14 offset:20480
    ds_read_b64_tr_b16 v[70:71], v14 offset:20992
    buffer_load_dwordx4 v5, s[8:11], s48 offen offset:0 lds
    v_mfma_f32_32x32x16_bf16 v[144:159], v[76:79], a[48:51], v[144:159]
    ds_read_b64_tr_b16 v[72:73], v13 offset:22528
    ds_read_b64_tr_b16 v[74:75], v13 offset:23040
    s_waitcnt lgkmcnt(10)
    v_mfma_f32_32x32x16_bf16 v[160:175], v[80:83], a[48:51], v[160:175]
    ds_read_b64_tr_b16 v[76:77], v14 offset:22528
    ds_read_b64_tr_b16 v[78:79], v14 offset:23040
    buffer_load_dwordx4 v6, s[8:11], s48 offen offset:1024 lds
    v_mfma_f32_32x32x16_bf16 v[176:191], v[84:87], a[48:51], v[176:191]
    ds_read_b64_tr_b16 v[80:81], v13 offset:12288
    ds_read_b64_tr_b16 v[82:83], v13 offset:12800
    s_waitcnt lgkmcnt(10)
    v_mfma_f32_32x32x16_bf16 v[96:111], v[88:91], a[52:55], v[96:111]
    ds_read_b64_tr_b16 v[84:85], v14 offset:12288
    ds_read_b64_tr_b16 v[86:87], v14 offset:12800
    buffer_load_dwordx4 v5, s[12:15], s48 offen offset:2048 lds
    v_mfma_f32_32x32x16_bf16 v[112:127], v[92:95], a[52:55], v[112:127]
    ds_read_b64_tr_b16 v[88:89], v13 offset:24576
    ds_read_b64_tr_b16 v[90:91], v13 offset:25088
    s_waitcnt lgkmcnt(10)
    v_mfma_f32_32x32x16_bf16 v[128:143], v[64:67], a[52:55], v[128:143]
    ds_read_b64_tr_b16 v[92:93], v14 offset:24576
    ds_read_b64_tr_b16 v[94:95], v14 offset:25088
    buffer_load_dwordx4 v6, s[12:15], s48 offen offset:3072 lds
    s_add_u32 m0, s42, 114688
    v_mfma_f32_32x32x16_bf16 v[144:159], v[68:71], a[52:55], v[144:159]
    ds_read_b64_tr_b16 v[64:65], v13 offset:26624
    ds_read_b64_tr_b16 v[66:67], v13 offset:27136
    s_bfe_u32 s46, s43, 0x30018
    s_lshl_b32 s46, s46, 7
    s_waitcnt lgkmcnt(10)
    v_mfma_f32_32x32x16_bf16 v[160:175], v[72:75], a[52:55], v[160:175]
    ds_read_b64_tr_b16 v[68:69], v14 offset:26624
    ds_read_b64_tr_b16 v[70:71], v14 offset:27136
    buffer_load_dwordx4 v7, s[4:7], s46 offen offset:0 lds
    v_mfma_f32_32x32x16_bf16 v[176:191], v[76:79], a[52:55], v[176:191]
    ds_read_b64_tr_b16 v[72:73], v13 offset:14336
    ds_read_b64_tr_b16 v[74:75], v13 offset:14848
    s_waitcnt lgkmcnt(10)
    v_mfma_f32_32x32x16_bf16 v[96:111], v[80:83], a[56:59], v[96:111]
    ds_read_b64_tr_b16 v[76:77], v14 offset:14336
    ds_read_b64_tr_b16 v[78:79], v14 offset:14848
    buffer_load_dwordx4 v8, s[4:7], s46 offen offset:1024 lds
    s_add_u32 s46, s46, 14336
    v_mfma_f32_32x32x16_bf16 v[112:127], v[84:87], a[56:59], v[112:127]
    ds_read_b64_tr_b16 v[80:81], v13 offset:28672
    ds_read_b64_tr_b16 v[82:83], v13 offset:29184
    s_waitcnt lgkmcnt(10)
    v_mfma_f32_32x32x16_bf16 v[128:143], v[88:91], a[56:59], v[128:143]
    ds_read_b64_tr_b16 v[84:85], v14 offset:28672
    ds_read_b64_tr_b16 v[86:87], v14 offset:29184
    buffer_load_dwordx4 v7, s[4:7], s46 offen offset:2048 lds
    v_mfma_f32_32x32x16_bf16 v[144:159], v[92:95], a[56:59], v[144:159]
    ds_read_b64_tr_b16 v[88:89], v13 offset:30720
    ds_read_b64_tr_b16 v[90:91], v13 offset:31232
    s_waitcnt lgkmcnt(10)
    v_mfma_f32_32x32x16_bf16 v[160:175], v[64:67], a[56:59], v[160:175]
    ds_read_b64_tr_b16 v[92:93], v14 offset:30720
    ds_read_b64_tr_b16 v[94:95], v14 offset:31232
    buffer_load_dwordx4 v8, s[4:7], s46 offen offset:3072 lds
    s_waitcnt vmcnt(11)
    s_barrier
    v_mfma_f32_32x32x16_bf16 v[176:191], v[68:71], a[56:59], v[176:191]
    ds_read_b64_tr_b16 v[64:65], v11 offset:0
    ds_read_b64_tr_b16 v[66:67], v11 offset:512
    ds_read_b128 a[80:83], v15 offset:32768
    ds_read_b128 a[84:87], v16 offset:32768
    s_add_u32 m0, s41, 49152
    s_bfe_u32 s48, s43, 0x30018
    s_waitcnt lgkmcnt(12)
    v_mfma_f32_32x32x16_bf16 v[96:111], v[72:75], a[60:63], v[96:111]
    ds_read_b64_tr_b16 v[68:69], v12 offset:0
    ds_read_b64_tr_b16 v[70:71], v12 offset:512
    ds_read_b128 a[88:91], v17 offset:32768
    s_mul_i32 s47, s48, 196608
    v_mfma_f32_32x32x16_bf16 v[112:127], v[76:79], a[60:63], v[112:127]
    ds_read_b64_tr_b16 v[72:73], v11 offset:8192
    ds_read_b64_tr_b16 v[74:75], v11 offset:8704
    ds_read_b128 a[92:95], v18 offset:32768
    buffer_load_dwordx4 v3, s[16:19], s47 offen offset:0 lds
    s_waitcnt lgkmcnt(14)
    v_mfma_f32_32x32x16_bf16 v[128:143], v[80:83], a[60:63], v[128:143]
    ds_read_b64_tr_b16 v[76:77], v12 offset:8192
    ds_read_b64_tr_b16 v[78:79], v12 offset:8704
    v_mfma_f32_32x32x16_bf16 v[144:159], v[84:87], a[60:63], v[144:159]
    ds_read_b64_tr_b16 v[80:81], v11 offset:10240
    ds_read_b64_tr_b16 v[82:83], v11 offset:10752
    buffer_load_dwordx4 v4, s[16:19], s47 offen offset:1024 lds
    s_add_u32 m0, s42, 57344
    s_mul_i32 s48, s48, 229376
    s_waitcnt lgkmcnt(14)
    v_mfma_f32_32x32x16_bf16 v[160:175], v[88:91], a[60:63], v[160:175]
    ds_read_b64_tr_b16 v[84:85], v12 offset:10240
    ds_read_b64_tr_b16 v[86:87], v12 offset:10752
    v_mfma_f32_32x32x16_bf16 v[176:191], v[92:95], a[60:63], v[176:191]
    ds_read_b64_tr_b16 v[88:89], v11 offset:2048
    ds_read_b64_tr_b16 v[90:91], v11 offset:2560
    buffer_load_dwordx4 v5, s[8:11], s48 offen offset:0 lds
    s_waitcnt lgkmcnt(12)
    v_mfma_f32_32x32x16_bf16 v[96:111], v[64:67], a[64:67], v[96:111]
    ds_read_b64_tr_b16 v[92:93], v12 offset:2048
    ds_read_b64_tr_b16 v[94:95], v12 offset:2560
    v_mfma_f32_32x32x16_bf16 v[112:127], v[68:71], a[64:67], v[112:127]
    ds_read_b64_tr_b16 v[64:65], v11 offset:12288
    ds_read_b64_tr_b16 v[66:67], v11 offset:12800
    buffer_load_dwordx4 v6, s[8:11], s48 offen offset:1024 lds
    s_waitcnt lgkmcnt(10)
    v_mfma_f32_32x32x16_bf16 v[128:143], v[72:75], a[64:67], v[128:143]
    ds_read_b64_tr_b16 v[68:69], v12 offset:12288
    ds_read_b64_tr_b16 v[70:71], v12 offset:12800
    v_mfma_f32_32x32x16_bf16 v[144:159], v[76:79], a[64:67], v[144:159]
    ds_read_b64_tr_b16 v[72:73], v11 offset:14336
    ds_read_b64_tr_b16 v[74:75], v11 offset:14848
    buffer_load_dwordx4 v5, s[12:15], s48 offen offset:2048 lds
    s_waitcnt lgkmcnt(10)
    v_mfma_f32_32x32x16_bf16 v[160:175], v[80:83], a[64:67], v[160:175]
    ds_read_b64_tr_b16 v[76:77], v12 offset:14336
    ds_read_b64_tr_b16 v[78:79], v12 offset:14848
    v_mfma_f32_32x32x16_bf16 v[176:191], v[84:87], a[64:67], v[176:191]
    ds_read_b64_tr_b16 v[80:81], v11 offset:4096
    ds_read_b64_tr_b16 v[82:83], v11 offset:4608
    buffer_load_dwordx4 v6, s[12:15], s48 offen offset:3072 lds
    s_add_u32 m0, s42, 131072
    s_bfe_u32 s46, s43, 0x3001c
    s_waitcnt lgkmcnt(10)
    v_mfma_f32_32x32x16_bf16 v[96:111], v[88:91], a[68:71], v[96:111]
    ds_read_b64_tr_b16 v[84:85], v12 offset:4096
    ds_read_b64_tr_b16 v[86:87], v12 offset:4608
    s_lshl_b32 s46, s46, 7
    v_mfma_f32_32x32x16_bf16 v[112:127], v[92:95], a[68:71], v[112:127]
    ds_read_b64_tr_b16 v[88:89], v11 offset:16384
    ds_read_b64_tr_b16 v[90:91], v11 offset:16896
    buffer_load_dwordx4 v7, s[4:7], s46 offen offset:0 lds
    s_waitcnt lgkmcnt(10)
    v_mfma_f32_32x32x16_bf16 v[128:143], v[64:67], a[68:71], v[128:143]
    ds_read_b64_tr_b16 v[92:93], v12 offset:16384
    ds_read_b64_tr_b16 v[94:95], v12 offset:16896
    v_mfma_f32_32x32x16_bf16 v[144:159], v[68:71], a[68:71], v[144:159]
    ds_read_b64_tr_b16 v[64:65], v11 offset:18432
    ds_read_b64_tr_b16 v[66:67], v11 offset:18944
    buffer_load_dwordx4 v8, s[4:7], s46 offen offset:1024 lds
    s_add_u32 s46, s46, 14336
    s_waitcnt lgkmcnt(10)
    v_mfma_f32_32x32x16_bf16 v[160:175], v[72:75], a[68:71], v[160:175]
    ds_read_b64_tr_b16 v[68:69], v12 offset:18432
    ds_read_b64_tr_b16 v[70:71], v12 offset:18944
    v_mfma_f32_32x32x16_bf16 v[176:191], v[76:79], a[68:71], v[176:191]
    ds_read_b64_tr_b16 v[72:73], v11 offset:6144
    ds_read_b64_tr_b16 v[74:75], v11 offset:6656
    buffer_load_dwordx4 v7, s[4:7], s46 offen offset:2048 lds
    s_waitcnt lgkmcnt(10)
    v_mfma_f32_32x32x16_bf16 v[96:111], v[80:83], a[72:75], v[96:111]
    ds_read_b64_tr_b16 v[76:77], v12 offset:6144
    ds_read_b64_tr_b16 v[78:79], v12 offset:6656
    v_mfma_f32_32x32x16_bf16 v[112:127], v[84:87], a[72:75], v[112:127]
    ds_read_b64_tr_b16 v[80:81], v11 offset:20480
    ds_read_b64_tr_b16 v[82:83], v11 offset:20992
    buffer_load_dwordx4 v8, s[4:7], s46 offen offset:3072 lds
    s_waitcnt lgkmcnt(10)
    v_mfma_f32_32x32x16_bf16 v[128:143], v[88:91], a[72:75], v[128:143]
    ds_read_b64_tr_b16 v[84:85], v12 offset:20480
    ds_read_b64_tr_b16 v[86:87], v12 offset:20992
    v_add_u32 v7, 14336, v9
    v_add_u32 v8, 14336, v10
    v_mfma_f32_32x32x16_bf16 v[144:159], v[92:95], a[72:75], v[144:159]
    ds_read_b64_tr_b16 v[88:89], v11 offset:22528
    ds_read_b64_tr_b16 v[90:91], v11 offset:23040
    buffer_store_dwordx4 v[220:223], v2, s[20:23], s50 offen sc1
    s_waitcnt lgkmcnt(10)
    v_mfma_f32_32x32x16_bf16 v[160:175], v[64:67], a[72:75], v[160:175]
    ds_read_b64_tr_b16 v[92:93], v12 offset:22528
    ds_read_b64_tr_b16 v[94:95], v12 offset:23040
    s_waitcnt vmcnt(11)
    s_barrier
    v_mfma_f32_32x32x16_bf16 v[176:191], v[68:71], a[72:75], v[176:191]
    ds_read_b64_tr_b16 v[64:65], v11 offset:24576
    ds_read_b64_tr_b16 v[66:67], v11 offset:25088
    ds_read_b128 a[96:99], v15 offset:0
    ds_read_b128 a[100:103], v16 offset:0
    s_waitcnt lgkmcnt(12)
    v_mfma_f32_32x32x16_bf16 v[96:111], v[72:75], a[76:79], v[96:111]
    ds_read_b64_tr_b16 v[68:69], v12 offset:24576
    ds_read_b64_tr_b16 v[70:71], v12 offset:25088
    ds_read_b128 a[104:107], v17 offset:0
    v_mfma_f32_32x32x16_bf16 v[112:127], v[76:79], a[76:79], v[112:127]
    ds_read_b64_tr_b16 v[72:73], v11 offset:32768
    ds_read_b64_tr_b16 v[74:75], v11 offset:33280
    ds_read_b128 a[108:111], v18 offset:0
    buffer_load_dwordx4 v[232:235], v242, s[20:23], s54 offen sc1
    s_waitcnt lgkmcnt(14)
    v_mfma_f32_32x32x16_bf16 v[128:143], v[80:83], a[76:79], v[128:143]
    ds_read_b64_tr_b16 v[76:77], v12 offset:32768
    ds_read_b64_tr_b16 v[78:79], v12 offset:33280
    buffer_store_dwordx4 v[220:223], v2, s[20:23], s50 offen offset:1024 sc1
    v_mfma_f32_32x32x16_bf16 v[144:159], v[84:87], a[76:79], v[144:159]
    ds_read_b64_tr_b16 v[80:81], v11 offset:34816
    ds_read_b64_tr_b16 v[82:83], v11 offset:35328
    s_add_u32 m0, s41, 73728
    s_bfe_u32 s48, s43, 0x3001c
    s_mul_i32 s47, s48, 196608
    s_waitcnt lgkmcnt(14)
    v_mfma_f32_32x32x16_bf16 v[160:175], v[88:91], a[76:79], v[160:175]
    ds_read_b64_tr_b16 v[84:85], v12 offset:34816
    ds_read_b64_tr_b16 v[86:87], v12 offset:35328
    buffer_load_dwordx4 v3, s[16:19], s47 offen offset:0 lds
    v_mfma_f32_32x32x16_bf16 v[176:191], v[92:95], a[76:79], v[176:191]
    ds_read_b64_tr_b16 v[88:89], v11 offset:26624
    ds_read_b64_tr_b16 v[90:91], v11 offset:27136
    buffer_load_dwordx4 v[192:195], v2, s[20:23], s53 offen offset:0 sc1
    s_waitcnt lgkmcnt(12)
    v_mfma_f32_32x32x16_bf16 v[96:111], v[64:67], a[80:83], v[96:111]
    ds_read_b64_tr_b16 v[92:93], v12 offset:26624
    ds_read_b64_tr_b16 v[94:95], v12 offset:27136
    buffer_load_dwordx4 v4, s[16:19], s47 offen offset:1024 lds
    s_add_u32 m0, s42, 81920
    v_mfma_f32_32x32x16_bf16 v[112:127], v[68:71], a[80:83], v[112:127]
    ds_read_b64_tr_b16 v[64:65], v11 offset:36864
    ds_read_b64_tr_b16 v[66:67], v11 offset:37376
    s_mul_i32 s48, s48, 229376
    buffer_load_dwordx4 v[196:199], v2, s[20:23], s53 offen offset:1024 sc1
    s_waitcnt lgkmcnt(10)
    v_mfma_f32_32x32x16_bf16 v[128:143], v[72:75], a[80:83], v[128:143]
    ds_read_b64_tr_b16 v[68:69], v12 offset:36864
    ds_read_b64_tr_b16 v[70:71], v12 offset:37376
    buffer_load_dwordx4 v5, s[8:11], s48 offen offset:0 lds
    v_mfma_f32_32x32x16_bf16 v[144:159], v[76:79], a[80:83], v[144:159]
    ds_read_b64_tr_b16 v[72:73], v11 offset:38912
    ds_read_b64_tr_b16 v[74:75], v11 offset:39424
    buffer_load_dwordx4 v[200:203], v2, s[20:23], s53 offen offset:2048 sc1
    s_waitcnt lgkmcnt(10)
    v_mfma_f32_32x32x16_bf16 v[160:175], v[80:83], a[80:83], v[160:175]
    ds_read_b64_tr_b16 v[76:77], v12 offset:38912
    ds_read_b64_tr_b16 v[78:79], v12 offset:39424
    buffer_load_dwordx4 v6, s[8:11], s48 offen offset:1024 lds
    v_mfma_f32_32x32x16_bf16 v[176:191], v[84:87], a[80:83], v[176:191]
    ds_read_b64_tr_b16 v[80:81], v11 offset:28672
    ds_read_b64_tr_b16 v[82:83], v11 offset:29184
    buffer_load_dwordx4 v[204:207], v2, s[20:23], s53 offen offset:3072 sc1
    s_waitcnt lgkmcnt(10)
    v_mfma_f32_32x32x16_bf16 v[96:111], v[88:91], a[84:87], v[96:111]
    ds_read_b64_tr_b16 v[84:85], v12 offset:28672
    ds_read_b64_tr_b16 v[86:87], v12 offset:29184
    buffer_load_dwordx4 v5, s[12:15], s48 offen offset:2048 lds
    v_mfma_f32_32x32x16_bf16 v[112:127], v[92:95], a[84:87], v[112:127]
    ds_read_b64_tr_b16 v[88:89], v11 offset:40960
    ds_read_b64_tr_b16 v[90:91], v11 offset:41472
    s_waitcnt lgkmcnt(10)
    v_mfma_f32_32x32x16_bf16 v[128:143], v[64:67], a[84:87], v[128:143]
    ds_read_b64_tr_b16 v[92:93], v12 offset:40960
    ds_read_b64_tr_b16 v[94:95], v12 offset:41472
    buffer_load_dwordx4 v6, s[12:15], s48 offen offset:3072 lds
    s_add_u32 m0, s42, 114688
    v_mfma_f32_32x32x16_bf16 v[144:159], v[68:71], a[84:87], v[144:159]
    ds_read_b64_tr_b16 v[64:65], v11 offset:43008
    ds_read_b64_tr_b16 v[66:67], v11 offset:43520
    s_bfe_u32 s49, s44, 0x30000
    s_lshl_b32 s49, s49, 16
    s_add_u32 s49, s49, s59
    s_waitcnt lgkmcnt(10)
    v_mfma_f32_32x32x16_bf16 v[160:175], v[72:75], a[84:87], v[160:175]
    ds_read_b64_tr_b16 v[68:69], v12 offset:43008
    ds_read_b64_tr_b16 v[70:71], v12 offset:43520
    buffer_load_dwordx4 v9, s[24:27], s49 offen offset:0 lds
    v_mfma_f32_32x32x16_bf16 v[176:191], v[76:79], a[84:87], v[176:191]
    ds_read_b64_tr_b16 v[72:73], v11 offset:30720
    ds_read_b64_tr_b16 v[74:75], v11 offset:31232
    v_subrev_u32 v3, 114688, v19
    v_subrev_u32 v4, 114688, v20
    s_waitcnt lgkmcnt(10)
    v_mfma_f32_32x32x16_bf16 v[96:111], v[80:83], a[88:91], v[96:111]
    ds_read_b64_tr_b16 v[76:77], v12 offset:30720
    ds_read_b64_tr_b16 v[78:79], v12 offset:31232
    buffer_load_dwordx4 v10, s[24:27], s49 offen offset:1024 lds
    v_mfma_f32_32x32x16_bf16 v[112:127], v[84:87], a[88:91], v[112:127]
    ds_read_b64_tr_b16 v[80:81], v11 offset:45056
    ds_read_b64_tr_b16 v[82:83], v11 offset:45568
    s_waitcnt lgkmcnt(10)
    v_mfma_f32_32x32x16_bf16 v[128:143], v[88:91], a[88:91], v[128:143]
    ds_read_b64_tr_b16 v[84:85], v12 offset:45056
    ds_read_b64_tr_b16 v[86:87], v12 offset:45568
    buffer_load_dwordx4 v7, s[24:27], s49 offen offset:2048 lds
    v_mfma_f32_32x32x16_bf16 v[144:159], v[92:95], a[88:91], v[144:159]
    ds_read_b64_tr_b16 v[88:89], v11 offset:47104
    ds_read_b64_tr_b16 v[90:91], v11 offset:47616
    s_waitcnt lgkmcnt(10)
    v_mfma_f32_32x32x16_bf16 v[160:175], v[64:67], a[88:91], v[160:175]
    ds_read_b64_tr_b16 v[92:93], v12 offset:47104
    ds_read_b64_tr_b16 v[94:95], v12 offset:47616
    buffer_load_dwordx4 v8, s[24:27], s49 offen offset:3072 lds
    s_waitcnt vmcnt(17)
    s_barrier
    v_mfma_f32_32x32x16_bf16 v[176:191], v[68:71], a[88:91], v[176:191]
    ds_read_b64_tr_b16 v[64:65], v11 offset:49152
    ds_read_b64_tr_b16 v[66:67], v11 offset:49664
    ds_read_b128 a[112:115], v15 offset:16384
    ds_read_b128 a[116:119], v16 offset:16384
    v_add_u32 v5, 384, v5
    v_add_u32 v6, 384, v6
    s_waitcnt lgkmcnt(12)
    v_mfma_f32_32x32x16_bf16 v[96:111], v[72:75], a[92:95], v[96:111]
    ds_read_b64_tr_b16 v[68:69], v12 offset:49152
    ds_read_b64_tr_b16 v[70:71], v12 offset:49664
    ds_read_b128 a[120:123], v17 offset:16384
    s_add_u32 m0, s42, 0
    s_bfe_u32 s48, s43, 0x30000
    v_mfma_f32_32x32x16_bf16 v[112:127], v[76:79], a[92:95], v[112:127]
    ds_read_b64_tr_b16 v[72:73], v11 offset:57344
    ds_read_b64_tr_b16 v[74:75], v11 offset:57856
    ds_read_b128 a[124:127], v18 offset:16384
    s_mul_i32 s48, s48, 229376
    s_waitcnt lgkmcnt(14)
    v_mfma_f32_32x32x16_bf16 v[128:143], v[80:83], a[92:95], v[128:143]
    ds_read_b64_tr_b16 v[76:77], v12 offset:57344
    ds_read_b64_tr_b16 v[78:79], v12 offset:57856
    buffer_load_dwordx4 v5, s[8:11], s48 offen offset:0 lds
    v_mfma_f32_32x32x16_bf16 v[144:159], v[84:87], a[92:95], v[144:159]
    ds_read_b64_tr_b16 v[80:81], v11 offset:59392
    ds_read_b64_tr_b16 v[82:83], v11 offset:59904
    s_waitcnt lgkmcnt(14)
    v_mfma_f32_32x32x16_bf16 v[160:175], v[88:91], a[92:95], v[160:175]
    ds_read_b64_tr_b16 v[84:85], v12 offset:59392
    ds_read_b64_tr_b16 v[86:87], v12 offset:59904
    buffer_load_dwordx4 v6, s[8:11], s48 offen offset:1024 lds
    v_mfma_f32_32x32x16_bf16 v[176:191], v[92:95], a[92:95], v[176:191]
    ds_read_b64_tr_b16 v[88:89], v11 offset:51200
    ds_read_b64_tr_b16 v[90:91], v11 offset:51712
    s_branch parallel_sum__sliding_block__glu_gated_bilinear__prompt_kernel_ws1
parallel_sum__sliding_block__glu_gated_bilinear__prompt_kernel_w2G1_0:
    s_branch parallel_sum__sliding_block__glu_gated_bilinear__prompt_kernel_wr2G
parallel_sum__sliding_block__glu_gated_bilinear__prompt_kernel_ws1:
    s_waitcnt lgkmcnt(12)
    v_mfma_f32_32x32x16_bf16 v[96:111], v[64:67], a[96:99], v[96:111]
    ds_read_b64_tr_b16 v[92:93], v12 offset:51200
    ds_read_b64_tr_b16 v[94:95], v12 offset:51712
    buffer_load_dwordx4 v5, s[12:15], s48 offen offset:2048 lds
    v_mfma_f32_32x32x16_bf16 v[112:127], v[68:71], a[96:99], v[112:127]
    ds_read_b64_tr_b16 v[64:65], v11 offset:61440
    ds_read_b64_tr_b16 v[66:67], v11 offset:61952
    s_waitcnt vmcnt(9)
    v_xor_b32 v235, s45, v235
    v_xor_b32 v195, s45, v195
    v_xor_b32 v199, s45, v199
    v_xor_b32 v203, s45, v203
    s_waitcnt lgkmcnt(10)
    v_mfma_f32_32x32x16_bf16 v[128:143], v[72:75], a[96:99], v[128:143]
    ds_read_b64_tr_b16 v[68:69], v12 offset:61440
    ds_read_b64_tr_b16 v[70:71], v12 offset:61952
    buffer_load_dwordx4 v6, s[12:15], s48 offen offset:3072 lds
    s_add_u32 m0, s42, 131072
    v_mfma_f32_32x32x16_bf16 v[144:159], v[76:79], a[96:99], v[144:159]
    ds_read_b64_tr_b16 v[72:73], v11 offset:63488
    ds_read_b64_tr_b16 v[74:75], v11 offset:64000
    s_add_u32 s49, s49, 32768
    v_xor_b32 v207, s45, v207
    v_or3_b32 v235, v235, v195, v199
    v_or3_b32 v235, v235, v203, v207
    v_cmp_ne_u32 s[76:77], 0, v235
    s_waitcnt lgkmcnt(10)
    v_mfma_f32_32x32x16_bf16 v[160:175], v[80:83], a[96:99], v[160:175]
    ds_read_b64_tr_b16 v[76:77], v12 offset:63488
    ds_read_b64_tr_b16 v[78:79], v12 offset:64000
    buffer_load_dwordx4 v9, s[24:27], s49 offen offset:0 lds
    v_mfma_f32_32x32x16_bf16 v[176:191], v[84:87], a[96:99], v[176:191]
    ds_read_b64_tr_b16 v[80:81], v11 offset:53248
    ds_read_b64_tr_b16 v[82:83], v11 offset:53760
    s_cmp_lg_u64 s[76:77], 0
    s_cbranch_scc1 parallel_sum__sliding_block__glu_gated_bilinear__prompt_kernel_rgG
parallel_sum__sliding_block__glu_gated_bilinear__prompt_kernel_rgrG:
    v_add_f32 v192, v192, v196
    v_add_f32 v193, v193, v197
    v_add_f32 v194, v194, v198
    s_waitcnt lgkmcnt(10)
    v_mfma_f32_32x32x16_bf16 v[96:111], v[88:91], a[100:103], v[96:111]
    ds_read_b64_tr_b16 v[84:85], v12 offset:53248
    ds_read_b64_tr_b16 v[86:87], v12 offset:53760
    buffer_load_dwordx4 v10, s[24:27], s49 offen offset:1024 lds
    v_add_f32 v200, v200, v204
    v_mfma_f32_32x32x16_bf16 v[112:127], v[92:95], a[100:103], v[112:127]
    ds_read_b64_tr_b16 v[88:89], v13 offset:0
    ds_read_b64_tr_b16 v[90:91], v13 offset:512
    v_add_f32 v201, v201, v205
    v_add_f32 v202, v202, v206
    v_add_f32 v192, v192, v200
    v_add_f32 v193, v193, v201
    v_add_f32 v194, v194, v202
    s_waitcnt lgkmcnt(10)
    v_mfma_f32_32x32x16_bf16 v[128:143], v[64:67], a[100:103], v[128:143]
    ds_read_b64_tr_b16 v[92:93], v14 offset:0
    ds_read_b64_tr_b16 v[94:95], v14 offset:512
    buffer_load_dwordx4 v7, s[24:27], s49 offen offset:2048 lds
    v_mov_b32 v239, v192
    v_mfma_f32_32x32x16_bf16 v[144:159], v[68:71], a[100:103], v[144:159]
    ds_read_b64_tr_b16 v[64:65], v13 offset:2048
    ds_read_b64_tr_b16 v[66:67], v13 offset:2560
    v_mov_b32 v240, v193
    v_mov_b32 v241, v194
    v_permlane32_swap_b32 v192, v239
    v_permlane32_swap_b32 v193, v240
    v_permlane32_swap_b32 v194, v241
    s_waitcnt lgkmcnt(10)
    v_mfma_f32_32x32x16_bf16 v[160:175], v[72:75], a[100:103], v[160:175]
    ds_read_b64_tr_b16 v[68:69], v14 offset:2048
    ds_read_b64_tr_b16 v[70:71], v14 offset:2560
    buffer_load_dwordx4 v8, s[24:27], s49 offen offset:3072 lds
    v_add_f32 v192, v192, v239
    v_mfma_f32_32x32x16_bf16 v[176:191], v[76:79], a[100:103], v[176:191]
    ds_read_b64_tr_b16 v[72:73], v11 offset:55296
    ds_read_b64_tr_b16 v[74:75], v11 offset:55808
    v_add_f32 v193, v193, v240
    v_add_f32 v194, v194, v241
    ds_write_b128 v243, v[192:195]
    s_waitcnt lgkmcnt(11)
    v_mfma_f32_32x32x16_bf16 v[96:111], v[80:83], a[104:107], v[96:111]
    ds_read_b64_tr_b16 v[76:77], v12 offset:55296
    ds_read_b64_tr_b16 v[78:79], v12 offset:55808
    s_waitcnt vmcnt(8)
    ds_read_b64_tr_b16 a[128:129], v19 offset:0
    ds_read_b64_tr_b16 a[130:131], v19 offset:1024
    v_mfma_f32_32x32x16_bf16 v[112:127], v[84:87], a[104:107], v[112:127]
    ds_read_b64_tr_b16 v[80:81], v13 offset:4096
    ds_read_b64_tr_b16 v[82:83], v13 offset:4608
    ds_read_b64_tr_b16 a[132:133], v20 offset:0
    ds_read_b64_tr_b16 a[134:135], v20 offset:1024
    ds_read_b64_tr_b16 a[136:137], v19 offset:2048
    s_waitcnt lgkmcnt(15)
    v_mfma_f32_32x32x16_bf16 v[128:143], v[88:91], a[104:107], v[128:143]
    ds_read_b64_tr_b16 v[84:85], v14 offset:4096
    ds_read_b64_tr_b16 v[86:87], v14 offset:4608
    ds_read_b64_tr_b16 a[138:139], v19 offset:3072
    ds_read_b64_tr_b16 a[140:141], v20 offset:2048
    ds_read_b64_tr_b16 a[142:143], v20 offset:3072
    v_mfma_f32_32x32x16_bf16 v[144:159], v[92:95], a[104:107], v[144:159]
    ds_read_b64_tr_b16 v[88:89], v13 offset:6144
    ds_read_b64_tr_b16 v[90:91], v13 offset:6656
    s_mov_b32 s76, 0
    s_mov_b32 s77, -1
    v_cvt_pk_bf16_f32 v33, v232, 0
    v_lshlrev_b32 v24, 16, v33
    s_waitcnt lgkmcnt(15)
    v_mfma_f32_32x32x16_bf16 v[160:175], v[64:67], a[104:107], v[160:175]
    ds_read_b64_tr_b16 v[92:93], v14 offset:6144
    ds_read_b64_tr_b16 v[94:95], v14 offset:6656
    v_sub_f32 v24, v232, v24
    s_barrier
    v_mfma_f32_32x32x16_bf16 v[176:191], v[68:71], a[104:107], v[176:191]
    ds_read_b64_tr_b16 v[64:65], v13 offset:8192
    ds_read_b64_tr_b16 v[66:67], v13 offset:8704
    s_add_u32 m0, s42, 16384
    s_bfe_u32 s48, s43, 0x30008
    s_mul_i32 s48, s48, 229376
    ds_read_b128 v[196:199], v244
    s_waitcnt lgkmcnt(15)
    v_mfma_f32_32x32x16_bf16 v[96:111], v[72:75], a[108:111], v[96:111]
    ds_read_b64_tr_b16 v[68:69], v14 offset:8192
    ds_read_b64_tr_b16 v[70:71], v14 offset:8704
    buffer_load_dwordx4 v5, s[8:11], s48 offen offset:0 lds
    v_mfma_f32_32x32x16_bf16 v[112:127], v[76:79], a[108:111], v[112:127]
    ds_read_b64_tr_b16 v[72:73], v13 offset:16384
    ds_read_b64_tr_b16 v[74:75], v13 offset:16896
    ds_read_b128 v[200:203], v244 offset:8192
    v_cvt_pk_bf16_f32 v32, v232, v24
    v_cndmask_b32 v36, 0, v32, s[76:77]
    s_waitcnt lgkmcnt(15)
    v_mfma_f32_32x32x16_bf16 v[128:143], v[80:83], a[108:111], v[128:143]
    ds_read_b64_tr_b16 v[76:77], v14 offset:16384
    ds_read_b64_tr_b16 v[78:79], v14 offset:16896
    buffer_load_dwordx4 v6, s[8:11], s48 offen offset:1024 lds
    v_mfma_f32_32x32x16_bf16 v[144:159], v[84:87], a[108:111], v[144:159]
    ds_read_b64_tr_b16 v[80:81], v13 offset:18432
    ds_read_b64_tr_b16 v[82:83], v13 offset:18944
    v_cndmask_b32 v37, 0, v33, s[76:77]
    v_cndmask_b32 v32, v32, 0, s[76:77]
    v_cndmask_b32 v33, v33, 0, s[76:77]
    v_mul_f32 v29, v29, v233
    s_waitcnt lgkmcnt(12)
    v_mfma_f32_32x32x16_bf16 v[160:175], v[88:91], a[108:111], v[160:175]
    ds_read_b64_tr_b16 v[84:85], v14 offset:18432
    ds_read_b64_tr_b16 v[86:87], v14 offset:18944
    buffer_load_dwordx4 v5, s[12:15], s48 offen offset:2048 lds
    v_mfma_f32_32x32x16_bf16 v[176:191], v[92:95], a[108:111], v[176:191]
    ds_read_b64_tr_b16 v[88:89], v13 offset:10240
    ds_read_b64_tr_b16 v[90:91], v13 offset:10752
    s_waitcnt lgkmcnt(8)
    v_add_f32 v198, v198, v202
    v_cvt_pk_bf16_f32 v38, v198, v198
    v_lshlrev_b32 v24, 16, v38
    v_mfma_f32_32x32x16_bf16 v[96:111], v[64:67], a[112:115], v[96:111]
    ds_read_b64_tr_b16 v[92:93], v14 offset:10240
    ds_read_b64_tr_b16 v[94:95], v14 offset:10752
    buffer_load_dwordx4 v6, s[12:15], s48 offen offset:3072 lds
    s_add_u32 m0, s42, 32768
    v_mfma_f32_32x32x16_bf16 v[112:127], v[68:71], a[112:115], v[112:127]
    ds_read_b64_tr_b16 v[64:65], v13 offset:20480
    ds_read_b64_tr_b16 v[66:67], v13 offset:20992
    s_bfe_u32 s48, s43, 0x3000c
    s_mul_i32 s48, s48, 229376
    v_sub_f32 v24, v198, v24
    v_cvt_pk_bf16_f32 v39, v24, 0
    s_waitcnt lgkmcnt(10)
    v_mfma_f32_32x32x16_bf16 v[128:143], v[72:75], a[112:115], v[128:143]
    ds_read_b64_tr_b16 v[68:69], v14 offset:20480
    ds_read_b64_tr_b16 v[70:71], v14 offset:20992
    buffer_load_dwordx4 v5, s[8:11], s48 offen offset:0 lds
    v_mfma_f32_32x32x16_bf16 v[144:159], v[76:79], a[112:115], v[144:159]
    ds_read_b64_tr_b16 v[72:73], v13 offset:22528
    ds_read_b64_tr_b16 v[74:75], v13 offset:23040
    v_cvt_pk_bf16_f32 v40, v196, v196
    v_lshlrev_b32 v24, 16, v40
    v_sub_f32 v24, v196, v24
    v_cvt_pk_bf16_f32 v41, v24, 0
    s_waitcnt lgkmcnt(10)
    v_mfma_f32_32x32x16_bf16 v[160:175], v[80:83], a[112:115], v[160:175]
    ds_read_b64_tr_b16 v[76:77], v14 offset:22528
    ds_read_b64_tr_b16 v[78:79], v14 offset:23040
    buffer_load_dwordx4 v6, s[8:11], s48 offen offset:1024 lds
    v_mfma_f32_32x32x16_bf16 v[176:191], v[84:87], a[112:115], v[176:191]
    ds_read_b64_tr_b16 v[80:81], v13 offset:12288
    ds_read_b64_tr_b16 v[82:83], v13 offset:12800
    v_cvt_pk_bf16_f32 v42, v200, v200
    v_lshlrev_b32 v24, 16, v42
    v_sub_f32 v24, v200, v24
    v_cvt_pk_bf16_f32 v43, v24, 0
    s_waitcnt lgkmcnt(10)
    v_mfma_f32_32x32x16_bf16 v[96:111], v[88:91], a[116:119], v[96:111]
    ds_read_b64_tr_b16 v[84:85], v14 offset:12288
    ds_read_b64_tr_b16 v[86:87], v14 offset:12800
    buffer_load_dwordx4 v5, s[12:15], s48 offen offset:2048 lds
    v_mfma_f32_32x32x16_bf16 v[112:127], v[92:95], a[116:119], v[112:127]
    ds_read_b64_tr_b16 v[88:89], v13 offset:24576
    ds_read_b64_tr_b16 v[90:91], v13 offset:25088
    v_cvt_pk_bf16_f32 v44, v197, v197
    v_lshlrev_b32 v24, 16, v44
    v_sub_f32 v24, v197, v24
    v_cvt_pk_bf16_f32 v45, v24, 0
    s_waitcnt lgkmcnt(10)
    v_mfma_f32_32x32x16_bf16 v[128:143], v[64:67], a[116:119], v[128:143]
    ds_read_b64_tr_b16 v[92:93], v14 offset:24576
    ds_read_b64_tr_b16 v[94:95], v14 offset:25088
    buffer_load_dwordx4 v6, s[12:15], s48 offen offset:3072 lds
    s_add_u32 m0, s42, 114688
    v_mfma_f32_32x32x16_bf16 v[144:159], v[68:71], a[116:119], v[144:159]
    ds_read_b64_tr_b16 v[64:65], v13 offset:26624
    ds_read_b64_tr_b16 v[66:67], v13 offset:27136
    s_bfe_u32 s49, s44, 0x30004
    s_lshl_b32 s49, s49, 16
    s_add_u32 s49, s49, s59
    v_cvt_pk_bf16_f32 v46, v201, v201
    s_waitcnt lgkmcnt(10)
    v_mfma_f32_32x32x16_bf16 v[160:175], v[72:75], a[116:119], v[160:175]
    ds_read_b64_tr_b16 v[68:69], v14 offset:26624
    ds_read_b64_tr_b16 v[70:71], v14 offset:27136
    buffer_load_dwordx4 v9, s[24:27], s49 offen offset:0 lds
    v_mfma_f32_32x32x16_bf16 v[176:191], v[76:79], a[116:119], v[176:191]
    ds_read_b64_tr_b16 v[72:73], v13 offset:14336
    ds_read_b64_tr_b16 v[74:75], v13 offset:14848
    v_lshlrev_b32 v24, 16, v46
    v_sub_f32 v24, v201, v24
    v_cvt_pk_bf16_f32 v47, v24, 0
    s_waitcnt lgkmcnt(10)
    v_mfma_f32_32x32x16_bf16 v[96:111], v[80:83], a[120:123], v[96:111]
    ds_read_b64_tr_b16 v[76:77], v14 offset:14336
    ds_read_b64_tr_b16 v[78:79], v14 offset:14848
    buffer_load_dwordx4 v10, s[24:27], s49 offen offset:1024 lds
    v_mfma_f32_32x32x16_bf16 v[112:127], v[84:87], a[120:123], v[112:127]
    ds_read_b64_tr_b16 v[80:81], v13 offset:28672
    ds_read_b64_tr_b16 v[82:83], v13 offset:29184
    s_waitcnt lgkmcnt(10)
    v_mfma_f32_32x32x16_bf16 v[128:143], v[88:91], a[120:123], v[128:143]
    ds_read_b64_tr_b16 v[84:85], v14 offset:28672
    ds_read_b64_tr_b16 v[86:87], v14 offset:29184
    buffer_load_dwordx4 v7, s[24:27], s49 offen offset:2048 lds
    v_mfma_f32_32x32x16_bf16 v[144:159], v[92:95], a[120:123], v[144:159]
    ds_read_b64_tr_b16 v[88:89], v13 offset:30720
    ds_read_b64_tr_b16 v[90:91], v13 offset:31232
    s_waitcnt lgkmcnt(10)
    v_mfma_f32_32x32x16_bf16 v[160:175], v[64:67], a[120:123], v[160:175]
    ds_read_b64_tr_b16 v[92:93], v14 offset:30720
    ds_read_b64_tr_b16 v[94:95], v14 offset:31232
    buffer_load_dwordx4 v8, s[24:27], s49 offen offset:3072 lds
    s_barrier
    v_mfma_f32_32x32x16_bf16 v[176:191], v[68:71], a[120:123], v[176:191]
    ds_read_b64_tr_b16 v[64:65], v13 offset:32768
    ds_read_b64_tr_b16 v[66:67], v13 offset:33280
    s_add_u32 m0, s42, 49152
    s_bfe_u32 s48, s43, 0x30010
    s_mul_i32 s48, s48, 229376
    s_waitcnt lgkmcnt(10)
    v_mfma_f32_32x32x16_bf16 v[96:111], v[72:75], a[124:127], v[96:111]
    ds_read_b64_tr_b16 v[68:69], v14 offset:32768
    ds_read_b64_tr_b16 v[70:71], v14 offset:33280
    buffer_load_dwordx4 v5, s[8:11], s48 offen offset:0 lds
    v_mfma_f32_32x32x16_bf16 v[112:127], v[76:79], a[124:127], v[112:127]
    ds_read_b64_tr_b16 v[72:73], v13 offset:34816
    ds_read_b64_tr_b16 v[74:75], v13 offset:35328
    s_waitcnt vmcnt(13)
    ds_read_b64_tr_b16 a[144:145], v19 offset:16384
    ds_read_b64_tr_b16 a[146:147], v19 offset:17408
    ds_read_b64_tr_b16 a[148:149], v20 offset:16384
    s_waitcnt lgkmcnt(13)
    v_mfma_f32_32x32x16_bf16 v[128:143], v[80:83], a[124:127], v[128:143]
    ds_read_b64_tr_b16 v[76:77], v14 offset:34816
    ds_read_b64_tr_b16 v[78:79], v14 offset:35328
    buffer_load_dwordx4 v6, s[8:11], s48 offen offset:1024 lds
    v_mfma_f32_32x32x16_bf16 v[144:159], v[84:87], a[124:127], v[144:159]
    ds_read_b64_tr_b16 v[80:81], v13 offset:36864
    ds_read_b64_tr_b16 v[82:83], v13 offset:37376
    ds_read_b64_tr_b16 a[150:151], v20 offset:17408
    ds_read_b64_tr_b16 a[152:153], v19 offset:18432
    ds_read_b64_tr_b16 a[154:155], v19 offset:19456
    s_waitcnt lgkmcnt(15)
    v_mfma_f32_32x32x16_bf16 v[160:175], v[88:91], a[124:127], v[160:175]
    ds_read_b64_tr_b16 v[84:85], v14 offset:36864
    ds_read_b64_tr_b16 v[86:87], v14 offset:37376
    buffer_load_dwordx4 v5, s[12:15], s48 offen offset:2048 lds
    v_mfma_f32_32x32x16_bf16 v[176:191], v[92:95], a[124:127], v[176:191]
    ds_read_b64_tr_b16 v[88:89], v13 offset:38912
    ds_read_b64_tr_b16 v[90:91], v13 offset:39424
    ds_read_b64_tr_b16 a[156:157], v20 offset:18432
    ds_read_b64_tr_b16 a[158:159], v20 offset:19456
    v_mfma_f32_32x32x16_bf16 v[96:111], v[38:41], v[32:35], v[96:111]
    buffer_load_dwordx4 v6, s[12:15], s48 offen offset:3072 lds
    v_mfma_f32_32x32x16_bf16 v[112:127], v[36:39], v[34:37], v[112:127]
    v_mfma_f32_32x32x16_bf16 v[128:143], v[40:43], v[32:35], v[128:143]
    v_mfma_f32_32x32x16_bf16 v[144:159], v[38:41], v[34:37], v[144:159]
    s_nop 7
    v_mul_f32 v96, v96, v29
    v_mul_f32 v97, v97, v29
    v_mul_f32 v98, v98, v29
    v_mul_f32 v99, v99, v29
    v_mul_f32 v100, v100, v29
    v_mul_f32 v101, v101, v29
    v_mul_f32 v102, v102, v29
    v_mul_f32 v103, v103, v29
    v_cvt_pk_bf16_f32 v96, v96, v97
    v_cvt_pk_bf16_f32 v97, v98, v99
    v_cvt_pk_bf16_f32 v98, v100, v101
    v_cvt_pk_bf16_f32 v99, v102, v103
    v_mfma_f32_32x32x16_bf16 v[160:175], v[42:45], v[32:35], v[160:175]
    buffer_store_dwordx4 v[96:99], v2, s[20:23], s55 offen offset:0 sc1
    v_mul_f32 v104, v104, v29
    v_mul_f32 v105, v105, v29
    v_mul_f32 v106, v106, v29
    v_mul_f32 v107, v107, v29
    v_mul_f32 v108, v108, v29
    v_mul_f32 v109, v109, v29
    v_mul_f32 v110, v110, v29
    v_mfma_f32_32x32x16_bf16 v[176:191], v[40:43], v[34:37], v[176:191]
    v_mul_f32 v111, v111, v29
    v_cvt_pk_bf16_f32 v104, v104, v105
    v_cvt_pk_bf16_f32 v105, v106, v107
    v_cvt_pk_bf16_f32 v106, v108, v109
    v_cvt_pk_bf16_f32 v107, v110, v111
    buffer_store_dwordx4 v[104:107], v2, s[20:23], s55 offen offset:1024 sc1
    v_mul_f32 v112, v112, v29
    v_mul_f32 v113, v113, v29
    v_mfma_f32_32x32x16_bf16 v[192:207], v[44:47], v[32:35], 0
    v_mul_f32 v114, v114, v29
    v_mul_f32 v115, v115, v29
    v_mul_f32 v116, v116, v29
    v_mul_f32 v117, v117, v29
    v_mul_f32 v118, v118, v29
    v_mul_f32 v119, v119, v29
    v_cvt_pk_bf16_f32 v112, v112, v113
    v_cvt_pk_bf16_f32 v113, v114, v115
    v_cvt_pk_bf16_f32 v114, v116, v117
    v_cvt_pk_bf16_f32 v115, v118, v119
    v_mfma_f32_32x32x16_bf16 v[208:223], v[42:45], v[34:37], 0
    buffer_store_dwordx4 v[112:115], v2, s[20:23], s55 offen offset:2048 sc1
    v_mul_f32 v120, v120, v29
    v_mul_f32 v121, v121, v29
    v_mul_f32 v122, v122, v29
    v_mul_f32 v123, v123, v29
    v_mul_f32 v124, v124, v29
    v_mul_f32 v125, v125, v29
    v_mul_f32 v126, v126, v29
    v_mfma_f32_32x32x16_bf16 v[224:239], v[46:49], v[32:35], 0
    v_mul_f32 v127, v127, v29
    v_cvt_pk_bf16_f32 v120, v120, v121
    v_cvt_pk_bf16_f32 v121, v122, v123
    v_cvt_pk_bf16_f32 v122, v124, v125
    v_cvt_pk_bf16_f32 v123, v126, v127
    buffer_store_dwordx4 v[120:123], v2, s[20:23], s55 offen offset:3072 sc1
    v_mfma_f32_32x32x16_bf16 v[240:255], v[44:47], v[34:37], 0
    s_waitcnt lgkmcnt(15)
    v_mfma_f32_32x32x16_bf16 v[192:207], v[64:67], a[0:3], v[192:207]
    ds_read_b64_tr_b16 v[92:93], v14 offset:38912
    ds_read_b64_tr_b16 v[94:95], v14 offset:39424
    v_mfma_f32_32x32x16_bf16 v[208:223], v[68:71], a[0:3], v[208:223]
    ds_read_b64_tr_b16 v[64:65], v13 offset:40960
    ds_read_b64_tr_b16 v[66:67], v13 offset:41472
    s_waitcnt lgkmcnt(15)
    v_mfma_f32_32x32x16_bf16 v[224:239], v[72:75], a[0:3], v[224:239]
    ds_read_b64_tr_b16 v[68:69], v14 offset:40960
    ds_read_b64_tr_b16 v[70:71], v14 offset:41472
    v_mfma_f32_32x32x16_bf16 v[240:255], v[76:79], a[0:3], v[240:255]
    ds_read_b64_tr_b16 v[72:73], v13 offset:43008
    ds_read_b64_tr_b16 v[74:75], v13 offset:43520
    s_waitcnt lgkmcnt(12)
    v_mfma_f32_32x32x16_bf16 v[192:207], v[80:83], a[4:7], v[192:207]
    ds_read_b64_tr_b16 v[76:77], v14 offset:43008
    ds_read_b64_tr_b16 v[78:79], v14 offset:43520
    v_mfma_f32_32x32x16_bf16 v[208:223], v[84:87], a[4:7], v[208:223]
    ds_read_b64_tr_b16 v[80:81], v13 offset:45056
    ds_read_b64_tr_b16 v[82:83], v13 offset:45568
    s_waitcnt lgkmcnt(10)
    v_mfma_f32_32x32x16_bf16 v[224:239], v[88:91], a[4:7], v[224:239]
    ds_read_b64_tr_b16 v[84:85], v14 offset:45056
    ds_read_b64_tr_b16 v[86:87], v14 offset:45568
    v_mfma_f32_32x32x16_bf16 v[240:255], v[92:95], a[4:7], v[240:255]
    ds_read_b64_tr_b16 v[88:89], v13 offset:47104
    ds_read_b64_tr_b16 v[90:91], v13 offset:47616
    s_waitcnt lgkmcnt(10)
    v_mfma_f32_32x32x16_bf16 v[192:207], v[64:67], a[8:11], v[192:207]
    ds_read_b64_tr_b16 v[92:93], v14 offset:47104
    ds_read_b64_tr_b16 v[94:95], v14 offset:47616
    s_barrier
    v_mfma_f32_32x32x16_bf16 v[208:223], v[68:71], a[8:11], v[208:223]
    ds_read_b64_tr_b16 v[64:65], v11 offset:0
    ds_read_b64_tr_b16 v[66:67], v11 offset:512
    s_add_u32 m0, s42, 65536
    s_bfe_u32 s48, s43, 0x30014
    s_mul_i32 s48, s48, 229376
    s_waitcnt lgkmcnt(10)
    v_mfma_f32_32x32x16_bf16 v[224:239], v[72:75], a[8:11], v[224:239]
    ds_read_b64_tr_b16 v[68:69], v12 offset:0
    ds_read_b64_tr_b16 v[70:71], v12 offset:512
    buffer_load_dwordx4 v5, s[8:11], s48 offen offset:0 lds
    v_mfma_f32_32x32x16_bf16 v[240:255], v[76:79], a[8:11], v[240:255]
    ds_read_b64_tr_b16 v[72:73], v11 offset:2048
    ds_read_b64_tr_b16 v[74:75], v11 offset:2560
    s_waitcnt vmcnt(9)
    ds_read_b64_tr_b16 a[160:161], v19 offset:0
    ds_read_b64_tr_b16 a[162:163], v19 offset:1024
    ds_read_b64_tr_b16 a[164:165], v20 offset:0
    s_waitcnt lgkmcnt(13)
    v_mfma_f32_32x32x16_bf16 v[192:207], v[80:83], a[12:15], v[192:207]
    ds_read_b64_tr_b16 v[76:77], v12 offset:2048
    ds_read_b64_tr_b16 v[78:79], v12 offset:2560
    buffer_load_dwordx4 v6, s[8:11], s48 offen offset:1024 lds
    v_mfma_f32_32x32x16_bf16 v[208:223], v[84:87], a[12:15], v[208:223]
    ds_read_b64_tr_b16 v[80:81], v11 offset:4096
    ds_read_b64_tr_b16 v[82:83], v11 offset:4608
    ds_read_b64_tr_b16 a[166:167], v20 offset:1024
    ds_read_b64_tr_b16 a[168:169], v19 offset:2048
    ds_read_b64_tr_b16 a[170:171], v19 offset:3072
    s_waitcnt lgkmcnt(15)
    v_mfma_f32_32x32x16_bf16 v[224:239], v[88:91], a[12:15], v[224:239]
    ds_read_b64_tr_b16 v[84:85], v12 offset:4096
    ds_read_b64_tr_b16 v[86:87], v12 offset:4608
    buffer_load_dwordx4 v5, s[12:15], s48 offen offset:2048 lds
    v_mfma_f32_32x32x16_bf16 v[240:255], v[92:95], a[12:15], v[240:255]
    ds_read_b64_tr_b16 v[88:89], v11 offset:6144
    ds_read_b64_tr_b16 v[90:91], v11 offset:6656
    ds_read_b64_tr_b16 a[172:173], v20 offset:2048
    ds_read_b64_tr_b16 a[174:175], v20 offset:3072
    s_waitcnt lgkmcnt(15)
    v_mfma_f32_32x32x16_bf16 v[192:207], v[64:67], a[16:19], v[192:207]
    ds_read_b64_tr_b16 v[92:93], v12 offset:6144
    ds_read_b64_tr_b16 v[94:95], v12 offset:6656
    buffer_load_dwordx4 v6, s[12:15], s48 offen offset:3072 lds
    s_add_u32 m0, s42, 81920
    v_mfma_f32_32x32x16_bf16 v[208:223], v[68:71], a[16:19], v[208:223]
    ds_read_b64_tr_b16 v[64:65], v11 offset:8192
    ds_read_b64_tr_b16 v[66:67], v11 offset:8704
    s_bfe_u32 s48, s43, 0x30018
    s_mul_i32 s48, s48, 229376
    s_waitcnt lgkmcnt(15)
    v_mfma_f32_32x32x16_bf16 v[224:239], v[72:75], a[16:19], v[224:239]
    ds_read_b64_tr_b16 v[68:69], v12 offset:8192
    ds_read_b64_tr_b16 v[70:71], v12 offset:8704
    buffer_load_dwordx4 v5, s[8:11], s48 offen offset:0 lds
    v_mfma_f32_32x32x16_bf16 v[240:255], v[76:79], a[16:19], v[240:255]
    ds_read_b64_tr_b16 v[72:73], v11 offset:10240
    ds_read_b64_tr_b16 v[74:75], v11 offset:10752
    s_waitcnt vmcnt(5)
    s_mov_b64 exec, 1
    buffer_store_dword v21, off, s[20:23], s58 sc1
    s_mov_b64 exec, -1
    s_add_u32 s58, s58, 262144
    s_waitcnt lgkmcnt(12)
    v_mfma_f32_32x32x16_bf16 v[192:207], v[80:83], a[20:23], v[192:207]
    ds_read_b64_tr_b16 v[76:77], v12 offset:10240
    ds_read_b64_tr_b16 v[78:79], v12 offset:10752
    buffer_load_dwordx4 v6, s[8:11], s48 offen offset:1024 lds
    v_mfma_f32_32x32x16_bf16 v[208:223], v[84:87], a[20:23], v[208:223]
    ds_read_b64_tr_b16 v[80:81], v11 offset:12288
    ds_read_b64_tr_b16 v[82:83], v11 offset:12800
    s_waitcnt lgkmcnt(10)
    v_mfma_f32_32x32x16_bf16 v[224:239], v[88:91], a[20:23], v[224:239]
    ds_read_b64_tr_b16 v[84:85], v12 offset:12288
    ds_read_b64_tr_b16 v[86:87], v12 offset:12800
    buffer_load_dwordx4 v5, s[12:15], s48 offen offset:2048 lds
    v_mfma_f32_32x32x16_bf16 v[240:255], v[92:95], a[20:23], v[240:255]
    ds_read_b64_tr_b16 v[88:89], v11 offset:14336
    ds_read_b64_tr_b16 v[90:91], v11 offset:14848
    s_lshr_b32 s70, s2, 3
    s_lshl2_add_u32 s70, s70, s40
    v_lshlrev_b32 v22, 9, v1
    s_mul_i32 s71, s70, 14336
    s_waitcnt lgkmcnt(10)
    v_mfma_f32_32x32x16_bf16 v[192:207], v[64:67], a[24:27], v[192:207]
    ds_read_b64_tr_b16 v[92:93], v12 offset:14336
    ds_read_b64_tr_b16 v[94:95], v12 offset:14848
    buffer_load_dwordx4 v6, s[12:15], s48 offen offset:3072 lds
    s_barrier
    v_mfma_f32_32x32x16_bf16 v[208:223], v[68:71], a[24:27], v[208:223]
    ds_read_b64_tr_b16 v[64:65], v11 offset:16384
    ds_read_b64_tr_b16 v[66:67], v11 offset:16896
    s_add_u32 m0, s42, 98304
    s_bfe_u32 s48, s43, 0x3001c
    s_mul_i32 s48, s48, 229376
    s_waitcnt lgkmcnt(10)
    v_mfma_f32_32x32x16_bf16 v[224:239], v[72:75], a[24:27], v[224:239]
    ds_read_b64_tr_b16 v[68:69], v12 offset:16384
    ds_read_b64_tr_b16 v[70:71], v12 offset:16896
    buffer_load_dwordx4 v5, s[8:11], s48 offen offset:0 lds
    v_mfma_f32_32x32x16_bf16 v[240:255], v[76:79], a[24:27], v[240:255]
    ds_read_b64_tr_b16 v[72:73], v11 offset:18432
    ds_read_b64_tr_b16 v[74:75], v11 offset:18944
    s_mov_b64 exec, 0xfffffff
    buffer_load_dword a248, v22, s[24:27], s71 offen offset:384
    s_mov_b64 exec, -1
    s_waitcnt lgkmcnt(10)
    v_mfma_f32_32x32x16_bf16 v[192:207], v[80:83], a[28:31], v[192:207]
    ds_read_b64_tr_b16 v[76:77], v12 offset:18432
    ds_read_b64_tr_b16 v[78:79], v12 offset:18944
    buffer_load_dwordx4 v6, s[8:11], s48 offen offset:1024 lds
    v_mfma_f32_32x32x16_bf16 v[208:223], v[84:87], a[28:31], v[208:223]
    ds_read_b64_tr_b16 v[80:81], v11 offset:20480
    ds_read_b64_tr_b16 v[82:83], v11 offset:20992
    s_lshl_b32 s70, s70, 12
    s_mov_b64 exec, 0xff
    buffer_load_dword a249, v22, s[28:31], s70 offen offset:384
    s_mov_b64 exec, -1
    s_waitcnt lgkmcnt(10)
    v_mfma_f32_32x32x16_bf16 v[224:239], v[88:91], a[28:31], v[224:239]
    ds_read_b64_tr_b16 v[84:85], v12 offset:20480
    ds_read_b64_tr_b16 v[86:87], v12 offset:20992
    buffer_load_dwordx4 v5, s[12:15], s48 offen offset:2048 lds
    v_mfma_f32_32x32x16_bf16 v[240:255], v[92:95], a[28:31], v[240:255]
    ds_read_b64_tr_b16 v[88:89], v11 offset:22528
    ds_read_b64_tr_b16 v[90:91], v11 offset:23040
    s_waitcnt lgkmcnt(10)
    v_mfma_f32_32x32x16_bf16 v[192:207], v[64:67], a[32:35], v[192:207]
    ds_read_b64_tr_b16 v[92:93], v12 offset:22528
    ds_read_b64_tr_b16 v[94:95], v12 offset:23040
    buffer_load_dwordx4 v6, s[12:15], s48 offen offset:3072 lds
    s_add_u32 m0, s42, 131072
    v_mfma_f32_32x32x16_bf16 v[208:223], v[68:71], a[32:35], v[208:223]
    ds_read_b64_tr_b16 v[64:65], v11 offset:24576
    ds_read_b64_tr_b16 v[66:67], v11 offset:25088
    s_add_u32 s49, s49, 32768
    s_waitcnt lgkmcnt(10)
    v_mfma_f32_32x32x16_bf16 v[224:239], v[72:75], a[32:35], v[224:239]
    ds_read_b64_tr_b16 v[68:69], v12 offset:24576
    ds_read_b64_tr_b16 v[70:71], v12 offset:25088
    buffer_load_dwordx4 v9, s[24:27], s49 offen offset:0 lds
    v_mfma_f32_32x32x16_bf16 v[240:255], v[76:79], a[32:35], v[240:255]
    ds_read_b64_tr_b16 v[72:73], v11 offset:26624
    ds_read_b64_tr_b16 v[74:75], v11 offset:27136
    s_waitcnt lgkmcnt(10)
    v_mfma_f32_32x32x16_bf16 v[192:207], v[80:83], a[36:39], v[192:207]
    ds_read_b64_tr_b16 v[76:77], v12 offset:26624
    ds_read_b64_tr_b16 v[78:79], v12 offset:27136
    buffer_load_dwordx4 v10, s[24:27], s49 offen offset:1024 lds
    v_mfma_f32_32x32x16_bf16 v[208:223], v[84:87], a[36:39], v[208:223]
    ds_read_b64_tr_b16 v[80:81], v11 offset:28672
    ds_read_b64_tr_b16 v[82:83], v11 offset:29184
    s_waitcnt lgkmcnt(10)
    v_mfma_f32_32x32x16_bf16 v[224:239], v[88:91], a[36:39], v[224:239]
    ds_read_b64_tr_b16 v[84:85], v12 offset:28672
    ds_read_b64_tr_b16 v[86:87], v12 offset:29184
    buffer_load_dwordx4 v7, s[24:27], s49 offen offset:2048 lds
    v_mfma_f32_32x32x16_bf16 v[240:255], v[92:95], a[36:39], v[240:255]
    ds_read_b64_tr_b16 v[88:89], v11 offset:30720
    ds_read_b64_tr_b16 v[90:91], v11 offset:31232
    s_waitcnt lgkmcnt(10)
    v_mfma_f32_32x32x16_bf16 v[192:207], v[64:67], a[40:43], v[192:207]
    ds_read_b64_tr_b16 v[92:93], v12 offset:30720
    ds_read_b64_tr_b16 v[94:95], v12 offset:31232
    buffer_load_dwordx4 v8, s[24:27], s49 offen offset:3072 lds
    s_barrier
    v_mfma_f32_32x32x16_bf16 v[208:223], v[68:71], a[40:43], v[208:223]
    ds_read_b64_tr_b16 v[64:65], v11 offset:32768
    ds_read_b64_tr_b16 v[66:67], v11 offset:33280
    s_add_u32 m0, s42, 147456
    s_bfe_u32 s49, s44, 0x30008
    s_lshl_b32 s49, s49, 16
    s_add_u32 s49, s49, s59
    v_mul_f32 v128, v128, v160
    v_mul_f32 v129, v129, v161
    s_waitcnt lgkmcnt(10)
    v_mfma_f32_32x32x16_bf16 v[224:239], v[72:75], a[40:43], v[224:239]
    ds_read_b64_tr_b16 v[68:69], v12 offset:32768
    ds_read_b64_tr_b16 v[70:71], v12 offset:33280
    buffer_load_dwordx4 v9, s[24:27], s49 offen offset:0 lds
    v_mul_f32 v130, v130, v162
    v_mfma_f32_32x32x16_bf16 v[240:255], v[76:79], a[40:43], v[240:255]
    ds_read_b64_tr_b16 v[72:73], v11 offset:34816
    ds_read_b64_tr_b16 v[74:75], v11 offset:35328
    v_mul_f32 v131, v131, v163
    v_mul_f32 v132, v132, v164
    v_mul_f32 v133, v133, v165
    v_mul_f32 v134, v134, v166
    v_mul_f32 v135, v135, v167
    v_cvt_pk_bf16_f32 v128, v128, v129
    s_waitcnt lgkmcnt(10)
    v_mfma_f32_32x32x16_bf16 v[192:207], v[80:83], a[44:47], v[192:207]
    ds_read_b64_tr_b16 v[76:77], v12 offset:34816
    ds_read_b64_tr_b16 v[78:79], v12 offset:35328
    buffer_load_dwordx4 v10, s[24:27], s49 offen offset:1024 lds
    v_cvt_pk_bf16_f32 v129, v130, v131
    v_cvt_pk_bf16_f32 v130, v132, v133
    v_mfma_f32_32x32x16_bf16 v[208:223], v[84:87], a[44:47], v[208:223]
    ds_read_b64_tr_b16 v[80:81], v11 offset:36864
    ds_read_b64_tr_b16 v[82:83], v11 offset:37376
    v_cvt_pk_bf16_f32 v131, v134, v135
    s_waitcnt lgkmcnt(10)
    s_branch parallel_sum__sliding_block__glu_gated_bilinear__prompt_kernel_ws2
parallel_sum__sliding_block__glu_gated_bilinear__prompt_kernel_w2G2_0:
    s_branch parallel_sum__sliding_block__glu_gated_bilinear__prompt_kernel_wr2G
parallel_sum__sliding_block__glu_gated_bilinear__prompt_kernel_ws2:
    v_mfma_f32_32x32x16_bf16 v[224:239], v[88:91], a[44:47], v[224:239]
    ds_read_b64_tr_b16 v[84:85], v12 offset:36864
    ds_read_b64_tr_b16 v[86:87], v12 offset:37376
    buffer_load_dwordx4 v7, s[24:27], s49 offen offset:2048 lds
    v_mfma_f32_32x32x16_bf16 v[240:255], v[92:95], a[44:47], v[240:255]
    ds_read_b64_tr_b16 v[88:89], v11 offset:38912
    ds_read_b64_tr_b16 v[90:91], v11 offset:39424
    buffer_store_dwordx4 v[128:131], v2, s[20:23], s57 offen offset:0 sc1
    s_waitcnt lgkmcnt(10)
    v_mfma_f32_32x32x16_bf16 v[192:207], v[64:67], a[48:51], v[192:207]
    ds_read_b64_tr_b16 v[92:93], v12 offset:38912
    ds_read_b64_tr_b16 v[94:95], v12 offset:39424
    buffer_load_dwordx4 v8, s[24:27], s49 offen offset:3072 lds
    s_add_u32 m0, s42, 114688
    v_mul_f32 v136, v136, v168
    v_mfma_f32_32x32x16_bf16 v[208:223], v[68:71], a[48:51], v[208:223]
    ds_read_b64_tr_b16 v[64:65], v11 offset:40960
    ds_read_b64_tr_b16 v[66:67], v11 offset:41472
    s_add_u32 s49, s49, 32768
    v_mul_f32 v137, v137, v169
    v_mul_f32 v138, v138, v170
    v_mul_f32 v139, v139, v171
    v_mul_f32 v140, v140, v172
    v_mul_f32 v141, v141, v173
    s_waitcnt lgkmcnt(10)
    v_mfma_f32_32x32x16_bf16 v[224:239], v[72:75], a[48:51], v[224:239]
    ds_read_b64_tr_b16 v[68:69], v12 offset:40960
    ds_read_b64_tr_b16 v[70:71], v12 offset:41472
    buffer_load_dwordx4 v9, s[24:27], s49 offen offset:0 lds
    v_mul_f32 v142, v142, v174
    v_mfma_f32_32x32x16_bf16 v[240:255], v[76:79], a[48:51], v[240:255]
    ds_read_b64_tr_b16 v[72:73], v11 offset:43008
    ds_read_b64_tr_b16 v[74:75], v11 offset:43520
    v_mul_f32 v143, v143, v175
    v_cvt_pk_bf16_f32 v136, v136, v137
    v_cvt_pk_bf16_f32 v137, v138, v139
    v_cvt_pk_bf16_f32 v138, v140, v141
    v_cvt_pk_bf16_f32 v139, v142, v143
    s_waitcnt lgkmcnt(10)
    v_mfma_f32_32x32x16_bf16 v[192:207], v[80:83], a[52:55], v[192:207]
    ds_read_b64_tr_b16 v[76:77], v12 offset:43008
    ds_read_b64_tr_b16 v[78:79], v12 offset:43520
    buffer_load_dwordx4 v10, s[24:27], s49 offen offset:1024 lds
    v_mfma_f32_32x32x16_bf16 v[208:223], v[84:87], a[52:55], v[208:223]
    ds_read_b64_tr_b16 v[80:81], v11 offset:45056
    ds_read_b64_tr_b16 v[82:83], v11 offset:45568
    buffer_store_dwordx4 v[136:139], v2, s[20:23], s57 offen offset:1024 sc1
    s_waitcnt lgkmcnt(10)
    v_mfma_f32_32x32x16_bf16 v[224:239], v[88:91], a[52:55], v[224:239]
    ds_read_b64_tr_b16 v[84:85], v12 offset:45056
    ds_read_b64_tr_b16 v[86:87], v12 offset:45568
    buffer_load_dwordx4 v7, s[24:27], s49 offen offset:2048 lds
    v_mul_f32 v144, v144, v176
    v_mul_f32 v145, v145, v177
    v_mfma_f32_32x32x16_bf16 v[240:255], v[92:95], a[52:55], v[240:255]
    ds_read_b64_tr_b16 v[88:89], v11 offset:47104
    ds_read_b64_tr_b16 v[90:91], v11 offset:47616
    v_mul_f32 v146, v146, v178
    v_mul_f32 v147, v147, v179
    v_mul_f32 v148, v148, v180
    v_mul_f32 v149, v149, v181
    v_mul_f32 v150, v150, v182
    v_mul_f32 v151, v151, v183
    s_waitcnt lgkmcnt(10)
    v_mfma_f32_32x32x16_bf16 v[192:207], v[64:67], a[56:59], v[192:207]
    ds_read_b64_tr_b16 v[92:93], v12 offset:47104
    ds_read_b64_tr_b16 v[94:95], v12 offset:47616
    s_waitcnt vmcnt(9)
    ds_read_b64_tr_b16 a[176:177], v19 offset:16384
    v_cvt_pk_bf16_f32 v144, v144, v145
    s_barrier
    v_mfma_f32_32x32x16_bf16 v[208:223], v[68:71], a[56:59], v[208:223]
    ds_read_b64_tr_b16 v[64:65], v11 offset:49152
    ds_read_b64_tr_b16 v[66:67], v11 offset:49664
    ds_read_b64_tr_b16 a[178:179], v19 offset:17408
    ds_read_b64_tr_b16 a[180:181], v20 offset:16384
    ds_read_b64_tr_b16 a[182:183], v20 offset:17408
    v_cvt_pk_bf16_f32 v145, v146, v147
    v_cvt_pk_bf16_f32 v146, v148, v149
    v_cvt_pk_bf16_f32 v147, v150, v151
    s_waitcnt lgkmcnt(14)
    v_mfma_f32_32x32x16_bf16 v[224:239], v[72:75], a[56:59], v[224:239]
    ds_read_b64_tr_b16 v[68:69], v12 offset:49152
    ds_read_b64_tr_b16 v[70:71], v12 offset:49664
    ds_read_b64_tr_b16 a[184:185], v19 offset:18432
    ds_read_b64_tr_b16 a[186:187], v19 offset:19456
    v_mfma_f32_32x32x16_bf16 v[240:255], v[76:79], a[56:59], v[240:255]
    ds_read_b64_tr_b16 v[72:73], v11 offset:51200
    ds_read_b64_tr_b16 v[74:75], v11 offset:51712
    ds_read_b64_tr_b16 a[188:189], v20 offset:18432
    ds_read_b64_tr_b16 a[190:191], v20 offset:19456
    buffer_load_dwordx4 v8, s[24:27], s49 offen offset:3072 lds
    s_waitcnt lgkmcnt(15)
    v_mfma_f32_32x32x16_bf16 v[192:207], v[80:83], a[60:63], v[192:207]
    ds_read_b64_tr_b16 v[76:77], v12 offset:51200
    ds_read_b64_tr_b16 v[78:79], v12 offset:51712
    buffer_store_dwordx4 v[144:147], v2, s[20:23], s57 offen offset:2048 sc1
    v_mfma_f32_32x32x16_bf16 v[208:223], v[84:87], a[60:63], v[208:223]
    ds_read_b64_tr_b16 v[80:81], v11 offset:53248
    ds_read_b64_tr_b16 v[82:83], v11 offset:53760
    v_mul_f32 v152, v152, v184
    v_mul_f32 v153, v153, v185
    v_mul_f32 v154, v154, v186
    v_mul_f32 v155, v155, v187
    v_mul_f32 v156, v156, v188
    v_mul_f32 v157, v157, v189
    s_waitcnt lgkmcnt(15)
    v_mfma_f32_32x32x16_bf16 v[224:239], v[88:91], a[60:63], v[224:239]
    ds_read_b64_tr_b16 v[84:85], v12 offset:53248
    ds_read_b64_tr_b16 v[86:87], v12 offset:53760
    s_add_u32 m0, s42, 131072
    s_bfe_u32 s49, s44, 0x3000c
    s_lshl_b32 s49, s49, 16
    s_add_u32 s49, s49, s59
    v_mul_f32 v158, v158, v190
    v_mfma_f32_32x32x16_bf16 v[240:255], v[92:95], a[60:63], v[240:255]
    ds_read_b64_tr_b16 v[88:89], v11 offset:55296
    ds_read_b64_tr_b16 v[90:91], v11 offset:55808
    s_waitcnt lgkmcnt(8)
    buffer_load_dwordx4 v9, s[24:27], s49 offen offset:0 lds
    v_mul_f32 v159, v159, v191
    v_cvt_pk_bf16_f32 v152, v152, v153
    v_mfma_f32_32x32x16_bf16 v[192:207], v[64:67], a[64:67], v[192:207]
    ds_read_b64_tr_b16 v[92:93], v12 offset:55296
    ds_read_b64_tr_b16 v[94:95], v12 offset:55808
    v_cvt_pk_bf16_f32 v153, v154, v155
    v_cvt_pk_bf16_f32 v154, v156, v157
    v_cvt_pk_bf16_f32 v155, v158, v159
    s_mov_b32 s16, s20
    s_mov_b32 s17, s21
    v_mfma_f32_32x32x16_bf16 v[208:223], v[68:71], a[64:67], v[208:223]
    ds_read_b64_tr_b16 v[64:65], v11 offset:57344
    ds_read_b64_tr_b16 v[66:67], v11 offset:57856
    buffer_load_dwordx4 v10, s[24:27], s49 offen offset:1024 lds
    s_mov_b32 s18, 20971520
    s_waitcnt lgkmcnt(10)
    v_mfma_f32_32x32x16_bf16 v[224:239], v[72:75], a[64:67], v[224:239]
    ds_read_b64_tr_b16 v[68:69], v12 offset:57344
    ds_read_b64_tr_b16 v[70:71], v12 offset:57856
    buffer_store_dwordx4 v[152:155], v2, s[20:23], s57 offen offset:3072 sc1
    v_mfma_f32_32x32x16_bf16 v[240:255], v[76:79], a[64:67], v[240:255]
    ds_read_b64_tr_b16 v[72:73], v11 offset:59392
    ds_read_b64_tr_b16 v[74:75], v11 offset:59904
    buffer_load_dwordx4 v7, s[24:27], s49 offen offset:2048 lds
    s_waitcnt lgkmcnt(10)
    v_mfma_f32_32x32x16_bf16 v[192:207], v[80:83], a[68:71], v[192:207]
    ds_read_b64_tr_b16 v[76:77], v12 offset:59392
    ds_read_b64_tr_b16 v[78:79], v12 offset:59904
    s_waitcnt vmcnt(10)
    ds_read_b64_tr_b16 a[192:193], v19 offset:32768
    ds_read_b64_tr_b16 a[194:195], v19 offset:33792
    s_add_u32 s57, s57, 12288
    v_mfma_f32_32x32x16_bf16 v[208:223], v[84:87], a[68:71], v[208:223]
    ds_read_b64_tr_b16 v[80:81], v11 offset:61440
    ds_read_b64_tr_b16 v[82:83], v11 offset:61952
    ds_read_b64_tr_b16 a[196:197], v20 offset:32768
    ds_read_b64_tr_b16 a[198:199], v20 offset:33792
    ds_read_b64_tr_b16 a[200:201], v19 offset:34816
    buffer_load_dword v29, v28, s[20:23], s60 offen sc1
    s_waitcnt lgkmcnt(15)
    v_mfma_f32_32x32x16_bf16 v[224:239], v[88:91], a[68:71], v[224:239]
    ds_read_b64_tr_b16 v[84:85], v12 offset:61440
    ds_read_b64_tr_b16 v[86:87], v12 offset:61952
    ds_read_b64_tr_b16 a[202:203], v19 offset:35840
    ds_read_b64_tr_b16 a[204:205], v20 offset:34816
    ds_read_b64_tr_b16 a[206:207], v20 offset:35840
    v_mfma_f32_32x32x16_bf16 v[240:255], v[92:95], a[68:71], v[240:255]
    ds_read_b64_tr_b16 v[88:89], v11 offset:63488
    ds_read_b64_tr_b16 v[90:91], v11 offset:64000
    buffer_load_dwordx4 v8, s[24:27], s49 offen offset:3072 lds
    s_add_u32 m0, s42, 0
    s_add_u32 s49, s49, 32768
    s_waitcnt lgkmcnt(15)
    v_mfma_f32_32x32x16_bf16 v[192:207], v[64:67], a[72:75], v[192:207]
    ds_read_b64_tr_b16 v[92:93], v12 offset:63488
    ds_read_b64_tr_b16 v[94:95], v12 offset:64000
    s_mov_b32 s50, 0x3f803f80
    s_mov_b32 s51, 0x3f803f80
    s_barrier
    v_mfma_f32_32x32x16_bf16 v[208:223], v[68:71], a[72:75], v[208:223]
    ds_read_b64_tr_b16 v[64:65], v13 offset:0
    ds_read_b64_tr_b16 v[66:67], v13 offset:512
    buffer_load_dwordx4 v9, s[24:27], s49 offen offset:0 lds
    v_mov_b64 v[180:181], s[50:51]
    s_waitcnt lgkmcnt(15)
    v_mfma_f32_32x32x16_bf16 v[224:239], v[72:75], a[72:75], v[224:239]
    ds_read_b64_tr_b16 v[68:69], v14 offset:0
    ds_read_b64_tr_b16 v[70:71], v14 offset:512
    v_mov_b64 v[182:183], s[50:51]
    v_mov_b64 v[172:173], s[50:51]
    v_mov_b64 v[174:175], s[50:51]
    v_mfma_f32_32x32x16_bf16 v[240:255], v[76:79], a[72:75], v[240:255]
    ds_read_b64_tr_b16 v[72:73], v13 offset:2048
    ds_read_b64_tr_b16 v[74:75], v13 offset:2560
    buffer_load_dwordx4 v10, s[24:27], s49 offen offset:1024 lds
    s_waitcnt lgkmcnt(13)
    v_mfma_f32_32x32x16_bf16 v[192:207], v[80:83], a[76:79], v[192:207]
    ds_read_b64_tr_b16 v[76:77], v14 offset:2048
    ds_read_b64_tr_b16 v[78:79], v14 offset:2560
    s_cmp_le_u32 s68, 0
    s_cselect_b64 s[50:51], 0, s[50:51]
    v_mov_b64 v[164:165], s[50:51]
    v_mfma_f32_32x32x16_bf16 v[208:223], v[84:87], a[76:79], v[208:223]
    ds_read_b64_tr_b16 v[80:81], v13 offset:4096
    ds_read_b64_tr_b16 v[82:83], v13 offset:4608
    buffer_load_dwordx4 v7, s[24:27], s49 offen offset:2048 lds
    v_mov_b64 v[166:167], s[50:51]
    s_waitcnt lgkmcnt(10)
    v_mfma_f32_32x32x16_bf16 v[224:239], v[88:91], a[76:79], v[224:239]
    ds_read_b64_tr_b16 v[84:85], v14 offset:4096
    ds_read_b64_tr_b16 v[86:87], v14 offset:4608
    s_waitcnt vmcnt(4)
    v_cmp_eq_u32 s[76:77], s45, v29
    s_andn2_b64 s[76:77], s[78:79], s[76:77]
    s_cbranch_scc1 parallel_sum__sliding_block__glu_gated_bilinear__prompt_kernel_p1G
parallel_sum__sliding_block__glu_gated_bilinear__prompt_kernel_p1Gr:
    v_mfma_f32_32x32x16_bf16 v[240:255], v[92:95], a[76:79], v[240:255]
    ds_read_b64_tr_b16 v[88:89], v13 offset:6144
    ds_read_b64_tr_b16 v[90:91], v13 offset:6656
    buffer_load_dwordx4 v8, s[24:27], s49 offen offset:3072 lds
    v_mov_b64 v[156:157], s[50:51]
    s_waitcnt lgkmcnt(10)
    v_mfma_f32_32x32x16_bf16 v[192:207], v[64:67], a[80:83], v[192:207]
    ds_read_b64_tr_b16 v[92:93], v14 offset:6144
    ds_read_b64_tr_b16 v[94:95], v14 offset:6656
    v_mov_b64 v[158:159], s[50:51]
    s_cmp_le_u32 s68, 1
    s_cselect_b64 s[50:51], 0, s[50:51]
    v_mfma_f32_32x32x16_bf16 v[208:223], v[68:71], a[80:83], v[208:223]
    ds_read_b64_tr_b16 v[64:65], v13 offset:8192
    ds_read_b64_tr_b16 v[66:67], v13 offset:8704
    buffer_load_dwordx4 v[100:103], v2, s[16:19], s61 offen sc1
    v_mov_b64 v[148:149], s[50:51]
    s_waitcnt lgkmcnt(10)
    v_mfma_f32_32x32x16_bf16 v[224:239], v[72:75], a[80:83], v[224:239]
    ds_read_b64_tr_b16 v[68:69], v14 offset:8192
    ds_read_b64_tr_b16 v[70:71], v14 offset:8704
    v_mov_b64 v[150:151], s[50:51]
    v_mov_b64 v[140:141], s[50:51]
    v_mov_b64 v[142:143], s[50:51]
    v_mfma_f32_32x32x16_bf16 v[240:255], v[76:79], a[80:83], v[240:255]
    ds_read_b64_tr_b16 v[72:73], v13 offset:10240
    ds_read_b64_tr_b16 v[74:75], v13 offset:10752
    buffer_load_dwordx4 a[36:39], v26, s[16:19], s61 offen sc1
    s_waitcnt lgkmcnt(10)
    v_mfma_f32_32x32x16_bf16 v[192:207], v[80:83], a[84:87], v[192:207]
    ds_read_b64_tr_b16 v[76:77], v14 offset:10240
    ds_read_b64_tr_b16 v[78:79], v14 offset:10752
    ds_read_b64_tr_b16 a[208:209], v19 offset:0
    ds_read_b64_tr_b16 a[210:211], v19 offset:1024
    v_mfma_f32_32x32x16_bf16 v[208:223], v[84:87], a[84:87], v[208:223]
    ds_read_b64_tr_b16 v[80:81], v13 offset:12288
    ds_read_b64_tr_b16 v[82:83], v13 offset:12800
    ds_read_b64_tr_b16 a[212:213], v20 offset:0
    ds_read_b64_tr_b16 a[214:215], v20 offset:1024
    ds_read_b64_tr_b16 a[216:217], v19 offset:2048
    s_waitcnt lgkmcnt(15)
    v_mfma_f32_32x32x16_bf16 v[224:239], v[88:91], a[84:87], v[224:239]
    ds_read_b64_tr_b16 v[84:85], v14 offset:12288
    ds_read_b64_tr_b16 v[86:87], v14 offset:12800
    ds_read_b64_tr_b16 a[218:219], v19 offset:3072
    ds_read_b64_tr_b16 a[220:221], v20 offset:2048
    ds_read_b64_tr_b16 a[222:223], v20 offset:3072
    v_mfma_f32_32x32x16_bf16 v[240:255], v[92:95], a[84:87], v[240:255]
    ds_read_b64_tr_b16 v[88:89], v13 offset:14336
    ds_read_b64_tr_b16 v[90:91], v13 offset:14848
    buffer_load_dwordx4 v[176:179], v27, s[16:19], s61 offen sc1
    s_waitcnt lgkmcnt(15)
    v_mfma_f32_32x32x16_bf16 v[192:207], v[64:67], a[88:91], v[192:207]
    ds_read_b64_tr_b16 v[92:93], v14 offset:14336
    ds_read_b64_tr_b16 v[94:95], v14 offset:14848
    s_cmp_le_u32 s68, 2
    s_cselect_b64 s[50:51], 0, s[50:51]
    s_barrier
    v_mfma_f32_32x32x16_bf16 v[208:223], v[68:71], a[88:91], v[208:223]
    ds_read_b64_tr_b16 v[64:65], v13 offset:16384
    ds_read_b64_tr_b16 v[66:67], v13 offset:16896
    s_sub_u32 s61, s61, 32768
    buffer_load_dwordx4 v[96:99], v2, s[16:19], s61 offen sc1
    s_waitcnt lgkmcnt(15)
    v_mfma_f32_32x32x16_bf16 v[224:239], v[72:75], a[88:91], v[224:239]
    ds_read_b64_tr_b16 v[68:69], v14 offset:16384
    ds_read_b64_tr_b16 v[70:71], v14 offset:16896
    v_mov_b64 v[132:133], s[50:51]
    v_mov_b64 v[134:135], s[50:51]
    v_mov_b64 v[124:125], s[50:51]
    v_mfma_f32_32x32x16_bf16 v[240:255], v[76:79], a[88:91], v[240:255]
    ds_read_b64_tr_b16 v[72:73], v13 offset:18432
    ds_read_b64_tr_b16 v[74:75], v13 offset:18944
    buffer_load_dwordx4 a[32:35], v26, s[16:19], s61 offen sc1
    v_mov_b64 v[126:127], s[50:51]
    s_waitcnt lgkmcnt(13)
    v_mfma_f32_32x32x16_bf16 v[192:207], v[80:83], a[92:95], v[192:207]
    ds_read_b64_tr_b16 v[76:77], v14 offset:18432
    ds_read_b64_tr_b16 v[78:79], v14 offset:18944
    s_waitcnt vmcnt(9)
    ds_read_b64_tr_b16 a[224:225], v19 offset:16384
    ds_read_b64_tr_b16 a[226:227], v19 offset:17408
    v_mfma_f32_32x32x16_bf16 v[208:223], v[84:87], a[92:95], v[208:223]
    ds_read_b64_tr_b16 v[80:81], v13 offset:20480
    ds_read_b64_tr_b16 v[82:83], v13 offset:20992
    ds_read_b64_tr_b16 a[228:229], v20 offset:16384
    ds_read_b64_tr_b16 a[230:231], v20 offset:17408
    ds_read_b64_tr_b16 a[232:233], v19 offset:18432
    s_waitcnt lgkmcnt(15)
    v_mfma_f32_32x32x16_bf16 v[224:239], v[88:91], a[92:95], v[224:239]
    ds_read_b64_tr_b16 v[84:85], v14 offset:20480
    ds_read_b64_tr_b16 v[86:87], v14 offset:20992
    ds_read_b64_tr_b16 a[234:235], v19 offset:19456
    ds_read_b64_tr_b16 a[236:237], v20 offset:18432
    ds_read_b64_tr_b16 a[238:239], v20 offset:19456
    v_mfma_f32_32x32x16_bf16 v[240:255], v[92:95], a[92:95], v[240:255]
    ds_read_b64_tr_b16 v[88:89], v13 offset:22528
    ds_read_b64_tr_b16 v[90:91], v13 offset:23040
    buffer_load_dwordx4 v[168:171], v27, s[16:19], s61 offen sc1
    s_waitcnt lgkmcnt(15)
    v_mfma_f32_32x32x16_bf16 v[192:207], v[64:67], a[96:99], v[192:207]
    ds_read_b64_tr_b16 v[92:93], v14 offset:22528
    ds_read_b64_tr_b16 v[94:95], v14 offset:23040
    s_cmp_le_u32 s68, 3
    s_cselect_b64 s[50:51], 0, s[50:51]
    v_mov_b64 v[116:117], s[50:51]
    v_mfma_f32_32x32x16_bf16 v[208:223], v[68:71], a[96:99], v[208:223]
    ds_read_b64_tr_b16 v[64:65], v13 offset:24576
    ds_read_b64_tr_b16 v[66:67], v13 offset:25088
    s_sub_u32 s61, s61, 32768
    s_cmp_le_u32 s68, 0
    s_cselect_b32 s18, 0, s18
    buffer_load_dwordx4 a[28:31], v26, s[16:19], s61 offen sc1
    s_waitcnt lgkmcnt(15)
    v_mfma_f32_32x32x16_bf16 v[224:239], v[72:75], a[96:99], v[224:239]
    ds_read_b64_tr_b16 v[68:69], v14 offset:24576
    ds_read_b64_tr_b16 v[70:71], v14 offset:25088
    v_mov_b64 v[118:119], s[50:51]
    v_mov_b64 v[108:109], s[50:51]
    v_mov_b64 v[110:111], s[50:51]
    v_mfma_f32_32x32x16_bf16 v[240:255], v[76:79], a[96:99], v[240:255]
    ds_read_b64_tr_b16 v[72:73], v13 offset:26624
    ds_read_b64_tr_b16 v[74:75], v13 offset:27136
    buffer_load_dwordx4 v[160:163], v27, s[16:19], s61 offen sc1
    s_waitcnt lgkmcnt(13)
    v_mfma_f32_32x32x16_bf16 v[192:207], v[80:83], a[100:103], v[192:207]
    ds_read_b64_tr_b16 v[76:77], v14 offset:26624
    ds_read_b64_tr_b16 v[78:79], v14 offset:27136
    v_mfma_f32_32x32x16_bf16 v[208:223], v[84:87], a[100:103], v[208:223]
    ds_read_b64_tr_b16 v[80:81], v13 offset:28672
    ds_read_b64_tr_b16 v[82:83], v13 offset:29184
    s_sub_u32 s61, s61, 32768
    buffer_load_dwordx4 a[24:27], v26, s[16:19], s61 offen sc1
    s_waitcnt lgkmcnt(10)
    v_mfma_f32_32x32x16_bf16 v[224:239], v[88:91], a[100:103], v[224:239]
    ds_read_b64_tr_b16 v[84:85], v14 offset:28672
    ds_read_b64_tr_b16 v[86:87], v14 offset:29184
    v_mfma_f32_32x32x16_bf16 v[240:255], v[92:95], a[100:103], v[240:255]
    ds_read_b64_tr_b16 v[88:89], v13 offset:30720
    ds_read_b64_tr_b16 v[90:91], v13 offset:31232
    s_mov_b64 exec, 1
    buffer_store_dword v21, off, s[20:23], s58 sc1
    s_mov_b64 exec, -1
    s_add_u32 s58, s58, 262144
    s_waitcnt lgkmcnt(10)
    v_mfma_f32_32x32x16_bf16 v[192:207], v[64:67], a[104:107], v[192:207]
    ds_read_b64_tr_b16 v[92:93], v14 offset:30720
    ds_read_b64_tr_b16 v[94:95], v14 offset:31232
    s_barrier
    v_mfma_f32_32x32x16_bf16 v[208:223], v[68:71], a[104:107], v[208:223]
    ds_read_b64_tr_b16 v[64:65], v13 offset:32768
    ds_read_b64_tr_b16 v[66:67], v13 offset:33280
    buffer_load_dwordx4 v[152:155], v27, s[16:19], s61 offen sc1
    s_waitcnt lgkmcnt(10)
    v_mfma_f32_32x32x16_bf16 v[224:239], v[72:75], a[104:107], v[224:239]
    ds_read_b64_tr_b16 v[68:69], v13 offset:34816
    ds_read_b64_tr_b16 v[70:71], v13 offset:35328
    v_mfma_f32_32x32x16_bf16 v[240:255], v[76:79], a[104:107], v[240:255]
    ds_read_b64_tr_b16 v[72:73], v13 offset:36864
    ds_read_b64_tr_b16 v[74:75], v13 offset:37376
    s_sub_u32 s61, s61, 32768
    s_cmp_le_u32 s68, 1
    s_cselect_b32 s18, 0, s18
    buffer_load_dwordx4 a[20:23], v26, s[16:19], s61 offen sc1
    s_waitcnt lgkmcnt(10)
    v_mfma_f32_32x32x16_bf16 v[192:207], v[80:83], a[108:111], v[192:207]
    ds_read_b64_tr_b16 v[76:77], v13 offset:38912
    ds_read_b64_tr_b16 v[78:79], v13 offset:39424
    v_mfma_f32_32x32x16_bf16 v[208:223], v[84:87], a[108:111], v[208:223]
    ds_read_b64_tr_b16 v[80:81], v13 offset:40960
    ds_read_b64_tr_b16 v[82:83], v13 offset:41472
    buffer_load_dwordx4 v[144:147], v27, s[16:19], s61 offen sc1
    s_waitcnt lgkmcnt(10)
    v_mfma_f32_32x32x16_bf16 v[224:239], v[88:91], a[108:111], v[224:239]
    ds_read_b64_tr_b16 v[84:85], v13 offset:43008
    ds_read_b64_tr_b16 v[86:87], v13 offset:43520
    v_mfma_f32_32x32x16_bf16 v[240:255], v[92:95], a[108:111], v[240:255]
    ds_read_b64_tr_b16 v[88:89], v13 offset:45056
    ds_read_b64_tr_b16 v[90:91], v13 offset:45568
    s_sub_u32 s61, s61, 32768
    buffer_load_dwordx4 a[16:19], v26, s[16:19], s61 offen sc1
    s_waitcnt lgkmcnt(10)
    v_mfma_f32_32x32x16_bf16 v[192:207], v[64:67], a[112:115], v[192:207]
    ds_read_b64_tr_b16 v[92:93], v13 offset:47104
    ds_read_b64_tr_b16 v[94:95], v13 offset:47616
    v_mfma_f32_32x32x16_bf16 v[224:239], v[68:71], a[112:115], v[224:239]
    ds_read_b64_tr_b16 v[64:65], v14 offset:32768
    ds_read_b64_tr_b16 v[66:67], v14 offset:33280
    buffer_load_dwordx4 v[136:139], v27, s[16:19], s61 offen sc1
    s_waitcnt lgkmcnt(10)
    v_mfma_f32_32x32x16_bf16 v[192:207], v[72:75], a[116:119], v[192:207]
    ds_read_b64_tr_b16 v[68:69], v14 offset:34816
    ds_read_b64_tr_b16 v[70:71], v14 offset:35328
    v_mfma_f32_32x32x16_bf16 v[224:239], v[76:79], a[116:119], v[224:239]
    ds_read_b64_tr_b16 v[72:73], v14 offset:36864
    ds_read_b64_tr_b16 v[74:75], v14 offset:37376
    s_sub_u32 s61, s61, 32768
    s_cmp_le_u32 s68, 2
    s_cselect_b32 s18, 0, s18
    buffer_load_dwordx4 a[12:15], v26, s[16:19], s61 offen sc1
    s_waitcnt lgkmcnt(10)
    v_mfma_f32_32x32x16_bf16 v[192:207], v[80:83], a[120:123], v[192:207]
    ds_read_b64_tr_b16 v[76:77], v14 offset:38912
    ds_read_b64_tr_b16 v[78:79], v14 offset:39424
    v_mfma_f32_32x32x16_bf16 v[224:239], v[84:87], a[120:123], v[224:239]
    ds_read_b64_tr_b16 v[80:81], v14 offset:40960
    ds_read_b64_tr_b16 v[82:83], v14 offset:41472
    buffer_load_dwordx4 v[128:131], v27, s[16:19], s61 offen sc1
    s_waitcnt lgkmcnt(10)
    v_mfma_f32_32x32x16_bf16 v[192:207], v[88:91], a[124:127], v[192:207]
    ds_read_b64_tr_b16 v[84:85], v14 offset:43008
    ds_read_b64_tr_b16 v[86:87], v14 offset:43520
    v_mfma_f32_32x32x16_bf16 v[224:239], v[92:95], a[124:127], v[224:239]
    ds_read_b64_tr_b16 v[88:89], v14 offset:45056
    ds_read_b64_tr_b16 v[90:91], v14 offset:45568
    s_sub_u32 s61, s61, 32768
    buffer_load_dwordx4 a[8:11], v26, s[16:19], s61 offen sc1
    s_waitcnt lgkmcnt(10)
    v_mfma_f32_32x32x16_bf16 v[208:223], v[64:67], a[112:115], v[208:223]
    ds_read_b64_tr_b16 v[92:93], v14 offset:47104
    ds_read_b64_tr_b16 v[94:95], v14 offset:47616
    v_mfma_f32_32x32x16_bf16 v[240:255], v[68:71], a[112:115], v[240:255]
    buffer_load_dwordx4 v[120:123], v27, s[16:19], s61 offen sc1
    s_waitcnt lgkmcnt(8)
    v_mfma_f32_32x32x16_bf16 v[208:223], v[72:75], a[116:119], v[208:223]
    v_mul_f32 v192, v192, v224
    v_mul_f32 v193, v193, v225
    v_mul_f32 v194, v194, v226
    v_mul_f32 v195, v195, v227
    v_mul_f32 v196, v196, v228
    v_mul_f32 v197, v197, v229
    v_mul_f32 v198, v198, v230
    v_mfma_f32_32x32x16_bf16 v[240:255], v[76:79], a[116:119], v[240:255]
    v_mul_f32 v199, v199, v231
    v_cvt_pk_bf16_f32 v192, v192, v193
    v_cvt_pk_bf16_f32 v193, v194, v195
    v_cvt_pk_bf16_f32 v194, v196, v197
    v_cvt_pk_bf16_f32 v195, v198, v199
    s_waitcnt lgkmcnt(4)
    v_mfma_f32_32x32x16_bf16 v[208:223], v[80:83], a[120:123], v[208:223]
    buffer_store_dwordx4 v[192:195], v2, s[20:23], s57 offen offset:0 sc1
    v_mfma_f32_32x32x16_bf16 v[240:255], v[84:87], a[120:123], v[240:255]
    v_mul_f32 v200, v200, v232
    v_mul_f32 v201, v201, v233
    v_mul_f32 v202, v202, v234
    v_mul_f32 v203, v203, v235
    v_mul_f32 v204, v204, v236
    v_mul_f32 v205, v205, v237
    v_mul_f32 v206, v206, v238
    v_mul_f32 v207, v207, v239
    s_waitcnt lgkmcnt(0)
    v_mfma_f32_32x32x16_bf16 v[208:223], v[88:91], a[124:127], v[208:223]
    v_cvt_pk_bf16_f32 v200, v200, v201
    v_cvt_pk_bf16_f32 v201, v202, v203
    v_cvt_pk_bf16_f32 v202, v204, v205
    v_cvt_pk_bf16_f32 v203, v206, v207
    v_mfma_f32_32x32x16_bf16 v[240:255], v[92:95], a[124:127], v[240:255]
    buffer_store_dwordx4 v[200:203], v2, s[20:23], s57 offen offset:1024 sc1
    s_sub_u32 s61, s61, 32768
    s_cmp_le_u32 s68, 3
    s_cselect_b32 s18, 0, s18
    buffer_load_dwordx4 a[4:7], v26, s[16:19], s61 offen sc1
    buffer_load_dwordx4 v[112:115], v27, s[16:19], s61 offen sc1
    s_sub_u32 s61, s61, 32768
    buffer_load_dwordx4 a[0:3], v26, s[16:19], s61 offen sc1
    buffer_load_dwordx4 v[104:107], v27, s[16:19], s61 offen sc1
    s_branch parallel_sum__sliding_block__glu_gated_bilinear__prompt_kernel_p2
.p2align 12
parallel_sum__sliding_block__glu_gated_bilinear__prompt_kernel_O:
    s_add_u32 m0, s42, 7296
    s_nop 0
    buffer_load_dwordx4 v3, s[16:19], s47 offen offset:896 lds
    buffer_load_dwordx4 v4, s[16:19], s47 offen offset:1920 lds
    s_add_u32 m0, s42, 9216
    s_nop 0
    buffer_load_dwordx4 v3, s[16:19], s47 offen offset:1024 lds
    buffer_load_dwordx4 v4, s[16:19], s47 offen offset:2048 lds
    s_bitcmp1_b32 s40, 1
    s_cbranch_scc1 parallel_sum__sliding_block__glu_gated_bilinear__prompt_kernel_wh2O
    s_bitcmp1_b32 s40, 0
    s_cbranch_scc1 parallel_sum__sliding_block__glu_gated_bilinear__prompt_kernel_w2O1_0
    s_branch parallel_sum__sliding_block__glu_gated_bilinear__prompt_kernel_w2O0_0
parallel_sum__sliding_block__glu_gated_bilinear__prompt_kernel_wh2O:
    s_bitcmp1_b32 s40, 0
    s_cbranch_scc1 parallel_sum__sliding_block__glu_gated_bilinear__prompt_kernel_w2O3_0
    s_branch parallel_sum__sliding_block__glu_gated_bilinear__prompt_kernel_w2O2_0
parallel_sum__sliding_block__glu_gated_bilinear__prompt_kernel_wr2O:
    v_lshrrev_b32 v22, 5, v1
    v_bfe_u32 v23, v1, 2, 2
    v_bfe_u32 v24, v1, 4, 1
    v_and_b32 v25, 3, v1
    v_lshlrev_b32 v25, 3, v25
    v_lshl_add_u32 v25, v24, 5, v25
    v_lshl_add_u32 v25, v22, 10, v25
    v_lshl_add_u32 v25, v23, 7, v25
    v_lshrrev_b32 v23, 1, v23
    v_lshl_add_u32 v11, v23, 6, v25
    v_xor_b32 v12, 64, v11
    v_bfe_u32 v23, v1, 1, 3
    v_xor_b32 v23, v23, v22
    v_and_b32 v25, 31, v1
    v_lshlrev_b32 v25, 7, v25
    v_lshl_add_u32 v25, v23, 4, v25
    s_add_u32 s70, s42, 114688
    v_add_u32 v15, s70, v25
    v_xor_b32 v16, 32, v15
    v_xor_b32 v17, 64, v15
    s_add_u32 m0, s42, 131072
    s_bfe_u32 s46, s43, 0x30004
    s_lshl_b32 s46, s46, 7
    buffer_load_dwordx4 v7, s[4:7], s46 offen offset:0 lds
    v_xor_b32 v18, 96, v15
    v_add_u32 v13, 0x10000, v11
    v_add_u32 v14, 0x10000, v12
    v_mov_b32 v224, 0x3f803f80
    v_mov_b32 v225, 0x3f803f80
    v_mov_b32 v226, 0x3f803f80
    v_mov_b32 v227, 0x3f803f80
    v_mov_b32 v200, 0
    v_mov_b32 v201, 0
    v_mov_b32 v202, 0
    v_mov_b32 v203, 0
    s_and_b32 s70, s40, 1
    s_lshl_b32 s70, s70, 6
    v_xor_b32 v238, s70, v11
    s_lshr_b32 s71, s40, 1
    s_lshl_b32 s70, s71, 11
    s_add_u32 s3, s70, 32768
    v_add_u32 v236, s3, v238
    s_add_u32 s3, s70, 98304
    v_add_u32 v237, s3, v238
    buffer_load_dwordx4 v8, s[4:7], s46 offen offset:1024 lds
    s_lshl1_add_u32 s3, s70, 24576
    v_add_u32 v238, s3, v238
    v_and_b32 v242, 0x1f0, v2
    s_add_u32 s3, s42, 147456
    v_add_u32 v243, s3, v242
    v_lshl_add_u32 v244, v22, 12, v242
    v_add_u32 v244, 147456, v244
    v_lshlrev_b32 v245, 4, v22
    s_add_u32 s3, s3, 1024
    v_lshrrev_b32 v246, 2, v242
    v_add_u32 v246, s3, v246
    s_bitcmp1_b32 s74, 1
    s_cselect_b32 s70, 1.0, 0x3eb8aa3b
    v_mov_b32 v29, s70
    s_and_b32 s70, s69, 1
    s_lshl1_add_u32 s53, s74, s70
    s_lshl2_add_u32 s53, s53, s40
    s_lshl_b32 s53, s53, 12
    s_add_u32 s53, s53, 18874368
    s_lshl_b32 s70, s49, 9
    s_add_u32 s46, s46, 14336
    buffer_load_dwordx4 v7, s[4:7], s46 offen offset:2048 lds
    s_add_u32 s52, s53, s70
    s_lshl_b32 s54, s73, 9
    s_add_u32 s54, s54, 19398656
    s_lshr_b32 s51, s51, 6
    s_add_u32 s51, s51, 19398656
    s_mul_i32 s57, s73, 144
    s_lshl3_add_u32 s50, s45, s57
    s_and_b32 s70, s72, 1
    s_lshl2_add_u32 s50, s70, s50
    s_lshl_b32 s55, s70, 12
    s_and_b32 s70, s72, 2
    s_add_u32 s50, s50, s70
    s_lshl_b32 s50, s50, 10
    s_add_u32 s50, s50, 9437184
    s_lshl_b32 s70, s70, 20
    s_add_u32 s55, s55, s70
    s_lshl2_add_u32 s56, s73, s45
    s_lshl_b32 s56, s56, 13
    s_add_u32 s55, s55, s56
    s_add_u32 s55, s55, 1048576
    buffer_load_dwordx4 v8, s[4:7], s46 offen offset:3072 lds
    s_add_u32 s56, s56, 5242880
    s_mul_i32 s70, s45, 28
    s_add_u32 s57, s57, s70
    s_lshl2_add_u32 s57, s72, s57
    s_lshl_b32 s57, s57, 10
    s_add_u32 s57, s57, 9469952
    s_lshl4_add_u32 s58, s73, s74
    s_lshl_b32 s58, s58, 7
    s_add_u32 s58, s58, 19939328
    v_mov_b32 v220, -1
    v_mov_b32 v221, -1
    v_mov_b32 v222, -1
    v_mov_b32 v223, -1
    v_mov_b32 v34, 0
    v_mov_b32 v35, 0
    s_and_b32 s70, s67, 3
    s_lshl2_add_u32 s68, s69, s70
    s_mul_i32 s59, s40, 458752
    s_lshl_b32 s70, s75, 2
    s_mov_b32 s76, 0x10210210
    s_add_u32 m0, s41, 24576
    s_bfe_u32 s48, s43, 0x30004
    s_mul_i32 s47, s48, 196608
    buffer_load_dwordx4 v3, s[16:19], s47 offen offset:0 lds
    s_mov_b32 s77, 0x2102
    s_lshr_b64 s[76:77], s[76:77], s70
    s_and_b32 s44, s76, 0xfff
    s_and_b32 s70, s70, 12
    s_lshr_b32 s70, 0x65436543, s70
    s_and_b32 s70, s70, 0xffff
    s_lshl_b32 s70, s70, 12
    s_or_b32 s44, s44, s70
    s_lshl_b32 s60, s68, 12
    s_add_u32 s60, s60, 19922944
    s_and_b32 s70, s75, 1
    s_lshl_b32 s78, 0x44444444, s70
    s_or_b32 s78, s78, 0x88888888
    s_lshl_b32 s79, 0x55, s70
    s_or_b32 s79, s79, 0x88
    s_lshl_b32 s70, s68, 3
    s_sub_i32 s70, 32, s70
    s_max_i32 s70, s70, 0
    s_lshl_b64 s[76:77], -1, s70
    s_and_b32 s78, s78, s76
    buffer_load_dwordx4 v4, s[16:19], s47 offen offset:1024 lds
    s_bitcmp1_b32 s40, 1
    s_cbranch_scc1 parallel_sum__sliding_block__glu_gated_bilinear__prompt_kernel_wh3O
    s_bitcmp1_b32 s40, 0
    s_cbranch_scc1 parallel_sum__sliding_block__glu_gated_bilinear__prompt_kernel_w3O1_0
    s_branch parallel_sum__sliding_block__glu_gated_bilinear__prompt_kernel_wr3O
parallel_sum__sliding_block__glu_gated_bilinear__prompt_kernel_wh3O:
    s_bitcmp1_b32 s40, 0
    s_cbranch_scc1 parallel_sum__sliding_block__glu_gated_bilinear__prompt_kernel_wr3O
    s_branch parallel_sum__sliding_block__glu_gated_bilinear__prompt_kernel_w3O2_0
parallel_sum__sliding_block__glu_gated_bilinear__prompt_kernel_wr3O:
    s_lshl2_add_u32 s71, s75, s40
    s_lshl_b32 s71, s71, 10
    s_lshl_b32 s61, s68, 16
    s_add_u32 s61, s61, s71
    s_add_u32 s61, s61, 1081344
    s_mul_i32 s70, s68, 294912
    s_add_u32 s70, s70, 9437184
    s_add_u32 s64, s70, s71
    s_lshl1_add_u32 s63, s42, s70
    s_mul_i32 s62, s40, 28672
    s_add_u32 s62, s62, s70
    s_add_u32 s62, s62, 32768
    s_lshl_b32 s66, s68, 10
    s_add_u32 s66, s66, 19398656
    s_and_b32 s70, s40, 1
    s_lshl1_add_u32 s65, s68, s70
    s_lshl_b32 s65, s65, 8
    s_add_u32 s65, s65, s75
    s_lshr_b32 s71, s40, 1
    s_lshl1_add_u32 s65, s65, s71
    s_add_u32 m0, s42, 31872
    s_nop 0
    buffer_load_dwordx4 v3, s[16:19], s47 offen offset:896 lds
    s_lshl_b32 s65, s65, 6
    s_lshl_b32 s71, s71, 6
    v_bfe_u32 v23, v1, 2, 2
    v_lshl_add_u32 v19, v22, 2, v23
    v_lshlrev_b32 v19, 7, v19
    v_lshrrev_b32 v23, 1, v23
    v_lshl_add_u32 v19, v23, 6, v19
    v_lshl_add_u32 v19, v24, 5, v19
    v_and_b32 v23, 1, v1
    v_lshl_add_u32 v19, v23, 4, v19
    v_bfe_u32 v23, v1, 1, 1
    v_lshl_add_u32 v19, v23, 3, v19
    v_xor_b32 v19, s71, v19
    s_add_u32 s71, s42, 114688
    v_add_u32 v19, s71, v19
    v_xor_b32 v20, 64, v19
    v_add_u32 v26, 2097152, v2
    v_and_b32 v23, 15, v1
    v_lshlrev_b32 v27, 4, v23
    v_lshl_add_u32 v27, v22, 9, v27
    buffer_load_dwordx4 v4, s[16:19], s47 offen offset:1920 lds
    v_lshl_add_u32 v27, v24, 10, v27
    s_mul_i32 s71, s70, 768
    s_sub_u32 s71, 4194304, s71
    v_add_u32 v27, s71, v27
    s_mul_i32 s70, s70, 147456
    s_sub_u32 s71, 147456, s70
    v_add_u32 v30, s70, v2
    v_add_u32 v31, s71, v2
    v_lshlrev_b32 v0, 6, v242
    v_lshl_add_u32 v0, v22, 4, v0
    v_lshrrev_b32 v23, 2, v1
    v_and_b32 v25, 3, v1
    v_lshlrev_b32 v25, 2, v25
    s_lshr_b32 s70, s75, 1
    s_lshl_b32 s70, s70, 4
    v_lshl_add_u32 v28, v23, 6, v25
    v_add_u32 v28, s70, v28
    v_and_b32 v23, 1, v23
    v_lshl_add_u32 v25, v23, 6, v25
    v_lshl_add_u32 v25, v24, 13, v25
    s_add_u32 m0, s42, 33792
    s_nop 0
    buffer_load_dwordx4 v3, s[16:19], s47 offen offset:1024 lds
    s_lshl4_add_u32 s70, s40, 8704
    v_add_u32 v25, s70, v25
    v_cmp_lt_u32 vcc, 39, v1
    s_nop 1
    v_cndmask_b32 v28, v28, v25, vcc
    v_lshlrev_b32 v28, 5, v28
    s_mov_b32 s67, 1006632960
    v_and_b32 v23, 31, v1
    v_lshlrev_b32 v24, 2, v22
    v_sub_u32 v23, v23, v24
    v_mov_b32 v24, 0xf149f2ca
    v_cmp_le_i32 vcc, 0, v23
    v_cmp_le_i32 s[76:77], 1, v23
    s_nop 0
    v_cndmask_b32 v48, v24, 0, vcc
    v_cndmask_b32 v49, v24, 0, s[76:77]
    v_cmp_le_i32 vcc, 2, v23
    v_cmp_le_i32 s[76:77], 3, v23
    s_nop 0
    v_cndmask_b32 v50, v24, 0, vcc
    v_cndmask_b32 v51, v24, 0, s[76:77]
    v_cmp_le_i32 vcc, 8, v23
    v_cmp_le_i32 s[76:77], 9, v23
    buffer_load_dwordx4 v4, s[16:19], s47 offen offset:2048 lds
    v_cndmask_b32 v52, v24, 0, vcc
    v_cndmask_b32 v53, v24, 0, s[76:77]
    v_cmp_le_i32 vcc, 10, v23
    v_cmp_le_i32 s[76:77], 11, v23
    s_nop 0
    v_cndmask_b32 v54, v24, 0, vcc
    v_cndmask_b32 v55, v24, 0, s[76:77]
    v_cmp_le_i32 vcc, 16, v23
    v_cmp_le_i32 s[76:77], 17, v23
    s_nop 0
    v_cndmask_b32 v56, v24, 0, vcc
    v_cndmask_b32 v57, v24, 0, s[76:77]
    v_cmp_le_i32 vcc, 18, v23
    v_cmp_le_i32 s[76:77], 19, v23
    s_nop 0
    v_cndmask_b32 v58, v24, 0, vcc
    v_cndmask_b32 v59, v24, 0, s[76:77]
    v_cmp_le_i32 vcc, 24, v23
    v_cmp_le_i32 s[76:77], 25, v23
    s_nop 0
    v_cndmask_b32 v60, v24, 0, vcc
    v_cndmask_b32 v61, v24, 0, s[76:77]
    v_cmp_le_i32 vcc, 26, v23
    v_cmp_le_i32 s[76:77], 27, v23
    s_nop 0
    v_cndmask_b32 v62, v24, 0, vcc
    v_cndmask_b32 v63, v24, 0, s[76:77]
    v_lshl_add_u32 v25, v22, 4, s3
    s_waitcnt vmcnt(20)
    v_dot2c_f32_bf16 v200, v224, v192
    v_dot2c_f32_bf16 v201, v192, v192
    v_dot2c_f32_bf16 v202, v224, v196
    v_dot2c_f32_bf16 v203, v196, v196
    v_dot2c_f32_bf16 v200, v224, v193
    v_dot2c_f32_bf16 v201, v193, v193
    v_dot2c_f32_bf16 v202, v224, v197
    v_dot2c_f32_bf16 v203, v197, v197
    v_dot2c_f32_bf16 v200, v224, v194
    v_dot2c_f32_bf16 v201, v194, v194
    v_dot2c_f32_bf16 v202, v224, v198
    v_dot2c_f32_bf16 v203, v198, v198
    v_dot2c_f32_bf16 v200, v224, v195
    v_dot2c_f32_bf16 v201, v195, v195
    v_dot2c_f32_bf16 v202, v224, v199
    v_dot2c_f32_bf16 v203, v199, v199
    s_nop 1
    v_permlane32_swap_b32 v200, v202
    v_permlane32_swap_b32 v201, v203
    v_add_f32 v200, v200, v202
    v_add_f32 v201, v201, v203
    s_nop 1
    v_permlane16_swap_b32 v200, v201
    v_add_f32 v200, v200, v201
    s_nop 1
    v_add_f32_dpp v200, v200, v200 row_ror:8 row_mask:0xf bank_mask:0xf
    s_nop 1
    v_add_f32_dpp v200, v200, v200 row_ror:4 row_mask:0xf bank_mask:0xf
    s_nop 1
    v_add_f32_dpp v200, v200, v200 row_ror:2 row_mask:0xf bank_mask:0xf
    s_nop 1
    v_add_f32_dpp v200, v200, v200 row_ror:1 row_mask:0xf bank_mask:0xf
    v_mov_b32 v201, v200
    s_nop 1
    v_permlane16_swap_b32 v200, v201
    v_mul_f32 v216, 0xbb000000, v200
    v_mul_f32 v201, 0x3b000000, v201
    v_fma_f32 v201, -v216, v216, v201
    v_max_f32 v201, 0, v201
    v_add_f32 v218, 0x3727c5ac, v201
    v_rsq_f32 v217, v218
    s_waitcnt vmcnt(10)
    s_barrier
    ds_read_b128 a[16:19], v15 offset:0
    ds_read_b64_tr_b16 v[64:65], v11 offset:0
    ds_read_b64_tr_b16 v[66:67], v11 offset:512
    ds_read_b64_tr_b16 v[68:69], v12 offset:0
    ds_read_b64_tr_b16 v[70:71], v12 offset:512
    ds_read_b128 a[20:23], v16 offset:0
    ds_read_b64_tr_b16 v[72:73], v11 offset:8192
    ds_read_b64_tr_b16 v[74:75], v11 offset:8704
    ds_read_b64_tr_b16 v[76:77], v12 offset:8192
    ds_read_b64_tr_b16 v[78:79], v12 offset:8704
    ds_read_b128 a[24:27], v17 offset:0
    ds_read_b64_tr_b16 v[80:81], v11 offset:10240
    ds_read_b64_tr_b16 v[82:83], v11 offset:10752
    ds_read_b64_tr_b16 v[84:85], v12 offset:10240
    ds_read_b64_tr_b16 v[86:87], v12 offset:10752
    ds_read_b128 a[28:31], v18 offset:0
    ds_read_b64_tr_b16 v[88:89], v11 offset:2048
    ds_read_b64_tr_b16 v[90:91], v11 offset:2560
    s_waitcnt lgkmcnt(2)
    v_mfma_f32_32x32x16_bf16 v[96:111], v[64:67], a[16:19], 0
    ds_read_b64_tr_b16 v[92:93], v12 offset:2048
    ds_read_b64_tr_b16 v[94:95], v12 offset:2560
    s_add_u32 m0, s42, 147456
    s_bfe_u32 s46, s43, 0x30008
    s_lshl_b32 s46, s46, 7
    v_mfma_f32_32x32x16_bf16 v[112:127], v[68:71], a[16:19], 0
    ds_read_b64_tr_b16 v[64:65], v11 offset:12288
    ds_read_b64_tr_b16 v[66:67], v11 offset:12800
    buffer_load_dwordx4 v7, s[4:7], s46 offen offset:0 lds
    v_mfma_f32_32x32x16_bf16 v[128:143], a[16:19], v[72:75], 0
    ds_read_b64_tr_b16 v[68:69], v12 offset:12288
    ds_read_b64_tr_b16 v[70:71], v12 offset:12800
    buffer_load_dwordx4 v8, s[4:7], s46 offen offset:1024 lds
    s_add_u32 s46, s46, 14336
    v_mfma_f32_32x32x16_bf16 v[144:159], a[16:19], v[76:79], 0
    ds_read_b64_tr_b16 v[72:73], v11 offset:14336
    ds_read_b64_tr_b16 v[74:75], v11 offset:14848
    buffer_load_dwordx4 v7, s[4:7], s46 offen offset:2048 lds
    v_mfma_f32_32x32x16_bf16 v[160:175], a[16:19], v[80:83], 0
    ds_read_b64_tr_b16 v[76:77], v12 offset:14336
    ds_read_b64_tr_b16 v[78:79], v12 offset:14848
    buffer_load_dwordx4 v8, s[4:7], s46 offen offset:3072 lds
    s_add_u32 m0, s41, 49152
    v_mfma_f32_32x32x16_bf16 v[176:191], a[16:19], v[84:87], 0
    ds_read_b64_tr_b16 v[80:81], v11 offset:4096
    ds_read_b64_tr_b16 v[82:83], v11 offset:4608
    s_bfe_u32 s48, s43, 0x30008
    s_mul_i32 s47, s48, 196608
    buffer_load_dwordx4 v3, s[16:19], s47 offen offset:0 lds
    s_waitcnt lgkmcnt(10)
    v_mfma_f32_32x32x16_bf16 v[96:111], v[88:91], a[20:23], v[96:111]
    ds_read_b64_tr_b16 v[84:85], v12 offset:4096
    ds_read_b64_tr_b16 v[86:87], v12 offset:4608
    buffer_load_dwordx4 v4, s[16:19], s47 offen offset:1024 lds
    s_add_u32 m0, s42, 56448
    v_mfma_f32_32x32x16_bf16 v[112:127], v[92:95], a[20:23], v[112:127]
    ds_read_b64_tr_b16 v[88:89], v11 offset:16384
    ds_read_b64_tr_b16 v[90:91], v11 offset:16896
    buffer_load_dwordx4 v3, s[16:19], s47 offen offset:896 lds
    s_waitcnt lgkmcnt(10)
    v_mfma_f32_32x32x16_bf16 v[128:143], a[20:23], v[64:67], v[128:143]
    ds_read_b64_tr_b16 v[92:93], v12 offset:16384
    ds_read_b64_tr_b16 v[94:95], v12 offset:16896
    buffer_load_dwordx4 v4, s[16:19], s47 offen offset:1920 lds
    s_add_u32 m0, s42, 58368
    v_mfma_f32_32x32x16_bf16 v[144:159], a[20:23], v[68:71], v[144:159]
    ds_read_b64_tr_b16 v[64:65], v11 offset:18432
    ds_read_b64_tr_b16 v[66:67], v11 offset:18944
    buffer_load_dwordx4 v3, s[16:19], s47 offen offset:1024 lds
    s_waitcnt lgkmcnt(10)
    v_mfma_f32_32x32x16_bf16 v[160:175], a[20:23], v[72:75], v[160:175]
    ds_read_b64_tr_b16 v[68:69], v12 offset:18432
    ds_read_b64_tr_b16 v[70:71], v12 offset:18944
    buffer_load_dwordx4 v4, s[16:19], s47 offen offset:2048 lds
    s_add_u32 m0, s42, 97920
    v_mfma_f32_32x32x16_bf16 v[176:191], a[20:23], v[76:79], v[176:191]
    ds_read_b64_tr_b16 v[72:73], v11 offset:6144
    ds_read_b64_tr_b16 v[74:75], v11 offset:6656
    s_bfe_u32 s48, s43, 0x30004
    s_mul_i32 s48, s48, 229376
    buffer_load_dwordx4 v5, s[8:11], s48 offen offset:384 lds
    s_waitcnt lgkmcnt(10)
    v_mfma_f32_32x32x16_bf16 v[96:111], v[80:83], a[24:27], v[96:111]
    ds_read_b64_tr_b16 v[76:77], v12 offset:6144
    ds_read_b64_tr_b16 v[78:79], v12 offset:6656
    buffer_load_dwordx4 v6, s[8:11], s48 offen offset:1408 lds
    v_mfma_f32_32x32x16_bf16 v[112:127], v[84:87], a[24:27], v[112:127]
    ds_read_b64_tr_b16 v[80:81], v11 offset:20480
    ds_read_b64_tr_b16 v[82:83], v11 offset:20992
    buffer_load_dwordx4 v5, s[12:15], s48 offen offset:2432 lds
    s_waitcnt lgkmcnt(10)
    v_mfma_f32_32x32x16_bf16 v[128:143], a[24:27], v[88:91], v[128:143]
    ds_read_b64_tr_b16 v[84:85], v12 offset:20480
    ds_read_b64_tr_b16 v[86:87], v12 offset:20992
    buffer_load_dwordx4 v6, s[12:15], s48 offen offset:3456 lds
    s_add_u32 m0, s42, 114688
    v_mfma_f32_32x32x16_bf16 v[144:159], a[24:27], v[92:95], v[144:159]
    ds_read_b64_tr_b16 v[88:89], v11 offset:22528
    ds_read_b64_tr_b16 v[90:91], v11 offset:23040
    s_bfe_u32 s46, s43, 0x3000c
    s_lshl_b32 s46, s46, 7
    s_waitcnt lgkmcnt(10)
    v_mfma_f32_32x32x16_bf16 v[160:175], a[24:27], v[64:67], v[160:175]
    ds_read_b64_tr_b16 v[92:93], v12 offset:22528
    ds_read_b64_tr_b16 v[94:95], v12 offset:23040
    buffer_load_dwordx4 v7, s[4:7], s46 offen offset:0 lds
    s_waitcnt vmcnt(15)
    s_barrier
    v_mfma_f32_32x32x16_bf16 v[176:191], a[24:27], v[68:71], v[176:191]
    ds_read_b64_tr_b16 v[64:65], v11 offset:24576
    ds_read_b64_tr_b16 v[66:67], v11 offset:25088
    ds_read_b128 a[0:3], v15 offset:16384
    ds_read_b128 a[4:7], v16 offset:16384
    s_waitcnt lgkmcnt(12)
    v_mfma_f32_32x32x16_bf16 v[96:111], v[72:75], a[28:31], v[96:111]
    ds_read_b64_tr_b16 v[68:69], v12 offset:24576
    ds_read_b64_tr_b16 v[70:71], v12 offset:25088
    ds_read_b128 a[8:11], v17 offset:16384
    v_mfma_f32_32x32x16_bf16 v[112:127], v[76:79], a[28:31], v[112:127]
    ds_read_b64_tr_b16 v[72:73], v11 offset:32768
    ds_read_b64_tr_b16 v[74:75], v11 offset:33280
    ds_read_b128 a[12:15], v18 offset:16384
    ds_read_b64_tr_b16 v[192:193], v236 offset:0
    s_waitcnt lgkmcnt(15)
    v_mfma_f32_32x32x16_bf16 v[128:143], a[28:31], v[80:83], v[128:143]
    ds_read_b64_tr_b16 v[76:77], v12 offset:32768
    ds_read_b64_tr_b16 v[78:79], v12 offset:33280
    ds_read_b64_tr_b16 v[194:195], v236 offset:512
    ds_read_b64_tr_b16 v[196:197], v236 offset:4096
    v_mfma_f32_32x32x16_bf16 v[144:159], a[28:31], v[84:87], v[144:159]
    ds_read_b64_tr_b16 v[80:81], v11 offset:34816
    ds_read_b64_tr_b16 v[82:83], v11 offset:35328
    ds_read_b64_tr_b16 v[198:199], v236 offset:4608
    ds_read_b64_tr_b16 v[200:201], v236 offset:8192
    ds_read_b64_tr_b16 v[202:203], v236 offset:8704
    s_waitcnt lgkmcnt(15)
    v_mfma_f32_32x32x16_bf16 v[160:175], a[28:31], v[88:91], v[160:175]
    ds_read_b64_tr_b16 v[84:85], v12 offset:34816
    ds_read_b64_tr_b16 v[86:87], v12 offset:35328
    ds_read_b64_tr_b16 v[204:205], v236 offset:12288
    ds_read_b64_tr_b16 v[206:207], v236 offset:12800
    v_mfma_f32_32x32x16_bf16 v[176:191], a[28:31], v[92:95], v[176:191]
    ds_read_b64_tr_b16 v[88:89], v11 offset:26624
    ds_read_b64_tr_b16 v[90:91], v11 offset:27136
    ds_read_b64_tr_b16 v[208:209], v238 offset:0
    ds_read_b64_tr_b16 v[210:211], v238 offset:512
    ds_read_b64_tr_b16 v[212:213], v238 offset:2048
    s_waitcnt lgkmcnt(15)
    v_mfma_f32_32x32x16_bf16 v[96:111], v[64:67], a[0:3], v[96:111]
    ds_read_b64_tr_b16 v[92:93], v12 offset:26624
    ds_read_b64_tr_b16 v[94:95], v12 offset:27136
    ds_read_b64_tr_b16 v[214:215], v238 offset:2560
    v_mfma_f32_32x32x16_bf16 v[112:127], v[68:71], a[0:3], v[112:127]
    ds_read_b64_tr_b16 v[64:65], v11 offset:36864
    ds_read_b64_tr_b16 v[66:67], v11 offset:37376
    buffer_load_dwordx4 v8, s[4:7], s46 offen offset:1024 lds
    s_add_u32 s46, s46, 14336
    v_mfma_f32_32x32x16_bf16 v[128:143], a[0:3], v[72:75], v[128:143]
    ds_read_b64_tr_b16 v[68:69], v12 offset:36864
    ds_read_b64_tr_b16 v[70:71], v12 offset:37376
    v_mfma_f32_32x32x16_bf16 v[144:159], a[0:3], v[76:79], v[144:159]
    ds_read_b64_tr_b16 v[72:73], v11 offset:38912
    ds_read_b64_tr_b16 v[74:75], v11 offset:39424
    buffer_load_dwordx4 v7, s[4:7], s46 offen offset:2048 lds
    s_waitcnt lgkmcnt(15)
    v_mfma_f32_32x32x16_bf16 v[160:175], a[0:3], v[80:83], v[160:175]
    ds_read_b64_tr_b16 v[76:77], v12 offset:38912
    ds_read_b64_tr_b16 v[78:79], v12 offset:39424
    v_mfma_f32_32x32x16_bf16 v[176:191], a[0:3], v[84:87], v[176:191]
    ds_read_b64_tr_b16 v[80:81], v11 offset:28672
    ds_read_b64_tr_b16 v[82:83], v11 offset:29184
    buffer_load_dwordx4 v8, s[4:7], s46 offen offset:3072 lds
    s_add_u32 m0, s41, 73728
    s_bfe_u32 s48, s43, 0x3000c
    s_waitcnt lgkmcnt(11)
    v_mfma_f32_32x32x16_bf16 v[96:111], v[88:91], a[4:7], v[96:111]
    ds_read_b64_tr_b16 v[84:85], v12 offset:28672
    ds_read_b64_tr_b16 v[86:87], v12 offset:29184
    s_mul_i32 s47, s48, 196608
    v_mfma_f32_32x32x16_bf16 v[112:127], v[92:95], a[4:7], v[112:127]
    ds_read_b64_tr_b16 v[88:89], v11 offset:40960
    ds_read_b64_tr_b16 v[90:91], v11 offset:41472
    buffer_load_dword v21, off, s[36:39], 0 sc1
    s_waitcnt lgkmcnt(10)
    v_mfma_f32_32x32x16_bf16 v[128:143], a[4:7], v[64:67], v[128:143]
    ds_read_b64_tr_b16 v[92:93], v12 offset:40960
    ds_read_b64_tr_b16 v[94:95], v12 offset:41472
    v_mfma_f32_32x32x16_bf16 v[144:159], a[4:7], v[68:71], v[144:159]
    ds_read_b64_tr_b16 v[64:65], v11 offset:43008
    ds_read_b64_tr_b16 v[66:67], v11 offset:43520
    buffer_load_dwordx4 v3, s[16:19], s47 offen offset:0 lds
    s_waitcnt lgkmcnt(10)
    v_mfma_f32_32x32x16_bf16 v[160:175], a[4:7], v[72:75], v[160:175]
    ds_read_b64_tr_b16 v[68:69], v12 offset:43008
    ds_read_b64_tr_b16 v[70:71], v12 offset:43520
    v_mfma_f32_32x32x16_bf16 a[128:143], v[224:227], v[192:195], 0
    buffer_load_dwordx4 v4, s[16:19], s47 offen offset:1024 lds
    s_add_u32 m0, s42, 81024
    v_mfma_f32_32x32x16_bf16 v[176:191], a[4:7], v[76:79], v[176:191]
    ds_read_b64_tr_b16 v[72:73], v11 offset:30720
    ds_read_b64_tr_b16 v[74:75], v11 offset:31232
    s_waitcnt lgkmcnt(10)
    v_mfma_f32_32x32x16_bf16 v[96:111], v[80:83], a[8:11], v[96:111]
    ds_read_b64_tr_b16 v[76:77], v12 offset:30720
    ds_read_b64_tr_b16 v[78:79], v12 offset:31232
    buffer_load_dwordx4 v3, s[16:19], s47 offen offset:896 lds
    v_mfma_f32_32x32x16_bf16 a[128:143], v[224:227], v[196:199], a[128:143]
    v_mfma_f32_32x32x16_bf16 v[112:127], v[84:87], a[8:11], v[112:127]
    ds_read_b64_tr_b16 v[80:81], v11 offset:45056
    ds_read_b64_tr_b16 v[82:83], v11 offset:45568
    buffer_load_dwordx4 v4, s[16:19], s47 offen offset:1920 lds
    s_add_u32 m0, s42, 82944
    s_waitcnt lgkmcnt(10)
    v_mfma_f32_32x32x16_bf16 v[128:143], a[8:11], v[88:91], v[128:143]
    ds_read_b64_tr_b16 v[84:85], v12 offset:45056
    ds_read_b64_tr_b16 v[86:87], v12 offset:45568
    v_mfma_f32_32x32x16_bf16 a[128:143], v[224:227], v[200:203], a[128:143]
    buffer_load_dwordx4 v3, s[16:19], s47 offen offset:1024 lds
    v_mfma_f32_32x32x16_bf16 v[144:159], a[8:11], v[92:95], v[144:159]
    ds_read_b64_tr_b16 v[88:89], v11 offset:47104
    ds_read_b64_tr_b16 v[90:91], v11 offset:47616
    s_waitcnt lgkmcnt(10)
    v_mfma_f32_32x32x16_bf16 v[160:175], a[8:11], v[64:67], v[160:175]
    ds_read_b64_tr_b16 v[92:93], v12 offset:47104
    ds_read_b64_tr_b16 v[94:95], v12 offset:47616
    buffer_load_dwordx4 v4, s[16:19], s47 offen offset:2048 lds
    s_waitcnt vmcnt(11)
    s_barrier
    v_mfma_f32_32x32x16_bf16 a[128:143], v[224:227], v[204:207], a[128:143]
    ds_read_b128 a[32:35], v15 offset:32768
    ds_read_b128 a[36:39], v16 offset:32768
    ds_read_b128 a[40:43], v17 offset:32768
    s_add_u32 m0, s42, 131072
    s_bfe_u32 s46, s43, 0x30010
    v_mfma_f32_32x32x16_bf16 v[176:191], a[8:11], v[68:71], v[176:191]
    ds_read_b64_tr_b16 v[64:65], v11 offset:49152
    ds_read_b64_tr_b16 v[66:67], v11 offset:49664
    ds_read_b128 a[44:47], v18 offset:32768
    ds_read_b64_tr_b16 v[192:193], v237 offset:0
    s_lshl_b32 s46, s46, 7
    s_waitcnt lgkmcnt(15)
    v_mfma_f32_32x32x16_bf16 v[96:111], v[72:75], a[12:15], v[96:111]
    ds_read_b64_tr_b16 v[68:69], v12 offset:49152
    ds_read_b64_tr_b16 v[70:71], v12 offset:49664
    ds_read_b64_tr_b16 v[194:195], v237 offset:512
    ds_read_b64_tr_b16 v[196:197], v237 offset:4096
    s_waitcnt vmcnt(6)
    v_readfirstlane_b32 s45, v21
    v_mfma_f32_32x32x16_bf16 a[160:175], v[224:227], v[208:211], 0
    ds_read_b64_tr_b16 v[198:199], v237 offset:4608
    ds_read_b64_tr_b16 v[200:201], v237 offset:8192
    ds_read_b64_tr_b16 v[202:203], v237 offset:8704
    ds_read_b64_tr_b16 v[204:205], v237 offset:12288
    ds_read_b64_tr_b16 v[206:207], v237 offset:12800
    s_cmp_eq_u32 s45, 0
    s_cbranch_scc1 parallel_sum__sliding_block__glu_gated_bilinear__prompt_kernel_rnO
parallel_sum__sliding_block__glu_gated_bilinear__prompt_kernel_rnrO:
    v_mfma_f32_32x32x16_bf16 v[112:127], v[76:79], a[12:15], v[112:127]
    ds_read_b64_tr_b16 v[72:73], v11 offset:57344
    ds_read_b64_tr_b16 v[74:75], v11 offset:57856
    buffer_load_dwordx4 v7, s[4:7], s46 offen offset:0 lds
    s_waitcnt lgkmcnt(15)
    v_mfma_f32_32x32x16_bf16 v[128:143], a[12:15], v[80:83], v[128:143]
    ds_read_b64_tr_b16 v[76:77], v12 offset:57344
    ds_read_b64_tr_b16 v[78:79], v12 offset:57856
    v_mov_b32 v219, v21
    v_mov_b32 v231, v21
    v_mfma_f32_32x32x16_bf16 a[160:175], v[224:227], v[212:215], a[160:175]
    buffer_load_dwordx4 v8, s[4:7], s46 offen offset:1024 lds
    s_add_u32 s46, s46, 14336
    v_mfma_f32_32x32x16_bf16 v[144:159], a[12:15], v[84:87], v[144:159]
    ds_read_b64_tr_b16 v[80:81], v11 offset:59392
    ds_read_b64_tr_b16 v[82:83], v11 offset:59904
    s_mov_b32 exec_lo, 1
    s_mov_b32 exec_hi, 1
    buffer_store_dwordx4 v[216:219], v245, s[20:23], s51 offen sc1
    s_mov_b64 exec, -1
    v_mfma_f32_32x32x16_bf16 v[160:175], a[12:15], v[88:91], v[160:175]
    ds_read_b64_tr_b16 v[84:85], v12 offset:59392
    ds_read_b64_tr_b16 v[86:87], v12 offset:59904
    buffer_load_dwordx4 v7, s[4:7], s46 offen offset:2048 lds
    v_mfma_f32_32x32x16_bf16 v[176:191], a[12:15], v[92:95], v[176:191]
    ds_read_b64_tr_b16 v[88:89], v11 offset:51200
    ds_read_b64_tr_b16 v[90:91], v11 offset:51712
    s_waitcnt lgkmcnt(15)
    v_mfma_f32_32x32x16_bf16 v[96:111], v[64:67], a[32:35], v[96:111]
    ds_read_b64_tr_b16 v[92:93], v12 offset:51200
    ds_read_b64_tr_b16 v[94:95], v12 offset:51712
    buffer_load_dwordx4 v8, s[4:7], s46 offen offset:3072 lds
    s_add_u32 m0, s41, 0
    v_mfma_f32_32x32x16_bf16 v[112:127], v[68:71], a[32:35], v[112:127]
    ds_read_b64_tr_b16 v[64:65], v11 offset:61440
    ds_read_b64_tr_b16 v[66:67], v11 offset:61952
    s_bfe_u32 s48, s43, 0x30010
    s_mul_i32 s47, s48, 196608
    s_waitcnt lgkmcnt(10)
    v_mfma_f32_32x32x16_bf16 v[128:143], a[32:35], v[72:75], v[128:143]
    ds_read_b64_tr_b16 v[68:69], v12 offset:61440
    ds_read_b64_tr_b16 v[70:71], v12 offset:61952
    buffer_load_dwordx4 v3, s[16:19], s47 offen offset:0 lds
    v_mfma_f32_32x32x16_bf16 v[144:159], a[32:35], v[76:79], v[144:159]
    ds_read_b64_tr_b16 v[72:73], v11 offset:63488
    ds_read_b64_tr_b16 v[74:75], v11 offset:64000
    s_waitcnt lgkmcnt(10)
    v_mfma_f32_32x32x16_bf16 v[160:175], a[32:35], v[80:83], v[160:175]
    ds_read_b64_tr_b16 v[76:77], v12 offset:63488
    ds_read_b64_tr_b16 v[78:79], v12 offset:64000
    buffer_load_dwordx4 v4, s[16:19], s47 offen offset:1024 lds
    s_branch parallel_sum__sliding_block__glu_gated_bilinear__prompt_kernel_ws3
parallel_sum__sliding_block__glu_gated_bilinear__prompt_kernel_w2O1_0:
    s_branch parallel_sum__sliding_block__glu_gated_bilinear__prompt_kernel_wr2O
parallel_sum__sliding_block__glu_gated_bilinear__prompt_kernel_ws3:
    s_add_u32 m0, s42, 7296
    v_mfma_f32_32x32x16_bf16 v[176:191], a[32:35], v[84:87], v[176:191]
    ds_read_b64_tr_b16 v[80:81], v11 offset:53248
    ds_read_b64_tr_b16 v[82:83], v11 offset:53760
    s_waitcnt lgkmcnt(10)
    v_mfma_f32_32x32x16_bf16 v[96:111], v[88:91], a[36:39], v[96:111]
    ds_read_b64_tr_b16 v[84:85], v12 offset:53248
    ds_read_b64_tr_b16 v[86:87], v12 offset:53760
    buffer_load_dwordx4 v3, s[16:19], s47 offen offset:896 lds
    v_mfma_f32_32x32x16_bf16 v[112:127], v[92:95], a[36:39], v[112:127]
    ds_read_b64_tr_b16 v[88:89], v13 offset:0
    ds_read_b64_tr_b16 v[90:91], v13 offset:512
    s_waitcnt lgkmcnt(10)
    v_mfma_f32_32x32x16_bf16 v[128:143], a[36:39], v[64:67], v[128:143]
    ds_read_b64_tr_b16 v[92:93], v14 offset:0
    ds_read_b64_tr_b16 v[94:95], v14 offset:512
    buffer_load_dwordx4 v4, s[16:19], s47 offen offset:1920 lds
    s_add_u32 m0, s42, 9216
    v_mfma_f32_32x32x16_bf16 a[144:159], v[224:227], v[192:195], 0
    v_mfma_f32_32x32x16_bf16 v[144:159], a[36:39], v[68:71], v[144:159]
    ds_read_b64_tr_b16 v[64:65], v13 offset:2048
    ds_read_b64_tr_b16 v[66:67], v13 offset:2560
    buffer_load_dwordx4 v3, s[16:19], s47 offen offset:1024 lds
    s_waitcnt lgkmcnt(10)
    v_mfma_f32_32x32x16_bf16 v[160:175], a[36:39], v[72:75], v[160:175]
    ds_read_b64_tr_b16 v[68:69], v14 offset:2048
    ds_read_b64_tr_b16 v[70:71], v14 offset:2560
    v_mfma_f32_32x32x16_bf16 a[144:159], v[224:227], v[196:199], a[144:159]
    buffer_load_dwordx4 v4, s[16:19], s47 offen offset:2048 lds
    s_add_u32 m0, s42, 147456
    s_bfe_u32 s46, s43, 0x30014
    s_lshl_b32 s46, s46, 7
    v_mfma_f32_32x32x16_bf16 v[176:191], a[36:39], v[76:79], v[176:191]
    ds_read_b64_tr_b16 v[72:73], v11 offset:55296
    ds_read_b64_tr_b16 v[74:75], v11 offset:55808
    s_waitcnt lgkmcnt(10)
    v_mfma_f32_32x32x16_bf16 v[96:111], v[80:83], a[40:43], v[96:111]
    ds_read_b64_tr_b16 v[76:77], v12 offset:55296
    ds_read_b64_tr_b16 v[78:79], v12 offset:55808
    buffer_load_dwordx4 v7, s[4:7], s46 offen offset:0 lds
    v_mfma_f32_32x32x16_bf16 a[144:159], v[224:227], v[200:203], a[144:159]
    v_mfma_f32_32x32x16_bf16 v[112:127], v[84:87], a[40:43], v[112:127]
    ds_read_b64_tr_b16 v[80:81], v13 offset:4096
    ds_read_b64_tr_b16 v[82:83], v13 offset:4608
    buffer_load_dwordx4 v8, s[4:7], s46 offen offset:1024 lds
    s_add_u32 s46, s46, 14336
    s_waitcnt lgkmcnt(10)
    v_mfma_f32_32x32x16_bf16 v[128:143], a[40:43], v[88:91], v[128:143]
    ds_read_b64_tr_b16 v[84:85], v14 offset:4096
    ds_read_b64_tr_b16 v[86:87], v14 offset:4608
    v_mfma_f32_32x32x16_bf16 a[144:159], v[224:227], v[204:207], a[144:159]
    buffer_load_dwordx4 v7, s[4:7], s46 offen offset:2048 lds
    v_mfma_f32_32x32x16_bf16 v[144:159], a[40:43], v[92:95], v[144:159]
    ds_read_b64_tr_b16 v[88:89], v13 offset:6144
    ds_read_b64_tr_b16 v[90:91], v13 offset:6656
    s_waitcnt lgkmcnt(10)
    v_mfma_f32_32x32x16_bf16 v[160:175], a[40:43], v[64:67], v[160:175]
    ds_read_b64_tr_b16 v[92:93], v14 offset:6144
    ds_read_b64_tr_b16 v[94:95], v14 offset:6656
    buffer_load_dwordx4 v8, s[4:7], s46 offen offset:3072 lds
    s_waitcnt vmcnt(10)
    s_barrier
    v_mfma_f32_32x32x16_bf16 v[176:191], a[40:43], v[68:71], v[176:191]
    ds_read_b64_tr_b16 v[64:65], v13 offset:8192
    ds_read_b64_tr_b16 v[66:67], v13 offset:8704
    ds_read_b128 a[48:51], v15 offset:0
    ds_read_b128 a[52:55], v16 offset:0
    s_add_u32 m0, s41, 24576
    s_bfe_u32 s48, s43, 0x30014
    s_waitcnt lgkmcnt(12)
    v_mfma_f32_32x32x16_bf16 v[96:111], v[72:75], a[44:47], v[96:111]
    ds_read_b64_tr_b16 v[68:69], v14 offset:8192
    ds_read_b64_tr_b16 v[70:71], v14 offset:8704
    ds_read_b128 a[56:59], v17 offset:0
    s_mul_i32 s47, s48, 196608
    v_accvgpr_read_b32 v228, a128
    v_mfma_f32_32x32x16_bf16 v[112:127], v[76:79], a[44:47], v[112:127]
    ds_read_b64_tr_b16 v[72:73], v13 offset:16384
    ds_read_b64_tr_b16 v[74:75], v13 offset:16896
    ds_read_b128 a[60:63], v18 offset:0
    ds_read_b128 a[64:67], v15 offset:16384
    v_accvgpr_read_b32 v229, a144
    v_accvgpr_read_b32 v230, a160
    s_waitcnt lgkmcnt(15)
    v_mfma_f32_32x32x16_bf16 v[128:143], a[44:47], v[80:83], v[128:143]
    ds_read_b64_tr_b16 v[76:77], v14 offset:16384
    ds_read_b64_tr_b16 v[78:79], v14 offset:16896
    ds_read_b128 a[68:71], v16 offset:16384
    v_mfma_f32_32x32x16_bf16 v[144:159], a[44:47], v[84:87], v[144:159]
    ds_read_b64_tr_b16 v[80:81], v13 offset:18432
    ds_read_b64_tr_b16 v[82:83], v13 offset:18944
    ds_read_b128 a[72:75], v17 offset:16384
    ds_read_b128 a[76:79], v18 offset:16384
    s_waitcnt lgkmcnt(15)
    v_mfma_f32_32x32x16_bf16 v[160:175], a[44:47], v[88:91], v[160:175]
    ds_read_b64_tr_b16 v[84:85], v14 offset:18432
    ds_read_b64_tr_b16 v[86:87], v14 offset:18944
    buffer_load_dwordx4 v3, s[16:19], s47 offen offset:0 lds
    v_mfma_f32_32x32x16_bf16 v[176:191], a[44:47], v[92:95], v[176:191]
    ds_read_b64_tr_b16 v[88:89], v13 offset:10240
    ds_read_b64_tr_b16 v[90:91], v13 offset:10752
    buffer_store_dwordx4 v[228:231], v242, s[20:23], s52 offen sc1
    s_waitcnt lgkmcnt(12)
    v_mfma_f32_32x32x16_bf16 v[96:111], v[64:67], a[48:51], v[96:111]
    ds_read_b64_tr_b16 v[92:93], v14 offset:10240
    ds_read_b64_tr_b16 v[94:95], v14 offset:10752
    buffer_load_dwordx4 v4, s[16:19], s47 offen offset:1024 lds
    s_add_u32 m0, s42, 31872
    v_mfma_f32_32x32x16_bf16 v[112:127], v[68:71], a[48:51], v[112:127]
    ds_read_b64_tr_b16 v[64:65], v13 offset:20480
    ds_read_b64_tr_b16 v[66:67], v13 offset:20992
    s_waitcnt lgkmcnt(13)
    v_mfma_f32_32x32x16_bf16 v[128:143], a[48:51], v[72:75], v[128:143]
    ds_read_b64_tr_b16 v[68:69], v14 offset:20480
    ds_read_b64_tr_b16 v[70:71], v14 offset:20992
    buffer_load_dwordx4 v3, s[16:19], s47 offen offset:896 lds
    v_mfma_f32_32x32x16_bf16 v[144:159], a[48:51], v[76:79], v[144:159]
    ds_read_b64_tr_b16 v[72:73], v13 offset:22528
    ds_read_b64_tr_b16 v[74:75], v13 offset:23040
    s_waitcnt lgkmcnt(10)
    v_mfma_f32_32x32x16_bf16 v[160:175], a[48:51], v[80:83], v[160:175]
    ds_read_b64_tr_b16 v[76:77], v14 offset:22528
    ds_read_b64_tr_b16 v[78:79], v14 offset:23040
    buffer_load_dwordx4 v4, s[16:19], s47 offen offset:1920 lds
    s_add_u32 m0, s42, 33792
    v_mfma_f32_32x32x16_bf16 v[176:191], a[48:51], v[84:87], v[176:191]
    ds_read_b64_tr_b16 v[80:81], v13 offset:12288
    ds_read_b64_tr_b16 v[82:83], v13 offset:12800
    s_waitcnt lgkmcnt(10)
    v_mfma_f32_32x32x16_bf16 v[96:111], v[88:91], a[52:55], v[96:111]
    ds_read_b64_tr_b16 v[84:85], v14 offset:12288
    ds_read_b64_tr_b16 v[86:87], v14 offset:12800
    buffer_load_dwordx4 v3, s[16:19], s47 offen offset:1024 lds
    v_mfma_f32_32x32x16_bf16 v[112:127], v[92:95], a[52:55], v[112:127]
    ds_read_b64_tr_b16 v[88:89], v13 offset:24576
    ds_read_b64_tr_b16 v[90:91], v13 offset:25088
    s_waitcnt lgkmcnt(10)
    v_mfma_f32_32x32x16_bf16 v[128:143], a[52:55], v[64:67], v[128:143]
    ds_read_b64_tr_b16 v[92:93], v14 offset:24576
    ds_read_b64_tr_b16 v[94:95], v14 offset:25088
    buffer_load_dwordx4 v4, s[16:19], s47 offen offset:2048 lds
    s_add_u32 m0, s42, 114688
    v_mfma_f32_32x32x16_bf16 v[144:159], a[52:55], v[68:71], v[144:159]
    ds_read_b64_tr_b16 v[64:65], v13 offset:26624
    ds_read_b64_tr_b16 v[66:67], v13 offset:27136
    s_bfe_u32 s46, s43, 0x30018
    s_lshl_b32 s46, s46, 7
    s_waitcnt lgkmcnt(10)
    v_mfma_f32_32x32x16_bf16 v[160:175], a[52:55], v[72:75], v[160:175]
    ds_read_b64_tr_b16 v[68:69], v14 offset:26624
    ds_read_b64_tr_b16 v[70:71], v14 offset:27136
    buffer_load_dwordx4 v7, s[4:7], s46 offen offset:0 lds
    v_mfma_f32_32x32x16_bf16 v[176:191], a[52:55], v[76:79], v[176:191]
    ds_read_b64_tr_b16 v[72:73], v13 offset:14336
    ds_read_b64_tr_b16 v[74:75], v13 offset:14848
    s_waitcnt lgkmcnt(10)
    v_mfma_f32_32x32x16_bf16 v[96:111], v[80:83], a[56:59], v[96:111]
    ds_read_b64_tr_b16 v[76:77], v14 offset:14336
    ds_read_b64_tr_b16 v[78:79], v14 offset:14848
    buffer_load_dwordx4 v8, s[4:7], s46 offen offset:1024 lds
    s_add_u32 s46, s46, 14336
    v_mfma_f32_32x32x16_bf16 v[112:127], v[84:87], a[56:59], v[112:127]
    ds_read_b64_tr_b16 v[80:81], v13 offset:28672
    ds_read_b64_tr_b16 v[82:83], v13 offset:29184
    s_waitcnt lgkmcnt(10)
    v_mfma_f32_32x32x16_bf16 v[128:143], a[56:59], v[88:91], v[128:143]
    ds_read_b64_tr_b16 v[84:85], v14 offset:28672
    ds_read_b64_tr_b16 v[86:87], v14 offset:29184
    buffer_load_dwordx4 v7, s[4:7], s46 offen offset:2048 lds
    v_mfma_f32_32x32x16_bf16 v[144:159], a[56:59], v[92:95], v[144:159]
    ds_read_b64_tr_b16 v[88:89], v13 offset:30720
    ds_read_b64_tr_b16 v[90:91], v13 offset:31232
    s_waitcnt lgkmcnt(10)
    v_mfma_f32_32x32x16_bf16 v[160:175], a[56:59], v[64:67], v[160:175]
    ds_read_b64_tr_b16 v[92:93], v14 offset:30720
    ds_read_b64_tr_b16 v[94:95], v14 offset:31232
    buffer_load_dwordx4 v8, s[4:7], s46 offen offset:3072 lds
    s_waitcnt vmcnt(11)
    s_barrier
    v_mfma_f32_32x32x16_bf16 v[176:191], a[56:59], v[68:71], v[176:191]
    ds_read_b64_tr_b16 v[64:65], v11 offset:0
    ds_read_b64_tr_b16 v[66:67], v11 offset:512
    ds_read_b128 a[80:83], v15 offset:32768
    ds_read_b128 a[84:87], v16 offset:32768
    s_add_u32 m0, s41, 49152
    s_bfe_u32 s48, s43, 0x30018
    s_waitcnt lgkmcnt(12)
    v_mfma_f32_32x32x16_bf16 v[96:111], v[72:75], a[60:63], v[96:111]
    ds_read_b64_tr_b16 v[68:69], v12 offset:0
    ds_read_b64_tr_b16 v[70:71], v12 offset:512
    ds_read_b128 a[88:91], v17 offset:32768
    s_mul_i32 s47, s48, 196608
    v_mfma_f32_32x32x16_bf16 v[112:127], v[76:79], a[60:63], v[112:127]
    ds_read_b64_tr_b16 v[72:73], v11 offset:8192
    ds_read_b64_tr_b16 v[74:75], v11 offset:8704
    ds_read_b128 a[92:95], v18 offset:32768
    buffer_load_dwordx4 v3, s[16:19], s47 offen offset:0 lds
    s_waitcnt lgkmcnt(14)
    v_mfma_f32_32x32x16_bf16 v[128:143], a[60:63], v[80:83], v[128:143]
    ds_read_b64_tr_b16 v[76:77], v12 offset:8192
    ds_read_b64_tr_b16 v[78:79], v12 offset:8704
    v_mfma_f32_32x32x16_bf16 v[144:159], a[60:63], v[84:87], v[144:159]
    ds_read_b64_tr_b16 v[80:81], v11 offset:10240
    ds_read_b64_tr_b16 v[82:83], v11 offset:10752
    buffer_load_dwordx4 v4, s[16:19], s47 offen offset:1024 lds
    s_add_u32 m0, s42, 56448
    s_waitcnt lgkmcnt(14)
    v_mfma_f32_32x32x16_bf16 v[160:175], a[60:63], v[88:91], v[160:175]
    ds_read_b64_tr_b16 v[84:85], v12 offset:10240
    ds_read_b64_tr_b16 v[86:87], v12 offset:10752
    v_mfma_f32_32x32x16_bf16 v[176:191], a[60:63], v[92:95], v[176:191]
    ds_read_b64_tr_b16 v[88:89], v11 offset:2048
    ds_read_b64_tr_b16 v[90:91], v11 offset:2560
    buffer_load_dwordx4 v3, s[16:19], s47 offen offset:896 lds
    s_waitcnt lgkmcnt(12)
    v_mfma_f32_32x32x16_bf16 v[96:111], v[64:67], a[64:67], v[96:111]
    ds_read_b64_tr_b16 v[92:93], v12 offset:2048
    ds_read_b64_tr_b16 v[94:95], v12 offset:2560
    v_mfma_f32_32x32x16_bf16 v[112:127], v[68:71], a[64:67], v[112:127]
    ds_read_b64_tr_b16 v[64:65], v11 offset:12288
    ds_read_b64_tr_b16 v[66:67], v11 offset:12800
    buffer_load_dwordx4 v4, s[16:19], s47 offen offset:1920 lds
    s_add_u32 m0, s42, 58368
    s_waitcnt lgkmcnt(10)
    v_mfma_f32_32x32x16_bf16 v[128:143], a[64:67], v[72:75], v[128:143]
    ds_read_b64_tr_b16 v[68:69], v12 offset:12288
    ds_read_b64_tr_b16 v[70:71], v12 offset:12800
    v_mfma_f32_32x32x16_bf16 v[144:159], a[64:67], v[76:79], v[144:159]
    ds_read_b64_tr_b16 v[72:73], v11 offset:14336
    ds_read_b64_tr_b16 v[74:75], v11 offset:14848
    buffer_load_dwordx4 v3, s[16:19], s47 offen offset:1024 lds
    s_waitcnt lgkmcnt(10)
    v_mfma_f32_32x32x16_bf16 v[160:175], a[64:67], v[80:83], v[160:175]
    ds_read_b64_tr_b16 v[76:77], v12 offset:14336
    ds_read_b64_tr_b16 v[78:79], v12 offset:14848
    v_mfma_f32_32x32x16_bf16 v[176:191], a[64:67], v[84:87], v[176:191]
    ds_read_b64_tr_b16 v[80:81], v11 offset:4096
    ds_read_b64_tr_b16 v[82:83], v11 offset:4608
    buffer_load_dwordx4 v4, s[16:19], s47 offen offset:2048 lds
    s_add_u32 m0, s42, 131072
    s_bfe_u32 s46, s43, 0x3001c
    s_waitcnt lgkmcnt(10)
    v_mfma_f32_32x32x16_bf16 v[96:111], v[88:91], a[68:71], v[96:111]
    ds_read_b64_tr_b16 v[84:85], v12 offset:4096
    ds_read_b64_tr_b16 v[86:87], v12 offset:4608
    s_lshl_b32 s46, s46, 7
    v_mfma_f32_32x32x16_bf16 v[112:127], v[92:95], a[68:71], v[112:127]
    ds_read_b64_tr_b16 v[88:89], v11 offset:16384
    ds_read_b64_tr_b16 v[90:91], v11 offset:16896
    buffer_load_dwordx4 v7, s[4:7], s46 offen offset:0 lds
    s_waitcnt lgkmcnt(10)
    v_mfma_f32_32x32x16_bf16 v[128:143], a[68:71], v[64:67], v[128:143]
    ds_read_b64_tr_b16 v[92:93], v12 offset:16384
    ds_read_b64_tr_b16 v[94:95], v12 offset:16896
    v_mfma_f32_32x32x16_bf16 v[144:159], a[68:71], v[68:71], v[144:159]
    ds_read_b64_tr_b16 v[64:65], v11 offset:18432
    ds_read_b64_tr_b16 v[66:67], v11 offset:18944
    buffer_load_dwordx4 v8, s[4:7], s46 offen offset:1024 lds
    s_add_u32 s46, s46, 14336
    s_waitcnt lgkmcnt(10)
    v_mfma_f32_32x32x16_bf16 v[160:175], a[68:71], v[72:75], v[160:175]
    ds_read_b64_tr_b16 v[68:69], v12 offset:18432
    ds_read_b64_tr_b16 v[70:71], v12 offset:18944
    v_mfma_f32_32x32x16_bf16 v[176:191], a[68:71], v[76:79], v[176:191]
    ds_read_b64_tr_b16 v[72:73], v11 offset:6144
    ds_read_b64_tr_b16 v[74:75], v11 offset:6656
    buffer_load_dwordx4 v7, s[4:7], s46 offen offset:2048 lds
    s_waitcnt lgkmcnt(10)
    v_mfma_f32_32x32x16_bf16 v[96:111], v[80:83], a[72:75], v[96:111]
    ds_read_b64_tr_b16 v[76:77], v12 offset:6144
    ds_read_b64_tr_b16 v[78:79], v12 offset:6656
    v_mfma_f32_32x32x16_bf16 v[112:127], v[84:87], a[72:75], v[112:127]
    ds_read_b64_tr_b16 v[80:81], v11 offset:20480
    ds_read_b64_tr_b16 v[82:83], v11 offset:20992
    buffer_load_dwordx4 v8, s[4:7], s46 offen offset:3072 lds
    s_waitcnt lgkmcnt(10)
    v_mfma_f32_32x32x16_bf16 v[128:143], a[72:75], v[88:91], v[128:143]
    ds_read_b64_tr_b16 v[84:85], v12 offset:20480
    ds_read_b64_tr_b16 v[86:87], v12 offset:20992
    v_add_u32 v7, 14336, v9
    v_add_u32 v8, 14336, v10
    v_mfma_f32_32x32x16_bf16 v[144:159], a[72:75], v[92:95], v[144:159]
    ds_read_b64_tr_b16 v[88:89], v11 offset:22528
    ds_read_b64_tr_b16 v[90:91], v11 offset:23040
    buffer_store_dwordx4 v[220:223], v2, s[20:23], s50 offen sc1
    s_waitcnt lgkmcnt(10)
    v_mfma_f32_32x32x16_bf16 v[160:175], a[72:75], v[64:67], v[160:175]
    ds_read_b64_tr_b16 v[92:93], v12 offset:22528
    ds_read_b64_tr_b16 v[94:95], v12 offset:23040
    s_waitcnt vmcnt(11)
    s_barrier
    v_mfma_f32_32x32x16_bf16 v[176:191], a[72:75], v[68:71], v[176:191]
    ds_read_b64_tr_b16 v[64:65], v11 offset:24576
    ds_read_b64_tr_b16 v[66:67], v11 offset:25088
    ds_read_b128 a[96:99], v15 offset:0
    ds_read_b128 a[100:103], v16 offset:0
    s_waitcnt lgkmcnt(12)
    v_mfma_f32_32x32x16_bf16 v[96:111], v[72:75], a[76:79], v[96:111]
    ds_read_b64_tr_b16 v[68:69], v12 offset:24576
    ds_read_b64_tr_b16 v[70:71], v12 offset:25088
    ds_read_b128 a[104:107], v17 offset:0
    v_mfma_f32_32x32x16_bf16 v[112:127], v[76:79], a[76:79], v[112:127]
    ds_read_b64_tr_b16 v[72:73], v11 offset:32768
    ds_read_b64_tr_b16 v[74:75], v11 offset:33280
    ds_read_b128 a[108:111], v18 offset:0
    buffer_load_dwordx4 v[232:235], v242, s[20:23], s54 offen sc1
    s_waitcnt lgkmcnt(14)
    v_mfma_f32_32x32x16_bf16 v[128:143], a[76:79], v[80:83], v[128:143]
    ds_read_b64_tr_b16 v[76:77], v12 offset:32768
    ds_read_b64_tr_b16 v[78:79], v12 offset:33280
    buffer_store_dwordx4 v[220:223], v2, s[20:23], s50 offen offset:1024 sc1
    v_mfma_f32_32x32x16_bf16 v[144:159], a[76:79], v[84:87], v[144:159]
    ds_read_b64_tr_b16 v[80:81], v11 offset:34816
    ds_read_b64_tr_b16 v[82:83], v11 offset:35328
    s_add_u32 m0, s41, 73728
    s_bfe_u32 s48, s43, 0x3001c
    s_mul_i32 s47, s48, 196608
    s_waitcnt lgkmcnt(14)
    v_mfma_f32_32x32x16_bf16 v[160:175], a[76:79], v[88:91], v[160:175]
    ds_read_b64_tr_b16 v[84:85], v12 offset:34816
    ds_read_b64_tr_b16 v[86:87], v12 offset:35328
    buffer_load_dwordx4 v3, s[16:19], s47 offen offset:0 lds
    v_mfma_f32_32x32x16_bf16 v[176:191], a[76:79], v[92:95], v[176:191]
    ds_read_b64_tr_b16 v[88:89], v11 offset:26624
    ds_read_b64_tr_b16 v[90:91], v11 offset:27136
    buffer_load_dwordx4 v[192:195], v2, s[20:23], s53 offen offset:0 sc1
    s_waitcnt lgkmcnt(12)
    v_mfma_f32_32x32x16_bf16 v[96:111], v[64:67], a[80:83], v[96:111]
    ds_read_b64_tr_b16 v[92:93], v12 offset:26624
    ds_read_b64_tr_b16 v[94:95], v12 offset:27136
    buffer_load_dwordx4 v4, s[16:19], s47 offen offset:1024 lds
    s_add_u32 m0, s42, 81024
    v_mfma_f32_32x32x16_bf16 v[112:127], v[68:71], a[80:83], v[112:127]
    ds_read_b64_tr_b16 v[64:65], v11 offset:36864
    ds_read_b64_tr_b16 v[66:67], v11 offset:37376
    buffer_load_dwordx4 v[196:199], v2, s[20:23], s53 offen offset:1024 sc1
    s_waitcnt lgkmcnt(10)
    v_mfma_f32_32x32x16_bf16 v[128:143], a[80:83], v[72:75], v[128:143]
    ds_read_b64_tr_b16 v[68:69], v12 offset:36864
    ds_read_b64_tr_b16 v[70:71], v12 offset:37376
    buffer_load_dwordx4 v3, s[16:19], s47 offen offset:896 lds
    v_mfma_f32_32x32x16_bf16 v[144:159], a[80:83], v[76:79], v[144:159]
    ds_read_b64_tr_b16 v[72:73], v11 offset:38912
    ds_read_b64_tr_b16 v[74:75], v11 offset:39424
    buffer_load_dwordx4 v[200:203], v2, s[20:23], s53 offen offset:2048 sc1
    s_waitcnt lgkmcnt(10)
    v_mfma_f32_32x32x16_bf16 v[160:175], a[80:83], v[80:83], v[160:175]
    ds_read_b64_tr_b16 v[76:77], v12 offset:38912
    ds_read_b64_tr_b16 v[78:79], v12 offset:39424
    buffer_load_dwordx4 v4, s[16:19], s47 offen offset:1920 lds
    s_add_u32 m0, s42, 82944
    v_mfma_f32_32x32x16_bf16 v[176:191], a[80:83], v[84:87], v[176:191]
    ds_read_b64_tr_b16 v[80:81], v11 offset:28672
    ds_read_b64_tr_b16 v[82:83], v11 offset:29184
    buffer_load_dwordx4 v[204:207], v2, s[20:23], s53 offen offset:3072 sc1
    s_waitcnt lgkmcnt(10)
    v_mfma_f32_32x32x16_bf16 v[96:111], v[88:91], a[84:87], v[96:111]
    ds_read_b64_tr_b16 v[84:85], v12 offset:28672
    ds_read_b64_tr_b16 v[86:87], v12 offset:29184
    buffer_load_dwordx4 v3, s[16:19], s47 offen offset:1024 lds
    v_mfma_f32_32x32x16_bf16 v[112:127], v[92:95], a[84:87], v[112:127]
    ds_read_b64_tr_b16 v[88:89], v11 offset:40960
    ds_read_b64_tr_b16 v[90:91], v11 offset:41472
    s_waitcnt lgkmcnt(10)
    v_mfma_f32_32x32x16_bf16 v[128:143], a[84:87], v[64:67], v[128:143]
    ds_read_b64_tr_b16 v[92:93], v12 offset:40960
    ds_read_b64_tr_b16 v[94:95], v12 offset:41472
    buffer_load_dwordx4 v4, s[16:19], s47 offen offset:2048 lds
    s_add_u32 m0, s42, 114688
    v_mfma_f32_32x32x16_bf16 v[144:159], a[84:87], v[68:71], v[144:159]
    ds_read_b64_tr_b16 v[64:65], v11 offset:43008
    ds_read_b64_tr_b16 v[66:67], v11 offset:43520
    s_bfe_u32 s49, s44, 0x30000
    s_lshl_b32 s49, s49, 16
    s_add_u32 s49, s49, s59
    s_waitcnt lgkmcnt(10)
    v_mfma_f32_32x32x16_bf16 v[160:175], a[84:87], v[72:75], v[160:175]
    ds_read_b64_tr_b16 v[68:69], v12 offset:43008
    ds_read_b64_tr_b16 v[70:71], v12 offset:43520
    buffer_load_dwordx4 v9, s[24:27], s49 offen offset:0 lds
    v_mfma_f32_32x32x16_bf16 v[176:191], a[84:87], v[76:79], v[176:191]
    ds_read_b64_tr_b16 v[72:73], v11 offset:30720
    ds_read_b64_tr_b16 v[74:75], v11 offset:31232
    v_subrev_u32 v3, 114688, v19
    v_subrev_u32 v4, 114688, v20
    s_waitcnt lgkmcnt(10)
    v_mfma_f32_32x32x16_bf16 v[96:111], v[80:83], a[88:91], v[96:111]
    ds_read_b64_tr_b16 v[76:77], v12 offset:30720
    ds_read_b64_tr_b16 v[78:79], v12 offset:31232
    buffer_load_dwordx4 v10, s[24:27], s49 offen offset:1024 lds
    v_mfma_f32_32x32x16_bf16 v[112:127], v[84:87], a[88:91], v[112:127]
    ds_read_b64_tr_b16 v[80:81], v11 offset:45056
    ds_read_b64_tr_b16 v[82:83], v11 offset:45568
    s_waitcnt lgkmcnt(10)
    v_mfma_f32_32x32x16_bf16 v[128:143], a[88:91], v[88:91], v[128:143]
    ds_read_b64_tr_b16 v[84:85], v12 offset:45056
    ds_read_b64_tr_b16 v[86:87], v12 offset:45568
    buffer_load_dwordx4 v7, s[24:27], s49 offen offset:2048 lds
    v_mfma_f32_32x32x16_bf16 v[144:159], a[88:91], v[92:95], v[144:159]
    ds_read_b64_tr_b16 v[88:89], v11 offset:47104
    ds_read_b64_tr_b16 v[90:91], v11 offset:47616
    s_waitcnt lgkmcnt(10)
    v_mfma_f32_32x32x16_bf16 v[160:175], a[88:91], v[64:67], v[160:175]
    ds_read_b64_tr_b16 v[92:93], v12 offset:47104
    ds_read_b64_tr_b16 v[94:95], v12 offset:47616
    buffer_load_dwordx4 v8, s[24:27], s49 offen offset:3072 lds
    s_waitcnt vmcnt(17)
    s_barrier
    v_mfma_f32_32x32x16_bf16 v[176:191], a[88:91], v[68:71], v[176:191]
    ds_read_b64_tr_b16 v[64:65], v11 offset:49152
    ds_read_b64_tr_b16 v[66:67], v11 offset:49664
    ds_read_b128 a[112:115], v15 offset:16384
    ds_read_b128 a[116:119], v16 offset:16384
    v_add_u32 v5, 384, v5
    v_add_u32 v6, 384, v6
    s_waitcnt lgkmcnt(12)
    v_mfma_f32_32x32x16_bf16 v[96:111], v[72:75], a[92:95], v[96:111]
    ds_read_b64_tr_b16 v[68:69], v12 offset:49152
    ds_read_b64_tr_b16 v[70:71], v12 offset:49664
    ds_read_b128 a[120:123], v17 offset:16384
    s_add_u32 m0, s42, 0
    s_bfe_u32 s48, s43, 0x30000
    v_mfma_f32_32x32x16_bf16 v[112:127], v[76:79], a[92:95], v[112:127]
    ds_read_b64_tr_b16 v[72:73], v11 offset:57344
    ds_read_b64_tr_b16 v[74:75], v11 offset:57856
    ds_read_b128 a[124:127], v18 offset:16384
    s_mul_i32 s48, s48, 229376
    s_waitcnt lgkmcnt(14)
    v_mfma_f32_32x32x16_bf16 v[128:143], a[92:95], v[80:83], v[128:143]
    ds_read_b64_tr_b16 v[76:77], v12 offset:57344
    ds_read_b64_tr_b16 v[78:79], v12 offset:57856
    buffer_load_dwordx4 v5, s[8:11], s48 offen offset:0 lds
    v_mfma_f32_32x32x16_bf16 v[144:159], a[92:95], v[84:87], v[144:159]
    ds_read_b64_tr_b16 v[80:81], v11 offset:59392
    ds_read_b64_tr_b16 v[82:83], v11 offset:59904
    s_waitcnt lgkmcnt(14)
    v_mfma_f32_32x32x16_bf16 v[160:175], a[92:95], v[88:91], v[160:175]
    ds_read_b64_tr_b16 v[84:85], v12 offset:59392
    ds_read_b64_tr_b16 v[86:87], v12 offset:59904
    buffer_load_dwordx4 v6, s[8:11], s48 offen offset:1024 lds
    v_mfma_f32_32x32x16_bf16 v[176:191], a[92:95], v[92:95], v[176:191]
    ds_read_b64_tr_b16 v[88:89], v11 offset:51200
    ds_read_b64_tr_b16 v[90:91], v11 offset:51712
    s_waitcnt lgkmcnt(12)
    v_mfma_f32_32x32x16_bf16 v[96:111], v[64:67], a[96:99], v[96:111]
    ds_read_b64_tr_b16 v[92:93], v12 offset:51200
    ds_read_b64_tr_b16 v[94:95], v12 offset:51712
    buffer_load_dwordx4 v5, s[12:15], s48 offen offset:2048 lds
    v_mfma_f32_32x32x16_bf16 v[112:127], v[68:71], a[96:99], v[112:127]
    ds_read_b64_tr_b16 v[64:65], v11 offset:61440
    ds_read_b64_tr_b16 v[66:67], v11 offset:61952
    s_waitcnt vmcnt(9)
    v_xor_b32 v235, s45, v235
    v_xor_b32 v195, s45, v195
    v_xor_b32 v199, s45, v199
    v_xor_b32 v203, s45, v203
    s_waitcnt lgkmcnt(10)
    v_mfma_f32_32x32x16_bf16 v[128:143], a[96:99], v[72:75], v[128:143]
    ds_read_b64_tr_b16 v[68:69], v12 offset:61440
    ds_read_b64_tr_b16 v[70:71], v12 offset:61952
    buffer_load_dwordx4 v6, s[12:15], s48 offen offset:3072 lds
    s_add_u32 m0, s42, 131072
    v_mfma_f32_32x32x16_bf16 v[144:159], a[96:99], v[76:79], v[144:159]
    ds_read_b64_tr_b16 v[72:73], v11 offset:63488
    ds_read_b64_tr_b16 v[74:75], v11 offset:64000
    s_add_u32 s49, s49, 32768
    v_xor_b32 v207, s45, v207
    v_or3_b32 v235, v235, v195, v199
    v_or3_b32 v235, v235, v203, v207
    v_cmp_ne_u32 s[76:77], 0, v235
    s_waitcnt lgkmcnt(10)
    v_mfma_f32_32x32x16_bf16 v[160:175], a[96:99], v[80:83], v[160:175]
    ds_read_b64_tr_b16 v[76:77], v12 offset:63488
    ds_read_b64_tr_b16 v[78:79], v12 offset:64000
    buffer_load_dwordx4 v9, s[24:27], s49 offen offset:0 lds
    v_mfma_f32_32x32x16_bf16 v[176:191], a[96:99], v[84:87], v[176:191]
    ds_read_b64_tr_b16 v[80:81], v11 offset:53248
    ds_read_b64_tr_b16 v[82:83], v11 offset:53760
    s_cmp_lg_u64 s[76:77], 0
    s_cbranch_scc1 parallel_sum__sliding_block__glu_gated_bilinear__prompt_kernel_rgO
parallel_sum__sliding_block__glu_gated_bilinear__prompt_kernel_rgrO:
    v_add_f32 v192, v192, v196
    v_add_f32 v193, v193, v197
    v_add_f32 v194, v194, v198
    s_waitcnt lgkmcnt(10)
    v_mfma_f32_32x32x16_bf16 v[96:111], v[88:91], a[100:103], v[96:111]
    ds_read_b64_tr_b16 v[84:85], v12 offset:53248
    ds_read_b64_tr_b16 v[86:87], v12 offset:53760
    buffer_load_dwordx4 v10, s[24:27], s49 offen offset:1024 lds
    v_add_f32 v200, v200, v204
    v_mfma_f32_32x32x16_bf16 v[112:127], v[92:95], a[100:103], v[112:127]
    ds_read_b64_tr_b16 v[88:89], v13 offset:0
    ds_read_b64_tr_b16 v[90:91], v13 offset:512
    v_add_f32 v201, v201, v205
    v_add_f32 v202, v202, v206
    v_add_f32 v192, v192, v200
    v_add_f32 v193, v193, v201
    v_add_f32 v194, v194, v202
    s_waitcnt lgkmcnt(10)
    v_mfma_f32_32x32x16_bf16 v[128:143], a[100:103], v[64:67], v[128:143]
    ds_read_b64_tr_b16 v[92:93], v14 offset:0
    ds_read_b64_tr_b16 v[94:95], v14 offset:512
    buffer_load_dwordx4 v7, s[24:27], s49 offen offset:2048 lds
    v_mov_b32 v239, v192
    v_mfma_f32_32x32x16_bf16 v[144:159], a[100:103], v[68:71], v[144:159]
    ds_read_b64_tr_b16 v[64:65], v13 offset:2048
    ds_read_b64_tr_b16 v[66:67], v13 offset:2560
    v_mov_b32 v240, v193
    v_mov_b32 v241, v194
    v_permlane32_swap_b32 v192, v239
    v_permlane32_swap_b32 v193, v240
    v_permlane32_swap_b32 v194, v241
    s_waitcnt lgkmcnt(10)
    v_mfma_f32_32x32x16_bf16 v[160:175], a[100:103], v[72:75], v[160:175]
    ds_read_b64_tr_b16 v[68:69], v14 offset:2048
    ds_read_b64_tr_b16 v[70:71], v14 offset:2560
    buffer_load_dwordx4 v8, s[24:27], s49 offen offset:3072 lds
    v_add_f32 v192, v192, v239
    v_mfma_f32_32x32x16_bf16 v[176:191], a[100:103], v[76:79], v[176:191]
    ds_read_b64_tr_b16 v[72:73], v11 offset:55296
    ds_read_b64_tr_b16 v[74:75], v11 offset:55808
    v_add_f32 v193, v193, v240
    v_add_f32 v194, v194, v241
    ds_write_b128 v243, v[192:195]
    s_waitcnt lgkmcnt(11)
    v_mfma_f32_32x32x16_bf16 v[96:111], v[80:83], a[104:107], v[96:111]
    ds_read_b64_tr_b16 v[76:77], v12 offset:55296
    ds_read_b64_tr_b16 v[78:79], v12 offset:55808
    s_waitcnt vmcnt(8)
    ds_read_b64_tr_b16 a[128:129], v19 offset:0
    ds_read_b64_tr_b16 a[130:131], v19 offset:1024
    v_mfma_f32_32x32x16_bf16 v[112:127], v[84:87], a[104:107], v[112:127]
    ds_read_b64_tr_b16 v[80:81], v13 offset:4096
    ds_read_b64_tr_b16 v[82:83], v13 offset:4608
    ds_read_b64_tr_b16 a[132:133], v20 offset:0
    ds_read_b64_tr_b16 a[134:135], v20 offset:1024
    ds_read_b64_tr_b16 a[136:137], v19 offset:2048
    s_waitcnt lgkmcnt(15)
    v_mfma_f32_32x32x16_bf16 v[128:143], a[104:107], v[88:91], v[128:143]
    ds_read_b64_tr_b16 v[84:85], v14 offset:4096
    ds_read_b64_tr_b16 v[86:87], v14 offset:4608
    ds_read_b64_tr_b16 a[138:139], v19 offset:3072
    ds_read_b64_tr_b16 a[140:141], v20 offset:2048
    ds_read_b64_tr_b16 a[142:143], v20 offset:3072
    v_mfma_f32_32x32x16_bf16 v[144:159], a[104:107], v[92:95], v[144:159]
    ds_read_b64_tr_b16 v[88:89], v13 offset:6144
    ds_read_b64_tr_b16 v[90:91], v13 offset:6656
    s_mov_b32 s76, 0
    s_mov_b32 s77, -1
    v_cvt_pk_bf16_f32 v33, v232, 0
    v_lshlrev_b32 v24, 16, v33
    s_waitcnt lgkmcnt(15)
    v_mfma_f32_32x32x16_bf16 v[160:175], a[104:107], v[64:67], v[160:175]
    ds_read_b64_tr_b16 v[92:93], v14 offset:6144
    ds_read_b64_tr_b16 v[94:95], v14 offset:6656
    v_sub_f32 v24, v232, v24
    s_barrier
    v_mfma_f32_32x32x16_bf16 v[176:191], a[104:107], v[68:71], v[176:191]
    ds_read_b64_tr_b16 v[64:65], v13 offset:8192
    ds_read_b64_tr_b16 v[66:67], v13 offset:8704
    s_add_u32 m0, s42, 16384
    s_bfe_u32 s48, s43, 0x30008
    s_branch parallel_sum__sliding_block__glu_gated_bilinear__prompt_kernel_ws4
parallel_sum__sliding_block__glu_gated_bilinear__prompt_kernel_w2O2_0:
    s_branch parallel_sum__sliding_block__glu_gated_bilinear__prompt_kernel_wr2O
parallel_sum__sliding_block__glu_gated_bilinear__prompt_kernel_ws4:
    s_mul_i32 s48, s48, 229376
    ds_read_b128 v[196:199], v244
    s_waitcnt lgkmcnt(15)
    v_mfma_f32_32x32x16_bf16 v[96:111], v[72:75], a[108:111], v[96:111]
    ds_read_b64_tr_b16 v[68:69], v14 offset:8192
    ds_read_b64_tr_b16 v[70:71], v14 offset:8704
    buffer_load_dwordx4 v5, s[8:11], s48 offen offset:0 lds
    v_mfma_f32_32x32x16_bf16 v[112:127], v[76:79], a[108:111], v[112:127]
    ds_read_b64_tr_b16 v[72:73], v13 offset:16384
    ds_read_b64_tr_b16 v[74:75], v13 offset:16896
    ds_read_b128 v[200:203], v244 offset:8192
    v_cvt_pk_bf16_f32 v32, v232, v24
    v_cndmask_b32 v36, 0, v32, s[76:77]
    s_waitcnt lgkmcnt(15)
    v_mfma_f32_32x32x16_bf16 v[128:143], a[108:111], v[80:83], v[128:143]
    ds_read_b64_tr_b16 v[76:77], v14 offset:16384
    ds_read_b64_tr_b16 v[78:79], v14 offset:16896
    buffer_load_dwordx4 v6, s[8:11], s48 offen offset:1024 lds
    v_mfma_f32_32x32x16_bf16 v[144:159], a[108:111], v[84:87], v[144:159]
    ds_read_b64_tr_b16 v[80:81], v13 offset:18432
    ds_read_b64_tr_b16 v[82:83], v13 offset:18944
    v_cndmask_b32 v37, 0, v33, s[76:77]
    v_cndmask_b32 v32, v32, 0, s[76:77]
    v_cndmask_b32 v33, v33, 0, s[76:77]
    v_mul_f32 v29, v29, v233
    s_waitcnt lgkmcnt(12)
    v_mfma_f32_32x32x16_bf16 v[160:175], a[108:111], v[88:91], v[160:175]
    ds_read_b64_tr_b16 v[84:85], v14 offset:18432
    ds_read_b64_tr_b16 v[86:87], v14 offset:18944
    buffer_load_dwordx4 v5, s[12:15], s48 offen offset:2048 lds
    v_mfma_f32_32x32x16_bf16 v[176:191], a[108:111], v[92:95], v[176:191]
    ds_read_b64_tr_b16 v[88:89], v13 offset:10240
    ds_read_b64_tr_b16 v[90:91], v13 offset:10752
    ds_write_b32 v246, v233
    s_waitcnt lgkmcnt(12)
    v_mfma_f32_32x32x16_bf16 v[96:111], v[64:67], a[112:115], v[96:111]
    ds_read_b64_tr_b16 v[92:93], v14 offset:10240
    ds_read_b64_tr_b16 v[94:95], v14 offset:10752
    buffer_load_dwordx4 v6, s[12:15], s48 offen offset:3072 lds
    s_add_u32 m0, s42, 32768
    v_mfma_f32_32x32x16_bf16 v[112:127], v[68:71], a[112:115], v[112:127]
    ds_read_b64_tr_b16 v[64:65], v13 offset:20480
    ds_read_b64_tr_b16 v[66:67], v13 offset:20992
    s_bfe_u32 s48, s43, 0x3000c
    s_mul_i32 s48, s48, 229376
    s_waitcnt lgkmcnt(13)
    v_add_f32 v198, v198, v202
    s_waitcnt lgkmcnt(11)
    v_mfma_f32_32x32x16_bf16 v[128:143], a[112:115], v[72:75], v[128:143]
    ds_read_b64_tr_b16 v[68:69], v14 offset:20480
    ds_read_b64_tr_b16 v[70:71], v14 offset:20992
    buffer_load_dwordx4 v5, s[8:11], s48 offen offset:0 lds
    v_mfma_f32_32x32x16_bf16 v[144:159], a[112:115], v[76:79], v[144:159]
    ds_read_b64_tr_b16 v[72:73], v13 offset:22528
    ds_read_b64_tr_b16 v[74:75], v13 offset:23040
    v_cvt_pk_bf16_f32 v38, v198, v198
    v_lshlrev_b32 v24, 16, v38
    v_sub_f32 v24, v198, v24
    v_cvt_pk_bf16_f32 v39, v24, 0
    s_waitcnt lgkmcnt(11)
    v_mfma_f32_32x32x16_bf16 v[160:175], a[112:115], v[80:83], v[160:175]
    ds_read_b64_tr_b16 v[76:77], v14 offset:22528
    ds_read_b64_tr_b16 v[78:79], v14 offset:23040
    buffer_load_dwordx4 v6, s[8:11], s48 offen offset:1024 lds
    v_mfma_f32_32x32x16_bf16 v[176:191], a[112:115], v[84:87], v[176:191]
    ds_read_b64_tr_b16 v[80:81], v13 offset:12288
    ds_read_b64_tr_b16 v[82:83], v13 offset:12800
    v_cvt_pk_bf16_f32 v40, v196, v196
    v_lshlrev_b32 v24, 16, v40
    v_sub_f32 v24, v196, v24
    v_cvt_pk_bf16_f32 v41, v24, 0
    s_waitcnt lgkmcnt(10)
    v_mfma_f32_32x32x16_bf16 v[96:111], v[88:91], a[116:119], v[96:111]
    ds_read_b64_tr_b16 v[84:85], v14 offset:12288
    ds_read_b64_tr_b16 v[86:87], v14 offset:12800
    buffer_load_dwordx4 v5, s[12:15], s48 offen offset:2048 lds
    v_mfma_f32_32x32x16_bf16 v[112:127], v[92:95], a[116:119], v[112:127]
    ds_read_b64_tr_b16 v[88:89], v13 offset:24576
    ds_read_b64_tr_b16 v[90:91], v13 offset:25088
    v_cvt_pk_bf16_f32 v42, v200, v200
    v_lshlrev_b32 v24, 16, v42
    v_sub_f32 v24, v200, v24
    v_cvt_pk_bf16_f32 v43, v24, 0
    s_waitcnt lgkmcnt(10)
    v_mfma_f32_32x32x16_bf16 v[128:143], a[116:119], v[64:67], v[128:143]
    ds_read_b64_tr_b16 v[92:93], v14 offset:24576
    ds_read_b64_tr_b16 v[94:95], v14 offset:25088
    buffer_load_dwordx4 v6, s[12:15], s48 offen offset:3072 lds
    s_add_u32 m0, s42, 114688
    v_mfma_f32_32x32x16_bf16 v[144:159], a[116:119], v[68:71], v[144:159]
    ds_read_b64_tr_b16 v[64:65], v13 offset:26624
    ds_read_b64_tr_b16 v[66:67], v13 offset:27136
    s_bfe_u32 s49, s44, 0x30004
    s_lshl_b32 s49, s49, 16
    s_add_u32 s49, s49, s59
    v_cvt_pk_bf16_f32 v44, v197, v197
    s_waitcnt lgkmcnt(10)
    v_mfma_f32_32x32x16_bf16 v[160:175], a[116:119], v[72:75], v[160:175]
    ds_read_b64_tr_b16 v[68:69], v14 offset:26624
    ds_read_b64_tr_b16 v[70:71], v14 offset:27136
    buffer_load_dwordx4 v9, s[24:27], s49 offen offset:0 lds
    v_mfma_f32_32x32x16_bf16 v[176:191], a[116:119], v[76:79], v[176:191]
    ds_read_b64_tr_b16 v[72:73], v13 offset:14336
    ds_read_b64_tr_b16 v[74:75], v13 offset:14848
    v_lshlrev_b32 v24, 16, v44
    v_sub_f32 v24, v197, v24
    v_cvt_pk_bf16_f32 v45, v24, 0
    v_cvt_pk_bf16_f32 v46, v201, v201
    s_waitcnt lgkmcnt(10)
    v_mfma_f32_32x32x16_bf16 v[96:111], v[80:83], a[120:123], v[96:111]
    ds_read_b64_tr_b16 v[76:77], v14 offset:14336
    ds_read_b64_tr_b16 v[78:79], v14 offset:14848
    buffer_load_dwordx4 v10, s[24:27], s49 offen offset:1024 lds
    v_mfma_f32_32x32x16_bf16 v[112:127], v[84:87], a[120:123], v[112:127]
    ds_read_b64_tr_b16 v[80:81], v13 offset:28672
    ds_read_b64_tr_b16 v[82:83], v13 offset:29184
    v_lshlrev_b32 v24, 16, v46
    v_sub_f32 v24, v201, v24
    v_cvt_pk_bf16_f32 v47, v24, 0
    s_waitcnt lgkmcnt(10)
    v_mfma_f32_32x32x16_bf16 v[128:143], a[120:123], v[88:91], v[128:143]
    ds_read_b64_tr_b16 v[84:85], v14 offset:28672
    ds_read_b64_tr_b16 v[86:87], v14 offset:29184
    buffer_load_dwordx4 v7, s[24:27], s49 offen offset:2048 lds
    v_mfma_f32_32x32x16_bf16 v[144:159], a[120:123], v[92:95], v[144:159]
    ds_read_b64_tr_b16 v[88:89], v13 offset:30720
    ds_read_b64_tr_b16 v[90:91], v13 offset:31232
    s_waitcnt lgkmcnt(10)
    v_mfma_f32_32x32x16_bf16 v[160:175], a[120:123], v[64:67], v[160:175]
    ds_read_b64_tr_b16 v[92:93], v14 offset:30720
    ds_read_b64_tr_b16 v[94:95], v14 offset:31232
    buffer_load_dwordx4 v8, s[24:27], s49 offen offset:3072 lds
    s_barrier
    v_mfma_f32_32x32x16_bf16 v[176:191], a[120:123], v[68:71], v[176:191]
    ds_read_b64_tr_b16 v[64:65], v13 offset:32768
    ds_read_b64_tr_b16 v[66:67], v13 offset:33280
    s_add_u32 m0, s42, 49152
    s_bfe_u32 s48, s43, 0x30010
    s_mul_i32 s48, s48, 229376
    s_waitcnt lgkmcnt(10)
    v_mfma_f32_32x32x16_bf16 v[96:111], v[72:75], a[124:127], v[96:111]
    ds_read_b64_tr_b16 v[68:69], v14 offset:32768
    ds_read_b64_tr_b16 v[70:71], v14 offset:33280
    buffer_load_dwordx4 v5, s[8:11], s48 offen offset:0 lds
    v_mfma_f32_32x32x16_bf16 v[112:127], v[76:79], a[124:127], v[112:127]
    ds_read_b64_tr_b16 v[72:73], v13 offset:34816
    ds_read_b64_tr_b16 v[74:75], v13 offset:35328
    s_waitcnt vmcnt(13)
    ds_read_b64_tr_b16 a[144:145], v19 offset:16384
    ds_read_b64_tr_b16 a[146:147], v19 offset:17408
    ds_read_b64_tr_b16 a[148:149], v20 offset:16384
    s_waitcnt lgkmcnt(13)
    v_mfma_f32_32x32x16_bf16 v[128:143], a[124:127], v[80:83], v[128:143]
    ds_read_b64_tr_b16 v[76:77], v14 offset:34816
    ds_read_b64_tr_b16 v[78:79], v14 offset:35328
    buffer_load_dwordx4 v6, s[8:11], s48 offen offset:1024 lds
    v_mfma_f32_32x32x16_bf16 v[144:159], a[124:127], v[84:87], v[144:159]
    ds_read_b64_tr_b16 v[80:81], v13 offset:36864
    ds_read_b64_tr_b16 v[82:83], v13 offset:37376
    ds_read_b64_tr_b16 a[150:151], v20 offset:17408
    ds_read_b64_tr_b16 a[152:153], v19 offset:18432
    ds_read_b64_tr_b16 a[154:155], v19 offset:19456
    s_waitcnt lgkmcnt(15)
    v_mfma_f32_32x32x16_bf16 v[160:175], a[124:127], v[88:91], v[160:175]
    ds_read_b64_tr_b16 v[84:85], v14 offset:36864
    ds_read_b64_tr_b16 v[86:87], v14 offset:37376
    buffer_load_dwordx4 v5, s[12:15], s48 offen offset:2048 lds
    v_mfma_f32_32x32x16_bf16 v[176:191], a[124:127], v[92:95], v[176:191]
    ds_read_b64_tr_b16 v[88:89], v13 offset:38912
    ds_read_b64_tr_b16 v[90:91], v13 offset:39424
    ds_read_b64_tr_b16 a[156:157], v20 offset:18432
    ds_read_b64_tr_b16 a[158:159], v20 offset:19456
    v_mfma_f32_32x32x16_bf16 v[96:111], v[38:41], v[32:35], v[96:111]
    buffer_load_dwordx4 v6, s[12:15], s48 offen offset:3072 lds
    v_mfma_f32_32x32x16_bf16 v[112:127], v[36:39], v[34:37], v[112:127]
    v_mfma_f32_32x32x16_bf16 v[128:143], v[32:35], v[40:43], v[128:143]
    v_mfma_f32_32x32x16_bf16 v[144:159], v[34:37], v[38:41], v[144:159]
    s_nop 7
    v_mul_f32 v96, v96, v29
    v_mul_f32 v97, v97, v29
    v_mul_f32 v98, v98, v29
    v_mul_f32 v99, v99, v29
    v_mul_f32 v100, v100, v29
    v_mul_f32 v101, v101, v29
    v_mul_f32 v102, v102, v29
    v_mul_f32 v103, v103, v29
    v_cvt_pk_bf16_f32 v96, v96, v97
    v_cvt_pk_bf16_f32 v97, v98, v99
    v_cvt_pk_bf16_f32 v98, v100, v101
    v_cvt_pk_bf16_f32 v99, v102, v103
    v_mfma_f32_32x32x16_bf16 v[160:175], v[32:35], v[42:45], v[160:175]
    buffer_store_dwordx4 v[96:99], v2, s[20:23], s55 offen offset:0 sc1
    v_mul_f32 v104, v104, v29
    v_mul_f32 v105, v105, v29
    v_mul_f32 v106, v106, v29
    v_mul_f32 v107, v107, v29
    v_mul_f32 v108, v108, v29
    v_mul_f32 v109, v109, v29
    v_mul_f32 v110, v110, v29
    v_mfma_f32_32x32x16_bf16 v[176:191], v[34:37], v[40:43], v[176:191]
    v_mul_f32 v111, v111, v29
    v_cvt_pk_bf16_f32 v104, v104, v105
    v_cvt_pk_bf16_f32 v105, v106, v107
    v_cvt_pk_bf16_f32 v106, v108, v109
    v_cvt_pk_bf16_f32 v107, v110, v111
    buffer_store_dwordx4 v[104:107], v2, s[20:23], s55 offen offset:1024 sc1
    v_mul_f32 v112, v112, v29
    v_mul_f32 v113, v113, v29
    v_mfma_f32_32x32x16_bf16 v[192:207], v[44:47], v[32:35], 0
    v_mul_f32 v114, v114, v29
    v_mul_f32 v115, v115, v29
    v_mul_f32 v116, v116, v29
    v_mul_f32 v117, v117, v29
    v_mul_f32 v118, v118, v29
    v_mul_f32 v119, v119, v29
    v_cvt_pk_bf16_f32 v112, v112, v113
    v_cvt_pk_bf16_f32 v113, v114, v115
    v_cvt_pk_bf16_f32 v114, v116, v117
    v_cvt_pk_bf16_f32 v115, v118, v119
    v_mfma_f32_32x32x16_bf16 v[208:223], v[42:45], v[34:37], 0
    buffer_store_dwordx4 v[112:115], v2, s[20:23], s55 offen offset:2048 sc1
    v_mul_f32 v120, v120, v29
    v_mul_f32 v121, v121, v29
    v_mul_f32 v122, v122, v29
    v_mul_f32 v123, v123, v29
    v_mul_f32 v124, v124, v29
    v_mul_f32 v125, v125, v29
    v_mul_f32 v126, v126, v29
    v_mfma_f32_32x32x16_bf16 v[224:239], v[46:49], v[32:35], 0
    v_mul_f32 v127, v127, v29
    v_cvt_pk_bf16_f32 v120, v120, v121
    v_cvt_pk_bf16_f32 v121, v122, v123
    v_cvt_pk_bf16_f32 v122, v124, v125
    v_cvt_pk_bf16_f32 v123, v126, v127
    buffer_store_dwordx4 v[120:123], v2, s[20:23], s55 offen offset:3072 sc1
    v_mfma_f32_32x32x16_bf16 v[240:255], v[44:47], v[34:37], 0
    s_waitcnt lgkmcnt(15)
    v_mfma_f32_32x32x16_bf16 v[192:207], v[64:67], a[0:3], v[192:207]
    ds_read_b64_tr_b16 v[92:93], v14 offset:38912
    ds_read_b64_tr_b16 v[94:95], v14 offset:39424
    ds_read_b128 v[32:35], v25 offset:0
    ds_read_b128 v[36:39], v25 offset:32
    v_mfma_f32_32x32x16_bf16 v[208:223], v[68:71], a[0:3], v[208:223]
    ds_read_b64_tr_b16 v[64:65], v13 offset:40960
    ds_read_b64_tr_b16 v[66:67], v13 offset:41472
    ds_read_b128 v[40:43], v25 offset:64
    ds_read_b128 v[44:47], v25 offset:96
    s_waitcnt lgkmcnt(15)
    v_mfma_f32_32x32x16_bf16 v[224:239], v[72:75], a[0:3], v[224:239]
    ds_read_b64_tr_b16 v[68:69], v14 offset:40960
    ds_read_b64_tr_b16 v[70:71], v14 offset:41472
    v_mfma_f32_32x32x16_bf16 v[240:255], v[76:79], a[0:3], v[240:255]
    ds_read_b64_tr_b16 v[72:73], v13 offset:43008
    ds_read_b64_tr_b16 v[74:75], v13 offset:43520
    s_waitcnt lgkmcnt(4)
    v_mul_f32 v128, v128, v32
    v_mul_f32 v129, v129, v33
    v_mul_f32 v130, v130, v34
    v_mul_f32 v131, v131, v35
    v_mul_f32 v132, v132, v36
    v_mul_f32 v133, v133, v37
    v_mul_f32 v134, v134, v38
    v_mul_f32 v135, v135, v39
    v_cvt_pk_bf16_f32 v128, v128, v129
    v_cvt_pk_bf16_f32 v129, v130, v131
    v_cvt_pk_bf16_f32 v130, v132, v133
    v_cvt_pk_bf16_f32 v131, v134, v135
    buffer_store_dwordx4 v[128:131], v2, s[20:23], s56 offen offset:0 sc1
    v_mul_f32 v136, v136, v40
    v_mul_f32 v137, v137, v41
    v_mul_f32 v138, v138, v42
    v_mul_f32 v139, v139, v43
    v_mul_f32 v140, v140, v44
    v_mul_f32 v141, v141, v45
    v_mul_f32 v142, v142, v46
    v_mul_f32 v143, v143, v47
    v_cvt_pk_bf16_f32 v136, v136, v137
    v_cvt_pk_bf16_f32 v137, v138, v139
    v_cvt_pk_bf16_f32 v138, v140, v141
    v_cvt_pk_bf16_f32 v139, v142, v143
    v_mfma_f32_32x32x16_bf16 v[192:207], v[80:83], a[4:7], v[192:207]
    ds_read_b64_tr_b16 v[76:77], v14 offset:43008
    ds_read_b64_tr_b16 v[78:79], v14 offset:43520
    buffer_store_dwordx4 v[136:139], v2, s[20:23], s56 offen offset:1024 sc1
    v_mul_f32 v144, v144, v32
    v_mul_f32 v145, v145, v33
    v_mul_f32 v146, v146, v34
    v_mul_f32 v147, v147, v35
    v_mul_f32 v148, v148, v36
    v_mul_f32 v149, v149, v37
    v_mul_f32 v150, v150, v38
    v_mul_f32 v151, v151, v39
    v_cvt_pk_bf16_f32 v144, v144, v145
    v_cvt_pk_bf16_f32 v145, v146, v147
    v_cvt_pk_bf16_f32 v146, v148, v149
    v_cvt_pk_bf16_f32 v147, v150, v151
    v_mfma_f32_32x32x16_bf16 v[208:223], v[84:87], a[4:7], v[208:223]
    ds_read_b64_tr_b16 v[80:81], v13 offset:45056
    ds_read_b64_tr_b16 v[82:83], v13 offset:45568
    buffer_store_dwordx4 v[144:147], v2, s[20:23], s56 offen offset:2048 sc1
    v_mul_f32 v152, v152, v40
    v_mul_f32 v153, v153, v41
    v_mul_f32 v154, v154, v42
    v_mul_f32 v155, v155, v43
    v_mul_f32 v156, v156, v44
    v_mul_f32 v157, v157, v45
    v_mul_f32 v158, v158, v46
    v_mul_f32 v159, v159, v47
    v_cvt_pk_bf16_f32 v152, v152, v153
    v_cvt_pk_bf16_f32 v153, v154, v155
    v_cvt_pk_bf16_f32 v154, v156, v157
    v_cvt_pk_bf16_f32 v155, v158, v159
    v_mfma_f32_32x32x16_bf16 v[224:239], v[88:91], a[4:7], v[224:239]
    ds_read_b64_tr_b16 v[84:85], v14 offset:45056
    ds_read_b64_tr_b16 v[86:87], v14 offset:45568
    buffer_store_dwordx4 v[152:155], v2, s[20:23], s56 offen offset:3072 sc1
    s_add_u32 s56, s56, 4096
    v_mul_f32 v160, v160, v32
    v_mul_f32 v161, v161, v33
    v_mul_f32 v162, v162, v34
    v_mul_f32 v163, v163, v35
    v_mul_f32 v164, v164, v36
    v_mul_f32 v165, v165, v37
    v_mul_f32 v166, v166, v38
    v_mul_f32 v167, v167, v39
    v_cvt_pk_bf16_f32 v160, v160, v161
    v_cvt_pk_bf16_f32 v161, v162, v163
    v_cvt_pk_bf16_f32 v162, v164, v165
    v_cvt_pk_bf16_f32 v163, v166, v167
    v_mfma_f32_32x32x16_bf16 v[240:255], v[92:95], a[4:7], v[240:255]
    ds_read_b64_tr_b16 v[88:89], v13 offset:47104
    ds_read_b64_tr_b16 v[90:91], v13 offset:47616
    buffer_store_dwordx4 v[160:163], v2, s[20:23], s56 offen offset:0 sc1
    v_mul_f32 v168, v168, v40
    v_mul_f32 v169, v169, v41
    v_mul_f32 v170, v170, v42
    v_mul_f32 v171, v171, v43
    v_mul_f32 v172, v172, v44
    v_mul_f32 v173, v173, v45
    v_mul_f32 v174, v174, v46
    v_mul_f32 v175, v175, v47
    v_cvt_pk_bf16_f32 v168, v168, v169
    v_cvt_pk_bf16_f32 v169, v170, v171
    v_cvt_pk_bf16_f32 v170, v172, v173
    v_cvt_pk_bf16_f32 v171, v174, v175
    s_waitcnt lgkmcnt(10)
    v_mfma_f32_32x32x16_bf16 v[192:207], v[64:67], a[8:11], v[192:207]
    ds_read_b64_tr_b16 v[92:93], v14 offset:47104
    ds_read_b64_tr_b16 v[94:95], v14 offset:47616
    buffer_store_dwordx4 v[168:171], v2, s[20:23], s56 offen offset:1024 sc1
    v_mul_f32 v176, v176, v32
    v_mul_f32 v177, v177, v33
    v_mul_f32 v178, v178, v34
    v_mul_f32 v179, v179, v35
    v_mul_f32 v180, v180, v36
    v_mul_f32 v181, v181, v37
    v_mul_f32 v182, v182, v38
    v_mul_f32 v183, v183, v39
    v_cvt_pk_bf16_f32 v176, v176, v177
    v_cvt_pk_bf16_f32 v177, v178, v179
    v_cvt_pk_bf16_f32 v178, v180, v181
    v_cvt_pk_bf16_f32 v179, v182, v183
    s_barrier
    v_mfma_f32_32x32x16_bf16 v[208:223], v[68:71], a[8:11], v[208:223]
    ds_read_b64_tr_b16 v[64:65], v11 offset:0
    ds_read_b64_tr_b16 v[66:67], v11 offset:512
    s_add_u32 m0, s42, 65536
    s_bfe_u32 s48, s43, 0x30014
    s_mul_i32 s48, s48, 229376
    buffer_store_dwordx4 v[176:179], v2, s[20:23], s56 offen offset:2048 sc1
    v_mul_f32 v184, v184, v40
    v_mul_f32 v185, v185, v41
    v_mul_f32 v186, v186, v42
    v_mul_f32 v187, v187, v43
    v_mul_f32 v188, v188, v44
    v_mul_f32 v189, v189, v45
    v_mul_f32 v190, v190, v46
    v_mul_f32 v191, v191, v47
    v_cvt_pk_bf16_f32 v184, v184, v185
    v_cvt_pk_bf16_f32 v185, v186, v187
    v_cvt_pk_bf16_f32 v186, v188, v189
    v_cvt_pk_bf16_f32 v187, v190, v191
    s_waitcnt lgkmcnt(10)
    v_mfma_f32_32x32x16_bf16 v[224:239], v[72:75], a[8:11], v[224:239]
    ds_read_b64_tr_b16 v[68:69], v12 offset:0
    ds_read_b64_tr_b16 v[70:71], v12 offset:512
    buffer_load_dwordx4 v5, s[8:11], s48 offen offset:0 lds
    v_mfma_f32_32x32x16_bf16 v[240:255], v[76:79], a[8:11], v[240:255]
    ds_read_b64_tr_b16 v[72:73], v11 offset:2048
    ds_read_b64_tr_b16 v[74:75], v11 offset:2560
    s_waitcnt vmcnt(16)
    ds_read_b64_tr_b16 a[160:161], v19 offset:0
    ds_read_b64_tr_b16 a[162:163], v19 offset:1024
    ds_read_b64_tr_b16 a[164:165], v20 offset:0
    buffer_store_dwordx4 v[184:187], v2, s[20:23], s56 offen offset:3072 sc1
    s_waitcnt lgkmcnt(13)
    v_mfma_f32_32x32x16_bf16 v[192:207], v[80:83], a[12:15], v[192:207]
    ds_read_b64_tr_b16 v[76:77], v12 offset:2048
    ds_read_b64_tr_b16 v[78:79], v12 offset:2560
    buffer_load_dwordx4 v6, s[8:11], s48 offen offset:1024 lds
    v_mfma_f32_32x32x16_bf16 v[208:223], v[84:87], a[12:15], v[208:223]
    ds_read_b64_tr_b16 v[80:81], v11 offset:4096
    ds_read_b64_tr_b16 v[82:83], v11 offset:4608
    ds_read_b64_tr_b16 a[166:167], v20 offset:1024
    ds_read_b64_tr_b16 a[168:169], v19 offset:2048
    ds_read_b64_tr_b16 a[170:171], v19 offset:3072
    s_waitcnt lgkmcnt(15)
    v_mfma_f32_32x32x16_bf16 v[224:239], v[88:91], a[12:15], v[224:239]
    ds_read_b64_tr_b16 v[84:85], v12 offset:4096
    ds_read_b64_tr_b16 v[86:87], v12 offset:4608
    buffer_load_dwordx4 v5, s[12:15], s48 offen offset:2048 lds
    v_mfma_f32_32x32x16_bf16 v[240:255], v[92:95], a[12:15], v[240:255]
    ds_read_b64_tr_b16 v[88:89], v11 offset:6144
    ds_read_b64_tr_b16 v[90:91], v11 offset:6656
    ds_read_b64_tr_b16 a[172:173], v20 offset:2048
    ds_read_b64_tr_b16 a[174:175], v20 offset:3072
    s_mov_b32 s50, 0x3f803f80
    s_mov_b32 s51, 0x3f803f80
    s_waitcnt lgkmcnt(15)
    v_mfma_f32_32x32x16_bf16 v[192:207], v[64:67], a[16:19], v[192:207]
    ds_read_b64_tr_b16 v[92:93], v12 offset:6144
    ds_read_b64_tr_b16 v[94:95], v12 offset:6656
    buffer_load_dwordx4 v6, s[12:15], s48 offen offset:3072 lds
    s_add_u32 m0, s42, 81920
    v_mfma_f32_32x32x16_bf16 v[208:223], v[68:71], a[16:19], v[208:223]
    ds_read_b64_tr_b16 v[64:65], v11 offset:8192
    ds_read_b64_tr_b16 v[66:67], v11 offset:8704
    s_bfe_u32 s48, s43, 0x30018
    s_mul_i32 s48, s48, 229376
    v_mov_b64 v[180:181], s[50:51]
    v_mov_b64 v[182:183], s[50:51]
    s_waitcnt lgkmcnt(15)
    v_mfma_f32_32x32x16_bf16 v[224:239], v[72:75], a[16:19], v[224:239]
    ds_read_b64_tr_b16 v[68:69], v12 offset:8192
    ds_read_b64_tr_b16 v[70:71], v12 offset:8704
    buffer_load_dwordx4 v5, s[8:11], s48 offen offset:0 lds
    v_mfma_f32_32x32x16_bf16 v[240:255], v[76:79], a[16:19], v[240:255]
    ds_read_b64_tr_b16 v[72:73], v11 offset:10240
    ds_read_b64_tr_b16 v[74:75], v11 offset:10752
    v_mov_b64 v[172:173], s[50:51]
    v_mov_b64 v[174:175], s[50:51]
    s_cmp_le_u32 s68, 0
    s_cselect_b64 s[50:51], 0, s[50:51]
    s_waitcnt lgkmcnt(12)
    v_mfma_f32_32x32x16_bf16 v[192:207], v[80:83], a[20:23], v[192:207]
    ds_read_b64_tr_b16 v[76:77], v12 offset:10240
    ds_read_b64_tr_b16 v[78:79], v12 offset:10752
    buffer_load_dwordx4 v6, s[8:11], s48 offen offset:1024 lds
    v_mfma_f32_32x32x16_bf16 v[208:223], v[84:87], a[20:23], v[208:223]
    ds_read_b64_tr_b16 v[80:81], v11 offset:12288
    ds_read_b64_tr_b16 v[82:83], v11 offset:12800
    v_mov_b64 v[164:165], s[50:51]
    v_mov_b64 v[166:167], s[50:51]
    v_mov_b64 v[156:157], s[50:51]
    v_mov_b64 v[158:159], s[50:51]
    s_waitcnt lgkmcnt(10)
    v_mfma_f32_32x32x16_bf16 v[224:239], v[88:91], a[20:23], v[224:239]
    ds_read_b64_tr_b16 v[84:85], v12 offset:12288
    ds_read_b64_tr_b16 v[86:87], v12 offset:12800
    buffer_load_dwordx4 v5, s[12:15], s48 offen offset:2048 lds
    v_mfma_f32_32x32x16_bf16 v[240:255], v[92:95], a[20:23], v[240:255]
    ds_read_b64_tr_b16 v[88:89], v11 offset:14336
    ds_read_b64_tr_b16 v[90:91], v11 offset:14848
    s_cmp_le_u32 s68, 1
    s_cselect_b64 s[50:51], 0, s[50:51]
    v_mov_b64 v[148:149], s[50:51]
    v_mov_b64 v[150:151], s[50:51]
    s_waitcnt lgkmcnt(10)
    v_mfma_f32_32x32x16_bf16 v[192:207], v[64:67], a[24:27], v[192:207]
    ds_read_b64_tr_b16 v[92:93], v12 offset:14336
    ds_read_b64_tr_b16 v[94:95], v12 offset:14848
    buffer_load_dwordx4 v6, s[12:15], s48 offen offset:3072 lds
    s_barrier
    v_mfma_f32_32x32x16_bf16 v[208:223], v[68:71], a[24:27], v[208:223]
    ds_read_b64_tr_b16 v[64:65], v11 offset:16384
    ds_read_b64_tr_b16 v[66:67], v11 offset:16896
    s_add_u32 m0, s42, 98304
    s_bfe_u32 s48, s43, 0x3001c
    s_mul_i32 s48, s48, 229376
    v_mov_b64 v[140:141], s[50:51]
    s_waitcnt lgkmcnt(10)
    v_mfma_f32_32x32x16_bf16 v[224:239], v[72:75], a[24:27], v[224:239]
    ds_read_b64_tr_b16 v[68:69], v12 offset:16384
    ds_read_b64_tr_b16 v[70:71], v12 offset:16896
    buffer_load_dwordx4 v5, s[8:11], s48 offen offset:0 lds
    v_mfma_f32_32x32x16_bf16 v[240:255], v[76:79], a[24:27], v[240:255]
    ds_read_b64_tr_b16 v[72:73], v11 offset:18432
    ds_read_b64_tr_b16 v[74:75], v11 offset:18944
    s_waitcnt vmcnt(8)
    s_mov_b64 exec, 1
    buffer_store_dword v21, off, s[20:23], s58 sc1
    s_mov_b64 exec, -1
    s_add_u32 s58, s58, 524288
    s_waitcnt lgkmcnt(10)
    v_mfma_f32_32x32x16_bf16 v[192:207], v[80:83], a[28:31], v[192:207]
    ds_read_b64_tr_b16 v[76:77], v12 offset:18432
    ds_read_b64_tr_b16 v[78:79], v12 offset:18944
    buffer_load_dwordx4 v6, s[8:11], s48 offen offset:1024 lds
    v_mfma_f32_32x32x16_bf16 v[208:223], v[84:87], a[28:31], v[208:223]
    ds_read_b64_tr_b16 v[80:81], v11 offset:20480
    ds_read_b64_tr_b16 v[82:83], v11 offset:20992
    v_mov_b64 v[142:143], s[50:51]
    s_cmp_le_u32 s68, 2
    s_cselect_b64 s[50:51], 0, s[50:51]
    v_mov_b64 v[132:133], s[50:51]
    s_waitcnt lgkmcnt(10)
    v_mfma_f32_32x32x16_bf16 v[224:239], v[88:91], a[28:31], v[224:239]
    ds_read_b64_tr_b16 v[84:85], v12 offset:20480
    ds_read_b64_tr_b16 v[86:87], v12 offset:20992
    buffer_load_dwordx4 v5, s[12:15], s48 offen offset:2048 lds
    v_mfma_f32_32x32x16_bf16 v[240:255], v[92:95], a[28:31], v[240:255]
    ds_read_b64_tr_b16 v[88:89], v11 offset:22528
    ds_read_b64_tr_b16 v[90:91], v11 offset:23040
    v_mov_b64 v[134:135], s[50:51]
    v_mov_b64 v[124:125], s[50:51]
    v_mov_b64 v[126:127], s[50:51]
    s_waitcnt lgkmcnt(10)
    v_mfma_f32_32x32x16_bf16 v[192:207], v[64:67], a[32:35], v[192:207]
    ds_read_b64_tr_b16 v[92:93], v12 offset:22528
    ds_read_b64_tr_b16 v[94:95], v12 offset:23040
    buffer_load_dwordx4 v6, s[12:15], s48 offen offset:3072 lds
    s_add_u32 m0, s42, 131072
    v_mfma_f32_32x32x16_bf16 v[208:223], v[68:71], a[32:35], v[208:223]
    ds_read_b64_tr_b16 v[64:65], v11 offset:24576
    ds_read_b64_tr_b16 v[66:67], v11 offset:25088
    s_add_u32 s49, s49, 32768
    s_cmp_le_u32 s68, 3
    s_cselect_b64 s[50:51], 0, s[50:51]
    v_mov_b64 v[116:117], s[50:51]
    s_waitcnt lgkmcnt(10)
    v_mfma_f32_32x32x16_bf16 v[224:239], v[72:75], a[32:35], v[224:239]
    ds_read_b64_tr_b16 v[68:69], v12 offset:24576
    ds_read_b64_tr_b16 v[70:71], v12 offset:25088
    buffer_load_dwordx4 v9, s[24:27], s49 offen offset:0 lds
    v_mfma_f32_32x32x16_bf16 v[240:255], v[76:79], a[32:35], v[240:255]
    ds_read_b64_tr_b16 v[72:73], v11 offset:26624
    ds_read_b64_tr_b16 v[74:75], v11 offset:27136
    v_mov_b64 v[118:119], s[50:51]
    v_mov_b64 v[108:109], s[50:51]
    v_mov_b64 v[110:111], s[50:51]
    s_waitcnt lgkmcnt(10)
    v_mfma_f32_32x32x16_bf16 v[192:207], v[80:83], a[36:39], v[192:207]
    ds_read_b64_tr_b16 v[76:77], v12 offset:26624
    ds_read_b64_tr_b16 v[78:79], v12 offset:27136
    s_lshr_b32 s70, s2, 3
    s_lshl2_add_u32 s70, s70, s40
    v_lshlrev_b32 v22, 9, v1
    s_mul_i32 s71, s70, 14336
    v_mfma_f32_32x32x16_bf16 v[208:223], v[84:87], a[36:39], v[208:223]
    ds_read_b64_tr_b16 v[80:81], v11 offset:28672
    ds_read_b64_tr_b16 v[82:83], v11 offset:29184
    s_mov_b64 exec, 0xfffffff
    buffer_load_dword a248, v22, s[24:27], s71 offen offset:384
    s_mov_b64 exec, -1
    s_waitcnt lgkmcnt(10)
    v_mfma_f32_32x32x16_bf16 v[224:239], v[88:91], a[36:39], v[224:239]
    ds_read_b64_tr_b16 v[84:85], v12 offset:28672
    ds_read_b64_tr_b16 v[86:87], v12 offset:29184
    s_lshl_b32 s70, s70, 12
    s_mov_b64 exec, 0xff
    buffer_load_dword a249, v22, s[28:31], s70 offen offset:384
    s_mov_b64 exec, -1
    v_mfma_f32_32x32x16_bf16 v[240:255], v[92:95], a[36:39], v[240:255]
    ds_read_b64_tr_b16 v[88:89], v11 offset:30720
    ds_read_b64_tr_b16 v[90:91], v11 offset:31232
    s_waitcnt lgkmcnt(10)
    v_mfma_f32_32x32x16_bf16 v[192:207], v[64:67], a[40:43], v[192:207]
    ds_read_b64_tr_b16 v[92:93], v12 offset:30720
    ds_read_b64_tr_b16 v[94:95], v12 offset:31232
    buffer_load_dwordx4 v10, s[24:27], s49 offen offset:1024 lds
    s_barrier
    v_mfma_f32_32x32x16_bf16 v[208:223], v[68:71], a[40:43], v[208:223]
    ds_read_b64_tr_b16 v[64:65], v11 offset:32768
    ds_read_b64_tr_b16 v[66:67], v11 offset:33280
    s_waitcnt lgkmcnt(10)
    v_mfma_f32_32x32x16_bf16 v[224:239], v[72:75], a[40:43], v[224:239]
    ds_read_b64_tr_b16 v[68:69], v12 offset:32768
    ds_read_b64_tr_b16 v[70:71], v12 offset:33280
    buffer_load_dwordx4 v7, s[24:27], s49 offen offset:2048 lds
    v_mfma_f32_32x32x16_bf16 v[240:255], v[76:79], a[40:43], v[240:255]
    ds_read_b64_tr_b16 v[72:73], v11 offset:34816
    ds_read_b64_tr_b16 v[74:75], v11 offset:35328
    s_waitcnt lgkmcnt(10)
    v_mfma_f32_32x32x16_bf16 v[192:207], v[80:83], a[44:47], v[192:207]
    ds_read_b64_tr_b16 v[76:77], v12 offset:34816
    ds_read_b64_tr_b16 v[78:79], v12 offset:35328
    buffer_load_dwordx4 v8, s[24:27], s49 offen offset:3072 lds
    s_add_u32 m0, s42, 147456
    v_mfma_f32_32x32x16_bf16 v[208:223], v[84:87], a[44:47], v[208:223]
    ds_read_b64_tr_b16 v[80:81], v11 offset:36864
    ds_read_b64_tr_b16 v[82:83], v11 offset:37376
    s_bfe_u32 s49, s44, 0x30008
    s_lshl_b32 s49, s49, 16
    s_add_u32 s49, s49, s59
    s_waitcnt lgkmcnt(10)
    v_mfma_f32_32x32x16_bf16 v[224:239], v[88:91], a[44:47], v[224:239]
    ds_read_b64_tr_b16 v[84:85], v12 offset:36864
    ds_read_b64_tr_b16 v[86:87], v12 offset:37376
    buffer_load_dwordx4 v9, s[24:27], s49 offen offset:0 lds
    v_mfma_f32_32x32x16_bf16 v[240:255], v[92:95], a[44:47], v[240:255]
    ds_read_b64_tr_b16 v[88:89], v11 offset:38912
    ds_read_b64_tr_b16 v[90:91], v11 offset:39424
    s_waitcnt lgkmcnt(10)
    v_mfma_f32_32x32x16_bf16 v[192:207], v[64:67], a[48:51], v[192:207]
    ds_read_b64_tr_b16 v[92:93], v12 offset:38912
    ds_read_b64_tr_b16 v[94:95], v12 offset:39424
    buffer_load_dwordx4 v10, s[24:27], s49 offen offset:1024 lds
    v_mfma_f32_32x32x16_bf16 v[208:223], v[68:71], a[48:51], v[208:223]
    ds_read_b64_tr_b16 v[64:65], v11 offset:40960
    s_branch parallel_sum__sliding_block__glu_gated_bilinear__prompt_kernel_ws5
parallel_sum__sliding_block__glu_gated_bilinear__prompt_kernel_w2O3_0:
    s_branch parallel_sum__sliding_block__glu_gated_bilinear__prompt_kernel_wr2O
parallel_sum__sliding_block__glu_gated_bilinear__prompt_kernel_ws5:
    ds_read_b64_tr_b16 v[66:67], v11 offset:41472
    s_waitcnt lgkmcnt(10)
    v_mfma_f32_32x32x16_bf16 v[224:239], v[72:75], a[48:51], v[224:239]
    ds_read_b64_tr_b16 v[68:69], v12 offset:40960
    ds_read_b64_tr_b16 v[70:71], v12 offset:41472
    buffer_load_dwordx4 v7, s[24:27], s49 offen offset:2048 lds
    v_mfma_f32_32x32x16_bf16 v[240:255], v[76:79], a[48:51], v[240:255]
    ds_read_b64_tr_b16 v[72:73], v11 offset:43008
    ds_read_b64_tr_b16 v[74:75], v11 offset:43520
    s_waitcnt lgkmcnt(10)
    v_mfma_f32_32x32x16_bf16 v[192:207], v[80:83], a[52:55], v[192:207]
    ds_read_b64_tr_b16 v[76:77], v12 offset:43008
    ds_read_b64_tr_b16 v[78:79], v12 offset:43520
    buffer_load_dwordx4 v8, s[24:27], s49 offen offset:3072 lds
    s_add_u32 m0, s42, 114688
    v_mfma_f32_32x32x16_bf16 v[208:223], v[84:87], a[52:55], v[208:223]
    ds_read_b64_tr_b16 v[80:81], v11 offset:45056
    ds_read_b64_tr_b16 v[82:83], v11 offset:45568
    s_add_u32 s49, s49, 32768
    s_waitcnt lgkmcnt(10)
    v_mfma_f32_32x32x16_bf16 v[224:239], v[88:91], a[52:55], v[224:239]
    ds_read_b64_tr_b16 v[84:85], v12 offset:45056
    ds_read_b64_tr_b16 v[86:87], v12 offset:45568
    buffer_load_dwordx4 v9, s[24:27], s49 offen offset:0 lds
    v_mfma_f32_32x32x16_bf16 v[240:255], v[92:95], a[52:55], v[240:255]
    ds_read_b64_tr_b16 v[88:89], v11 offset:47104
    ds_read_b64_tr_b16 v[90:91], v11 offset:47616
    s_waitcnt lgkmcnt(10)
    v_mfma_f32_32x32x16_bf16 v[192:207], v[64:67], a[56:59], v[192:207]
    ds_read_b64_tr_b16 v[92:93], v12 offset:47104
    ds_read_b64_tr_b16 v[94:95], v12 offset:47616
    buffer_load_dwordx4 v10, s[24:27], s49 offen offset:1024 lds
    s_barrier
    v_mfma_f32_32x32x16_bf16 v[208:223], v[68:71], a[56:59], v[208:223]
    ds_read_b64_tr_b16 v[64:65], v11 offset:49152
    ds_read_b64_tr_b16 v[66:67], v11 offset:49664
    s_waitcnt lgkmcnt(10)
    v_mfma_f32_32x32x16_bf16 v[224:239], v[72:75], a[56:59], v[224:239]
    ds_read_b64_tr_b16 v[68:69], v12 offset:49152
    ds_read_b64_tr_b16 v[70:71], v12 offset:49664
    buffer_load_dwordx4 v7, s[24:27], s49 offen offset:2048 lds
    v_mfma_f32_32x32x16_bf16 v[240:255], v[76:79], a[56:59], v[240:255]
    ds_read_b64_tr_b16 v[72:73], v11 offset:51200
    ds_read_b64_tr_b16 v[74:75], v11 offset:51712
    s_waitcnt lgkmcnt(10)
    v_mfma_f32_32x32x16_bf16 v[192:207], v[80:83], a[60:63], v[192:207]
    ds_read_b64_tr_b16 v[76:77], v12 offset:51200
    ds_read_b64_tr_b16 v[78:79], v12 offset:51712
    s_waitcnt vmcnt(7)
    ds_read_b64_tr_b16 a[176:177], v19 offset:16384
    ds_read_b64_tr_b16 a[178:179], v19 offset:17408
    v_mfma_f32_32x32x16_bf16 v[208:223], v[84:87], a[60:63], v[208:223]
    ds_read_b64_tr_b16 v[80:81], v11 offset:53248
    ds_read_b64_tr_b16 v[82:83], v11 offset:53760
    ds_read_b64_tr_b16 a[180:181], v20 offset:16384
    ds_read_b64_tr_b16 a[182:183], v20 offset:17408
    ds_read_b64_tr_b16 a[184:185], v19 offset:18432
    s_waitcnt lgkmcnt(15)
    v_mfma_f32_32x32x16_bf16 v[224:239], v[88:91], a[60:63], v[224:239]
    ds_read_b64_tr_b16 v[84:85], v12 offset:53248
    ds_read_b64_tr_b16 v[86:87], v12 offset:53760
    ds_read_b64_tr_b16 a[186:187], v19 offset:19456
    ds_read_b64_tr_b16 a[188:189], v20 offset:18432
    ds_read_b64_tr_b16 a[190:191], v20 offset:19456
    s_mov_b32 s16, s20
    s_mov_b32 s17, s21
    v_mfma_f32_32x32x16_bf16 v[240:255], v[92:95], a[60:63], v[240:255]
    ds_read_b64_tr_b16 v[88:89], v11 offset:55296
    ds_read_b64_tr_b16 v[90:91], v11 offset:55808
    buffer_load_dwordx4 v8, s[24:27], s49 offen offset:3072 lds
    s_mov_b32 s18, 20971520
    s_waitcnt lgkmcnt(15)
    v_mfma_f32_32x32x16_bf16 v[192:207], v[64:67], a[64:67], v[192:207]
    ds_read_b64_tr_b16 v[92:93], v12 offset:55296
    ds_read_b64_tr_b16 v[94:95], v12 offset:55808
    v_mfma_f32_32x32x16_bf16 v[208:223], v[68:71], a[64:67], v[208:223]
    ds_read_b64_tr_b16 v[64:65], v11 offset:57344
    ds_read_b64_tr_b16 v[66:67], v11 offset:57856
    s_add_u32 m0, s42, 131072
    s_bfe_u32 s49, s44, 0x3000c
    s_lshl_b32 s49, s49, 16
    s_add_u32 s49, s49, s59
    s_waitcnt lgkmcnt(15)
    v_mfma_f32_32x32x16_bf16 v[224:239], v[72:75], a[64:67], v[224:239]
    ds_read_b64_tr_b16 v[68:69], v12 offset:57344
    ds_read_b64_tr_b16 v[70:71], v12 offset:57856
    s_waitcnt lgkmcnt(8)
    buffer_load_dwordx4 v9, s[24:27], s49 offen offset:0 lds
    v_mfma_f32_32x32x16_bf16 v[240:255], v[76:79], a[64:67], v[240:255]
    ds_read_b64_tr_b16 v[72:73], v11 offset:59392
    ds_read_b64_tr_b16 v[74:75], v11 offset:59904
    buffer_load_dword v29, v28, s[20:23], s60 offen sc1
    v_mfma_f32_32x32x16_bf16 v[192:207], v[80:83], a[68:71], v[192:207]
    ds_read_b64_tr_b16 v[76:77], v12 offset:59392
    ds_read_b64_tr_b16 v[78:79], v12 offset:59904
    s_waitcnt vmcnt(6)
    ds_read_b64_tr_b16 a[192:193], v19 offset:32768
    ds_read_b64_tr_b16 a[194:195], v19 offset:33792
    s_add_u32 s57, s57, 12288
    v_mfma_f32_32x32x16_bf16 v[208:223], v[84:87], a[68:71], v[208:223]
    ds_read_b64_tr_b16 v[80:81], v11 offset:61440
    ds_read_b64_tr_b16 v[82:83], v11 offset:61952
    ds_read_b64_tr_b16 a[196:197], v20 offset:32768
    ds_read_b64_tr_b16 a[198:199], v20 offset:33792
    ds_read_b64_tr_b16 a[200:201], v19 offset:34816
    s_waitcnt lgkmcnt(15)
    v_mfma_f32_32x32x16_bf16 v[224:239], v[88:91], a[68:71], v[224:239]
    ds_read_b64_tr_b16 v[84:85], v12 offset:61440
    ds_read_b64_tr_b16 v[86:87], v12 offset:61952
    ds_read_b64_tr_b16 a[202:203], v19 offset:35840
    ds_read_b64_tr_b16 a[204:205], v20 offset:34816
    ds_read_b64_tr_b16 a[206:207], v20 offset:35840
    v_mfma_f32_32x32x16_bf16 v[240:255], v[92:95], a[68:71], v[240:255]
    ds_read_b64_tr_b16 v[88:89], v11 offset:63488
    ds_read_b64_tr_b16 v[90:91], v11 offset:64000
    buffer_load_dwordx4 v10, s[24:27], s49 offen offset:1024 lds
    s_waitcnt lgkmcnt(15)
    v_mfma_f32_32x32x16_bf16 v[192:207], v[64:67], a[72:75], v[192:207]
    ds_read_b64_tr_b16 v[92:93], v12 offset:63488
    ds_read_b64_tr_b16 v[94:95], v12 offset:64000
    s_barrier
    v_mfma_f32_32x32x16_bf16 v[208:223], v[68:71], a[72:75], v[208:223]
    ds_read_b64_tr_b16 v[64:65], v13 offset:0
    ds_read_b64_tr_b16 v[66:67], v13 offset:512
    buffer_load_dwordx4 v7, s[24:27], s49 offen offset:2048 lds
    s_waitcnt lgkmcnt(15)
    v_mfma_f32_32x32x16_bf16 v[224:239], v[72:75], a[72:75], v[224:239]
    ds_read_b64_tr_b16 v[68:69], v14 offset:0
    ds_read_b64_tr_b16 v[70:71], v14 offset:512
    v_mfma_f32_32x32x16_bf16 v[240:255], v[76:79], a[72:75], v[240:255]
    ds_read_b64_tr_b16 v[72:73], v13 offset:2048
    ds_read_b64_tr_b16 v[74:75], v13 offset:2560
    buffer_load_dwordx4 v8, s[24:27], s49 offen offset:3072 lds
    s_add_u32 m0, s42, 0
    s_add_u32 s49, s49, 32768
    s_waitcnt lgkmcnt(13)
    v_mfma_f32_32x32x16_bf16 v[192:207], v[80:83], a[76:79], v[192:207]
    ds_read_b64_tr_b16 v[76:77], v14 offset:2048
    ds_read_b64_tr_b16 v[78:79], v14 offset:2560
    v_mfma_f32_32x32x16_bf16 v[208:223], v[84:87], a[76:79], v[208:223]
    ds_read_b64_tr_b16 v[80:81], v13 offset:4096
    ds_read_b64_tr_b16 v[82:83], v13 offset:4608
    buffer_load_dwordx4 v9, s[24:27], s49 offen offset:0 lds
    s_waitcnt lgkmcnt(10)
    v_mfma_f32_32x32x16_bf16 v[224:239], v[88:91], a[76:79], v[224:239]
    ds_read_b64_tr_b16 v[84:85], v14 offset:4096
    ds_read_b64_tr_b16 v[86:87], v14 offset:4608
    s_waitcnt vmcnt(4)
    v_cmp_eq_u32 s[76:77], s45, v29
    s_andn2_b64 s[76:77], s[78:79], s[76:77]
    s_cbranch_scc1 parallel_sum__sliding_block__glu_gated_bilinear__prompt_kernel_p1O
parallel_sum__sliding_block__glu_gated_bilinear__prompt_kernel_p1Or:
    v_mfma_f32_32x32x16_bf16 v[240:255], v[92:95], a[76:79], v[240:255]
    ds_read_b64_tr_b16 v[88:89], v13 offset:6144
    ds_read_b64_tr_b16 v[90:91], v13 offset:6656
    buffer_load_dwordx4 v10, s[24:27], s49 offen offset:1024 lds
    s_waitcnt lgkmcnt(10)
    v_mfma_f32_32x32x16_bf16 v[192:207], v[64:67], a[80:83], v[192:207]
    ds_read_b64_tr_b16 v[92:93], v14 offset:6144
    ds_read_b64_tr_b16 v[94:95], v14 offset:6656
    v_mfma_f32_32x32x16_bf16 v[208:223], v[68:71], a[80:83], v[208:223]
    ds_read_b64_tr_b16 v[64:65], v13 offset:8192
    ds_read_b64_tr_b16 v[66:67], v13 offset:8704
    buffer_load_dwordx4 v7, s[24:27], s49 offen offset:2048 lds
    s_waitcnt lgkmcnt(10)
    v_mfma_f32_32x32x16_bf16 v[224:239], v[72:75], a[80:83], v[224:239]
    ds_read_b64_tr_b16 v[68:69], v14 offset:8192
    ds_read_b64_tr_b16 v[70:71], v14 offset:8704
    v_mfma_f32_32x32x16_bf16 v[240:255], v[76:79], a[80:83], v[240:255]
    ds_read_b64_tr_b16 v[72:73], v13 offset:10240
    ds_read_b64_tr_b16 v[74:75], v13 offset:10752
    buffer_load_dwordx4 v8, s[24:27], s49 offen offset:3072 lds
    s_waitcnt lgkmcnt(10)
    v_mfma_f32_32x32x16_bf16 v[192:207], v[80:83], a[84:87], v[192:207]
    ds_read_b64_tr_b16 v[76:77], v14 offset:10240
    ds_read_b64_tr_b16 v[78:79], v14 offset:10752
    ds_read_b64_tr_b16 a[208:209], v19 offset:0
    ds_read_b64_tr_b16 a[210:211], v19 offset:1024
    v_mfma_f32_32x32x16_bf16 v[208:223], v[84:87], a[84:87], v[208:223]
    ds_read_b64_tr_b16 v[80:81], v13 offset:12288
    ds_read_b64_tr_b16 v[82:83], v13 offset:12800
    ds_read_b64_tr_b16 a[212:213], v20 offset:0
    ds_read_b64_tr_b16 a[214:215], v20 offset:1024
    ds_read_b64_tr_b16 a[216:217], v19 offset:2048
    s_waitcnt lgkmcnt(15)
    v_mfma_f32_32x32x16_bf16 v[224:239], v[88:91], a[84:87], v[224:239]
    ds_read_b64_tr_b16 v[84:85], v14 offset:12288
    ds_read_b64_tr_b16 v[86:87], v14 offset:12800
    ds_read_b64_tr_b16 a[218:219], v19 offset:3072
    ds_read_b64_tr_b16 a[220:221], v20 offset:2048
    ds_read_b64_tr_b16 a[222:223], v20 offset:3072
    v_mfma_f32_32x32x16_bf16 v[240:255], v[92:95], a[84:87], v[240:255]
    ds_read_b64_tr_b16 v[88:89], v13 offset:14336
    ds_read_b64_tr_b16 v[90:91], v13 offset:14848
    buffer_load_dwordx4 v[100:103], v2, s[16:19], s61 offen sc1
    s_waitcnt lgkmcnt(15)
    v_mfma_f32_32x32x16_bf16 v[192:207], v[64:67], a[88:91], v[192:207]
    ds_read_b64_tr_b16 v[92:93], v14 offset:14336
    ds_read_b64_tr_b16 v[94:95], v14 offset:14848
    s_barrier
    v_mfma_f32_32x32x16_bf16 v[208:223], v[68:71], a[88:91], v[208:223]
    ds_read_b64_tr_b16 v[64:65], v13 offset:16384
    ds_read_b64_tr_b16 v[66:67], v13 offset:16896
    buffer_load_dwordx4 a[36:39], v26, s[16:19], s61 offen sc1
    s_waitcnt lgkmcnt(15)
    v_mfma_f32_32x32x16_bf16 v[224:239], v[72:75], a[88:91], v[224:239]
    ds_read_b64_tr_b16 v[68:69], v14 offset:16384
    ds_read_b64_tr_b16 v[70:71], v14 offset:16896
    v_mfma_f32_32x32x16_bf16 v[240:255], v[76:79], a[88:91], v[240:255]
    ds_read_b64_tr_b16 v[72:73], v13 offset:18432
    ds_read_b64_tr_b16 v[74:75], v13 offset:18944
    buffer_load_dwordx4 v[176:179], v27, s[16:19], s61 offen sc1
    s_waitcnt lgkmcnt(13)
    v_mfma_f32_32x32x16_bf16 v[192:207], v[80:83], a[92:95], v[192:207]
    ds_read_b64_tr_b16 v[76:77], v14 offset:18432
    ds_read_b64_tr_b16 v[78:79], v14 offset:18944
    s_waitcnt vmcnt(7)
    ds_read_b64_tr_b16 a[224:225], v19 offset:16384
    ds_read_b64_tr_b16 a[226:227], v19 offset:17408
    v_mfma_f32_32x32x16_bf16 v[208:223], v[84:87], a[92:95], v[208:223]
    ds_read_b64_tr_b16 v[80:81], v13 offset:20480
    ds_read_b64_tr_b16 v[82:83], v13 offset:20992
    ds_read_b64_tr_b16 a[228:229], v20 offset:16384
    ds_read_b64_tr_b16 a[230:231], v20 offset:17408
    ds_read_b64_tr_b16 a[232:233], v19 offset:18432
    s_waitcnt lgkmcnt(15)
    v_mfma_f32_32x32x16_bf16 v[224:239], v[88:91], a[92:95], v[224:239]
    ds_read_b64_tr_b16 v[84:85], v14 offset:20480
    ds_read_b64_tr_b16 v[86:87], v14 offset:20992
    ds_read_b64_tr_b16 a[234:235], v19 offset:19456
    ds_read_b64_tr_b16 a[236:237], v20 offset:18432
    ds_read_b64_tr_b16 a[238:239], v20 offset:19456
    v_mfma_f32_32x32x16_bf16 v[240:255], v[92:95], a[92:95], v[240:255]
    ds_read_b64_tr_b16 v[88:89], v13 offset:22528
    ds_read_b64_tr_b16 v[90:91], v13 offset:23040
    s_sub_u32 s61, s61, 32768
    buffer_load_dwordx4 v[96:99], v2, s[16:19], s61 offen sc1
    s_waitcnt lgkmcnt(15)
    v_mfma_f32_32x32x16_bf16 v[192:207], v[64:67], a[96:99], v[192:207]
    ds_read_b64_tr_b16 v[92:93], v14 offset:22528
    ds_read_b64_tr_b16 v[94:95], v14 offset:23040
    v_mfma_f32_32x32x16_bf16 v[208:223], v[68:71], a[96:99], v[208:223]
    ds_read_b64_tr_b16 v[64:65], v13 offset:24576
    ds_read_b64_tr_b16 v[66:67], v13 offset:25088
    buffer_load_dwordx4 a[32:35], v26, s[16:19], s61 offen sc1
    s_waitcnt lgkmcnt(15)
    v_mfma_f32_32x32x16_bf16 v[224:239], v[72:75], a[96:99], v[224:239]
    ds_read_b64_tr_b16 v[68:69], v14 offset:24576
    ds_read_b64_tr_b16 v[70:71], v14 offset:25088
    v_mfma_f32_32x32x16_bf16 v[240:255], v[76:79], a[96:99], v[240:255]
    ds_read_b64_tr_b16 v[72:73], v13 offset:26624
    ds_read_b64_tr_b16 v[74:75], v13 offset:27136
    buffer_load_dwordx4 v[168:171], v27, s[16:19], s61 offen sc1
    s_waitcnt lgkmcnt(13)
    v_mfma_f32_32x32x16_bf16 v[192:207], v[80:83], a[100:103], v[192:207]
    ds_read_b64_tr_b16 v[76:77], v14 offset:26624
    ds_read_b64_tr_b16 v[78:79], v14 offset:27136
    v_mfma_f32_32x32x16_bf16 v[208:223], v[84:87], a[100:103], v[208:223]
    ds_read_b64_tr_b16 v[80:81], v13 offset:28672
    ds_read_b64_tr_b16 v[82:83], v13 offset:29184
    s_sub_u32 s61, s61, 32768
    s_cmp_le_u32 s68, 0
    s_cselect_b32 s18, 0, s18
    buffer_load_dwordx4 a[28:31], v26, s[16:19], s61 offen sc1
    s_waitcnt lgkmcnt(10)
    v_mfma_f32_32x32x16_bf16 v[224:239], v[88:91], a[100:103], v[224:239]
    ds_read_b64_tr_b16 v[84:85], v14 offset:28672
    ds_read_b64_tr_b16 v[86:87], v14 offset:29184
    v_mfma_f32_32x32x16_bf16 v[240:255], v[92:95], a[100:103], v[240:255]
    ds_read_b64_tr_b16 v[88:89], v13 offset:30720
    ds_read_b64_tr_b16 v[90:91], v13 offset:31232
    buffer_load_dwordx4 v[160:163], v27, s[16:19], s61 offen sc1
    s_waitcnt lgkmcnt(10)
    v_mfma_f32_32x32x16_bf16 v[192:207], v[64:67], a[104:107], v[192:207]
    ds_read_b64_tr_b16 v[92:93], v14 offset:30720
    ds_read_b64_tr_b16 v[94:95], v14 offset:31232
    s_barrier
    v_mfma_f32_32x32x16_bf16 v[208:223], v[68:71], a[104:107], v[208:223]
    ds_read_b64_tr_b16 v[64:65], v13 offset:32768
    ds_read_b64_tr_b16 v[66:67], v13 offset:33280
    s_sub_u32 s61, s61, 32768
    buffer_load_dwordx4 a[24:27], v26, s[16:19], s61 offen sc1
    s_waitcnt lgkmcnt(10)
    v_mfma_f32_32x32x16_bf16 v[224:239], v[72:75], a[104:107], v[224:239]
    ds_read_b64_tr_b16 v[68:69], v13 offset:34816
    ds_read_b64_tr_b16 v[70:71], v13 offset:35328
    v_mfma_f32_32x32x16_bf16 v[240:255], v[76:79], a[104:107], v[240:255]
    ds_read_b64_tr_b16 v[72:73], v13 offset:36864
    ds_read_b64_tr_b16 v[74:75], v13 offset:37376
    buffer_load_dwordx4 v[152:155], v27, s[16:19], s61 offen sc1
    s_waitcnt lgkmcnt(10)
    v_mfma_f32_32x32x16_bf16 v[192:207], v[80:83], a[108:111], v[192:207]
    ds_read_b64_tr_b16 v[76:77], v13 offset:38912
    ds_read_b64_tr_b16 v[78:79], v13 offset:39424
    v_mfma_f32_32x32x16_bf16 v[208:223], v[84:87], a[108:111], v[208:223]
    ds_read_b64_tr_b16 v[80:81], v13 offset:40960
    ds_read_b64_tr_b16 v[82:83], v13 offset:41472
    s_sub_u32 s61, s61, 32768
    s_cmp_le_u32 s68, 1
    s_cselect_b32 s18, 0, s18
    buffer_load_dwordx4 a[20:23], v26, s[16:19], s61 offen sc1
    s_waitcnt lgkmcnt(10)
    v_mfma_f32_32x32x16_bf16 v[224:239], v[88:91], a[108:111], v[224:239]
    ds_read_b64_tr_b16 v[84:85], v13 offset:43008
    ds_read_b64_tr_b16 v[86:87], v13 offset:43520
    v_mfma_f32_32x32x16_bf16 v[240:255], v[92:95], a[108:111], v[240:255]
    ds_read_b64_tr_b16 v[88:89], v13 offset:45056
    ds_read_b64_tr_b16 v[90:91], v13 offset:45568
    buffer_load_dwordx4 v[144:147], v27, s[16:19], s61 offen sc1
    s_waitcnt lgkmcnt(10)
    v_mfma_f32_32x32x16_bf16 v[192:207], v[64:67], a[112:115], v[192:207]
    ds_read_b64_tr_b16 v[92:93], v13 offset:47104
    ds_read_b64_tr_b16 v[94:95], v13 offset:47616
    v_mfma_f32_32x32x16_bf16 v[224:239], v[68:71], a[112:115], v[224:239]
    ds_read_b64_tr_b16 v[64:65], v14 offset:32768
    ds_read_b64_tr_b16 v[66:67], v14 offset:33280
    s_sub_u32 s61, s61, 32768
    buffer_load_dwordx4 a[16:19], v26, s[16:19], s61 offen sc1
    s_waitcnt lgkmcnt(10)
    v_mfma_f32_32x32x16_bf16 v[192:207], v[72:75], a[116:119], v[192:207]
    ds_read_b64_tr_b16 v[68:69], v14 offset:34816
    ds_read_b64_tr_b16 v[70:71], v14 offset:35328
    v_mfma_f32_32x32x16_bf16 v[224:239], v[76:79], a[116:119], v[224:239]
    ds_read_b64_tr_b16 v[72:73], v14 offset:36864
    ds_read_b64_tr_b16 v[74:75], v14 offset:37376
    buffer_load_dwordx4 v[136:139], v27, s[16:19], s61 offen sc1
    s_waitcnt lgkmcnt(10)
    v_mfma_f32_32x32x16_bf16 v[192:207], v[80:83], a[120:123], v[192:207]
    ds_read_b64_tr_b16 v[76:77], v14 offset:38912
    ds_read_b64_tr_b16 v[78:79], v14 offset:39424
    v_mfma_f32_32x32x16_bf16 v[224:239], v[84:87], a[120:123], v[224:239]
    ds_read_b64_tr_b16 v[80:81], v14 offset:40960
    ds_read_b64_tr_b16 v[82:83], v14 offset:41472
    s_sub_u32 s61, s61, 32768
    s_cmp_le_u32 s68, 2
    s_cselect_b32 s18, 0, s18
    buffer_load_dwordx4 a[12:15], v26, s[16:19], s61 offen sc1
    s_waitcnt lgkmcnt(10)
    v_mfma_f32_32x32x16_bf16 v[192:207], v[88:91], a[124:127], v[192:207]
    ds_read_b64_tr_b16 v[84:85], v14 offset:43008
    ds_read_b64_tr_b16 v[86:87], v14 offset:43520
    v_mfma_f32_32x32x16_bf16 v[224:239], v[92:95], a[124:127], v[224:239]
    ds_read_b64_tr_b16 v[88:89], v14 offset:45056
    ds_read_b64_tr_b16 v[90:91], v14 offset:45568
    buffer_load_dwordx4 v[128:131], v27, s[16:19], s61 offen sc1
    s_waitcnt lgkmcnt(10)
    v_mfma_f32_32x32x16_bf16 v[208:223], v[64:67], a[112:115], v[208:223]
    ds_read_b64_tr_b16 v[92:93], v14 offset:47104
    ds_read_b64_tr_b16 v[94:95], v14 offset:47616
    v_mfma_f32_32x32x16_bf16 v[240:255], v[68:71], a[112:115], v[240:255]
    s_sub_u32 s61, s61, 32768
    buffer_load_dwordx4 a[8:11], v26, s[16:19], s61 offen sc1
    s_waitcnt lgkmcnt(8)
    v_mfma_f32_32x32x16_bf16 v[208:223], v[72:75], a[116:119], v[208:223]
    v_mul_f32 v192, v192, v224
    v_mul_f32 v193, v193, v225
    v_mul_f32 v194, v194, v226
    v_mul_f32 v195, v195, v227
    v_mul_f32 v196, v196, v228
    v_mul_f32 v197, v197, v229
    v_mul_f32 v198, v198, v230
    v_mfma_f32_32x32x16_bf16 v[240:255], v[76:79], a[116:119], v[240:255]
    v_mul_f32 v199, v199, v231
    v_cvt_pk_bf16_f32 v192, v192, v193
    v_cvt_pk_bf16_f32 v193, v194, v195
    v_cvt_pk_bf16_f32 v194, v196, v197
    v_cvt_pk_bf16_f32 v195, v198, v199
    s_waitcnt lgkmcnt(4)
    v_mfma_f32_32x32x16_bf16 v[208:223], v[80:83], a[120:123], v[208:223]
    buffer_store_dwordx4 v[192:195], v2, s[20:23], s57 offen offset:0 sc1
    v_mfma_f32_32x32x16_bf16 v[240:255], v[84:87], a[120:123], v[240:255]
    v_mul_f32 v200, v200, v232
    v_mul_f32 v201, v201, v233
    v_mul_f32 v202, v202, v234
    v_mul_f32 v203, v203, v235
    v_mul_f32 v204, v204, v236
    v_mul_f32 v205, v205, v237
    v_mul_f32 v206, v206, v238
    v_mul_f32 v207, v207, v239
    s_waitcnt lgkmcnt(0)
    v_mfma_f32_32x32x16_bf16 v[208:223], v[88:91], a[124:127], v[208:223]
    v_cvt_pk_bf16_f32 v200, v200, v201
    v_cvt_pk_bf16_f32 v201, v202, v203
    v_cvt_pk_bf16_f32 v202, v204, v205
    v_cvt_pk_bf16_f32 v203, v206, v207
    v_mfma_f32_32x32x16_bf16 v[240:255], v[92:95], a[124:127], v[240:255]
    buffer_store_dwordx4 v[200:203], v2, s[20:23], s57 offen offset:1024 sc1
    buffer_load_dwordx4 v[120:123], v27, s[16:19], s61 offen sc1
    s_sub_u32 s61, s61, 32768
    s_cmp_le_u32 s68, 3
    s_cselect_b32 s18, 0, s18
    buffer_load_dwordx4 a[4:7], v26, s[16:19], s61 offen sc1
    buffer_load_dwordx4 v[112:115], v27, s[16:19], s61 offen sc1
    s_sub_u32 s61, s61, 32768
    buffer_load_dwordx4 a[0:3], v26, s[16:19], s61 offen sc1
    buffer_load_dwordx4 v[104:107], v27, s[16:19], s61 offen sc1
    s_branch parallel_sum__sliding_block__glu_gated_bilinear__prompt_kernel_ws6
parallel_sum__sliding_block__glu_gated_bilinear__prompt_kernel_w2G3_0:
    s_branch parallel_sum__sliding_block__glu_gated_bilinear__prompt_kernel_wr2G
parallel_sum__sliding_block__glu_gated_bilinear__prompt_kernel_ws6:
parallel_sum__sliding_block__glu_gated_bilinear__prompt_kernel_p2:
    s_waitcnt vmcnt(22)
    v_mfma_f32_32x32x16_bf16 v[224:239], a[36:39], v[100:103], v[48:63]
    s_add_u32 m0, s42, 16384
    s_bfe_u32 s49, s44, 0x30010
    s_lshl_b32 s49, s49, 16
    s_add_u32 s49, s49, s59
    buffer_load_dwordx4 v9, s[24:27], s49 offen offset:0 lds
    buffer_load_dwordx4 v10, s[24:27], s49 offen offset:1024 lds
    v_mul_f32 v208, v208, v240
    v_mul_f32 v209, v209, v241
    v_mul_f32 v210, v210, v242
    v_mul_f32 v211, v211, v243
    v_mul_f32 v212, v212, v244
    v_mul_f32 v213, v213, v245
    v_mul_f32 v214, v214, v246
    v_mul_f32 v215, v215, v247
    v_mul_f32 v216, v216, v248
    v_mul_f32 v217, v217, v249
    v_mul_f32 v218, v218, v250
    v_mul_f32 v219, v219, v251
    v_mul_f32 v220, v220, v252
    v_mul_f32 v221, v221, v253
    v_mul_f32 v222, v222, v254
    v_mul_f32 v223, v223, v255
    s_waitcnt vmcnt(21)
    v_mfma_f32_32x32x16_bf16 v[240:255], a[32:35], v[96:99], v[48:63]
    v_cvt_pk_bf16_f32 v208, v208, v209
    v_cvt_pk_bf16_f32 v209, v210, v211
    v_cvt_pk_bf16_f32 v210, v212, v213
    v_cvt_pk_bf16_f32 v211, v214, v215
    buffer_store_dwordx4 v[208:211], v2, s[20:23], s57 offen offset:2048 sc1
    v_cvt_pk_bf16_f32 v216, v216, v217
    v_cvt_pk_bf16_f32 v217, v218, v219
    v_cvt_pk_bf16_f32 v218, v220, v221
    v_cvt_pk_bf16_f32 v219, v222, v223
    buffer_store_dwordx4 v[216:219], v2, s[20:23], s57 offen offset:3072 sc1
    v_exp_f32 v224, v224
    v_exp_f32 v225, v225
    v_exp_f32 v226, v226
    v_exp_f32 v227, v227
    s_mov_b32 s78, 0
    s_mov_b32 s79, 0x7700
    buffer_load_dword v29, v28, s[20:23], s60 offen sc1
    v_exp_f32 v228, v228
    v_exp_f32 v229, v229
    v_exp_f32 v230, v230
    v_exp_f32 v231, v231
    buffer_load_dwordx4 v7, s[24:27], s49 offen offset:2048 lds
    v_cvt_pk_bf16_f32 v224, v224, v225
    v_cvt_pk_bf16_f32 v225, v226, v227
    v_cvt_pk_bf16_f32 v226, v228, v229
    v_cvt_pk_bf16_f32 v227, v230, v231
    v_permlane16_swap_b32 v176, v180
    v_permlane16_swap_b32 v177, v181
    v_permlane16_swap_b32 v178, v182
    v_permlane16_swap_b32 v179, v183
    v_exp_f32 v232, v232
    v_exp_f32 v233, v233
    v_mfma_f32_32x32x16_bf16 v[208:223], v[176:179], v[224:227], 0
    v_exp_f32 v234, v234
    v_exp_f32 v235, v235
    buffer_load_dwordx4 v8, s[24:27], s49 offen offset:3072 lds
    ds_read_b64_tr_b16 a[240:241], v3 offset:0
    v_exp_f32 v236, v236
    v_exp_f32 v237, v237
    v_exp_f32 v238, v238
    s_add_u32 m0, s42, 32768
    s_add_u32 s49, s49, 32768
    buffer_load_dwordx4 v9, s[24:27], s49 offen offset:0 lds
    ds_read_b64_tr_b16 a[242:243], v3 offset:1024
    v_exp_f32 v239, v239
    v_cvt_pk_bf16_f32 v232, v232, v233
    v_cvt_pk_bf16_f32 v233, v234, v235
    v_cvt_pk_bf16_f32 v234, v236, v237
    v_cvt_pk_bf16_f32 v235, v238, v239
    v_exp_f32 v240, v240
    v_exp_f32 v241, v241
    v_mfma_f32_32x32x16_bf16 v[208:223], v[180:183], v[232:235], v[208:223]
    v_exp_f32 v242, v242
    v_exp_f32 v243, v243
    buffer_load_dwordx4 v10, s[24:27], s49 offen offset:1024 lds
    v_exp_f32 v244, v244
    v_exp_f32 v245, v245
    v_mfma_f32_32x32x16_bf16 v[224:239], a[32:35], v[100:103], 0
    v_exp_f32 v246, v246
    v_exp_f32 v247, v247
    buffer_load_dwordx4 v7, s[24:27], s49 offen offset:2048 lds
    v_cvt_pk_bf16_f32 v240, v240, v241
    v_cvt_pk_bf16_f32 v241, v242, v243
    v_cvt_pk_bf16_f32 v242, v244, v245
    v_cvt_pk_bf16_f32 v243, v246, v247
    s_waitcnt vmcnt(28)
    v_permlane16_swap_b32 v168, v172
    v_permlane16_swap_b32 v169, v173
    v_permlane16_swap_b32 v170, v174
    v_permlane16_swap_b32 v171, v175
    v_exp_f32 v248, v248
    v_exp_f32 v249, v249
    v_mfma_f32_32x32x16_bf16 v[192:207], v[168:171], v[240:243], 0
    v_exp_f32 v250, v250
    v_exp_f32 v251, v251
    buffer_load_dwordx4 v8, s[24:27], s49 offen offset:3072 lds
    ds_read_b64_tr_b16 a[244:245], v4 offset:0
    v_exp_f32 v252, v252
    v_exp_f32 v253, v253
    v_exp_f32 v254, v254
    s_add_u32 m0, s42, 49152
    s_bfe_u32 s49, s44, 0x30014
    s_lshl_b32 s49, s49, 16
    s_add_u32 s49, s49, s59
    buffer_load_dwordx4 v9, s[24:27], s49 offen offset:0 lds
    ds_read_b64_tr_b16 a[246:247], v4 offset:1024
    v_exp_f32 v255, v255
    v_cvt_pk_bf16_f32 v248, v248, v249
    v_cvt_pk_bf16_f32 v249, v250, v251
    v_cvt_pk_bf16_f32 v250, v252, v253
    v_cvt_pk_bf16_f32 v251, v254, v255
    v_exp_f32 v224, v224
    v_exp_f32 v225, v225
    v_mfma_f32_32x32x16_bf16 v[192:207], v[172:175], v[248:251], v[192:207]
    v_exp_f32 v226, v226
    v_exp_f32 v227, v227
    buffer_load_dwordx4 v10, s[24:27], s49 offen offset:1024 lds
    v_exp_f32 v228, v228
    v_exp_f32 v229, v229
    s_waitcnt vmcnt(30)
    v_mfma_f32_32x32x16_bf16 v[240:255], a[28:31], v[96:99], 0
    s_waitcnt vmcnt(8)
    v_cmp_eq_u32 s[76:77], s45, v29
    s_andn2_b64 s[76:77], s[78:79], s[76:77]
    s_cbranch_scc1 parallel_sum__sliding_block__glu_gated_bilinear__prompt_kernel_pq1
parallel_sum__sliding_block__glu_gated_bilinear__prompt_kernel_pq1r:
    v_exp_f32 v230, v230
    v_exp_f32 v231, v231
    s_bfe_u32 s69, s44, 0x30000
    s_lshl_b32 s69, s69, 12
    s_add_u32 s69, s69, s62
    buffer_load_dwordx4 v[184:187], v30, s[20:23], s69 offen offset:0 sc1
    v_cvt_pk_bf16_f32 v224, v224, v225
    v_cvt_pk_bf16_f32 v225, v226, v227
    v_cvt_pk_bf16_f32 v226, v228, v229
    v_cvt_pk_bf16_f32 v227, v230, v231
    ds_read_b64_tr_b16 a[248:249], v3 offset:2048
    ds_read_b64_tr_b16 a[250:251], v3 offset:3072
    v_exp_f32 v232, v232
    v_exp_f32 v233, v233
    v_mfma_f32_32x32x16_bf16 v[208:223], v[168:171], v[224:227], v[208:223]
    v_exp_f32 v234, v234
    v_exp_f32 v235, v235
    buffer_load_dwordx4 v[188:191], v31, s[20:23], s69 offen offset:0 sc1
    ds_read_b64_tr_b16 a[252:253], v4 offset:2048
    v_exp_f32 v236, v236
    v_exp_f32 v237, v237
    v_exp_f32 v238, v238
    buffer_load_dwordx4 a[40:43], v30, s[20:23], s69 offen offset:1024 sc1
    ds_read_b64_tr_b16 a[254:255], v4 offset:3072
    v_exp_f32 v239, v239
    v_cvt_pk_bf16_f32 v232, v232, v233
    v_cvt_pk_bf16_f32 v233, v234, v235
    v_cvt_pk_bf16_f32 v234, v236, v237
    v_cvt_pk_bf16_f32 v235, v238, v239
    v_exp_f32 v240, v240
    v_exp_f32 v241, v241
    v_mfma_f32_32x32x16_bf16 v[208:223], v[172:175], v[232:235], v[208:223]
    v_exp_f32 v242, v242
    v_exp_f32 v243, v243
    buffer_load_dwordx4 a[44:47], v31, s[20:23], s69 offen offset:1024 sc1
    v_exp_f32 v244, v244
    v_exp_f32 v245, v245
    v_mfma_f32_32x32x16_bf16 v[224:239], a[28:31], v[100:103], 0
    v_exp_f32 v246, v246
    v_exp_f32 v247, v247
    buffer_load_dwordx4 a[48:51], v30, s[20:23], s69 offen offset:2048 sc1
    v_cvt_pk_bf16_f32 v240, v240, v241
    v_cvt_pk_bf16_f32 v241, v242, v243
    v_cvt_pk_bf16_f32 v242, v244, v245
    v_cvt_pk_bf16_f32 v243, v246, v247
    v_permlane16_swap_b32 v160, v164
    v_permlane16_swap_b32 v161, v165
    v_permlane16_swap_b32 v162, v166
    v_permlane16_swap_b32 v163, v167
    v_exp_f32 v248, v248
    v_exp_f32 v249, v249
    v_mfma_f32_32x32x16_bf16 v[192:207], v[160:163], v[240:243], v[192:207]
    v_exp_f32 v250, v250
    v_exp_f32 v251, v251
    buffer_load_dwordx4 a[52:55], v31, s[20:23], s69 offen offset:2048 sc1
    v_exp_f32 v252, v252
    v_exp_f32 v253, v253
    v_exp_f32 v254, v254
    buffer_load_dwordx4 a[56:59], v30, s[20:23], s69 offen offset:3072 sc1
    v_exp_f32 v255, v255
    v_cvt_pk_bf16_f32 v248, v248, v249
    v_cvt_pk_bf16_f32 v249, v250, v251
    v_cvt_pk_bf16_f32 v250, v252, v253
    v_cvt_pk_bf16_f32 v251, v254, v255
    v_exp_f32 v224, v224
    v_exp_f32 v225, v225
    v_mfma_f32_32x32x16_bf16 v[192:207], v[164:167], v[248:251], v[192:207]
    v_exp_f32 v226, v226
    v_exp_f32 v227, v227
    s_mov_b64 exec, 1
    buffer_store_dword v21, off, s[20:23], s58 sc1
    s_mov_b64 exec, -1
    v_exp_f32 v228, v228
    v_exp_f32 v229, v229
    v_mfma_f32_32x32x16_bf16 v[240:255], a[24:27], v[96:99], 0
    v_xor_b32 v48, 0xf149f2ca, v48
    v_xor_b32 v49, 0xf149f2ca, v49
    v_exp_f32 v230, v230
    v_exp_f32 v231, v231
    buffer_load_dwordx4 a[60:63], v31, s[20:23], s69 offen offset:3072 sc1
    v_cvt_pk_bf16_f32 v224, v224, v225
    s_branch parallel_sum__sliding_block__glu_gated_bilinear__prompt_kernel_ws7
parallel_sum__sliding_block__glu_gated_bilinear__prompt_kernel_w3G0_0:
    s_branch parallel_sum__sliding_block__glu_gated_bilinear__prompt_kernel_wr3G
parallel_sum__sliding_block__glu_gated_bilinear__prompt_kernel_w2O0_0:
    s_branch parallel_sum__sliding_block__glu_gated_bilinear__prompt_kernel_wr2O
parallel_sum__sliding_block__glu_gated_bilinear__prompt_kernel_ws7:
    v_cvt_pk_bf16_f32 v225, v226, v227
    v_cvt_pk_bf16_f32 v226, v228, v229
    v_cvt_pk_bf16_f32 v227, v230, v231
    v_exp_f32 v232, v232
    v_exp_f32 v233, v233
    v_mfma_f32_32x32x16_bf16 v[208:223], v[160:163], v[224:227], v[208:223]
    v_exp_f32 v234, v234
    v_exp_f32 v235, v235
    s_bfe_u32 s69, s44, 0x30004
    s_lshl_b32 s69, s69, 12
    s_add_u32 s69, s69, s62
    buffer_load_dwordx4 a[64:67], v30, s[20:23], s69 offen offset:0 sc1
    s_waitcnt vmcnt(8)
    v_mfma_f32_32x32x16_bf16 a[112:127], a[132:135], v[188:191], 0
    v_exp_f32 v236, v236
    v_exp_f32 v237, v237
    v_exp_f32 v238, v238
    buffer_load_dwordx4 a[68:71], v31, s[20:23], s69 offen offset:0 sc1
    v_mfma_f32_32x32x16_bf16 a[96:111], a[132:135], v[184:187], 0
    v_exp_f32 v239, v239
    v_cvt_pk_bf16_f32 v232, v232, v233
    v_cvt_pk_bf16_f32 v233, v234, v235
    v_cvt_pk_bf16_f32 v234, v236, v237
    v_cvt_pk_bf16_f32 v235, v238, v239
    v_exp_f32 v240, v240
    v_exp_f32 v241, v241
    v_mfma_f32_32x32x16_bf16 v[208:223], v[164:167], v[232:235], v[208:223]
    v_exp_f32 v242, v242
    v_exp_f32 v243, v243
    buffer_load_dwordx4 a[72:75], v30, s[20:23], s69 offen offset:1024 sc1
    v_exp_f32 v244, v244
    v_exp_f32 v245, v245
    v_mfma_f32_32x32x16_bf16 v[224:239], a[24:27], v[100:103], 0
    v_xor_b32 v50, 0xf149f2ca, v50
    v_xor_b32 v51, 0xf149f2ca, v51
    v_exp_f32 v246, v246
    v_exp_f32 v247, v247
    buffer_load_dwordx4 a[76:79], v31, s[20:23], s69 offen offset:1024 sc1
    v_mfma_f32_32x32x16_bf16 v[80:95], a[128:131], v[188:191], 0
    v_cvt_pk_bf16_f32 v240, v240, v241
    v_cvt_pk_bf16_f32 v241, v242, v243
    v_cvt_pk_bf16_f32 v242, v244, v245
    v_cvt_pk_bf16_f32 v243, v246, v247
    v_permlane16_swap_b32 v152, v156
    v_permlane16_swap_b32 v153, v157
    v_permlane16_swap_b32 v154, v158
    v_permlane16_swap_b32 v155, v159
    v_exp_f32 v248, v248
    v_exp_f32 v249, v249
    v_mfma_f32_32x32x16_bf16 v[192:207], v[152:155], v[240:243], v[192:207]
    v_exp_f32 v250, v250
    v_exp_f32 v251, v251
    buffer_load_dwordx4 a[80:83], v30, s[20:23], s69 offen offset:2048 sc1
    v_mfma_f32_32x32x16_bf16 v[64:79], a[128:131], v[184:187], 0
    ds_read_b64_tr_b16 a[128:129], v3 offset:16384
    v_exp_f32 v252, v252
    v_exp_f32 v253, v253
    v_exp_f32 v254, v254
    buffer_load_dwordx4 a[84:87], v31, s[20:23], s69 offen offset:2048 sc1
    s_waitcnt vmcnt(11)
    v_mfma_f32_32x32x16_bf16 a[112:127], a[140:143], a[44:47], a[112:127]
    ds_read_b64_tr_b16 a[130:131], v3 offset:17408
    v_exp_f32 v255, v255
    v_cvt_pk_bf16_f32 v248, v248, v249
    v_cvt_pk_bf16_f32 v249, v250, v251
    v_cvt_pk_bf16_f32 v250, v252, v253
    v_cvt_pk_bf16_f32 v251, v254, v255
    v_exp_f32 v224, v224
    v_exp_f32 v225, v225
    v_mfma_f32_32x32x16_bf16 v[192:207], v[156:159], v[248:251], v[192:207]
    v_exp_f32 v226, v226
    v_exp_f32 v227, v227
    buffer_load_dwordx4 a[88:91], v30, s[20:23], s69 offen offset:3072 sc1
    v_exp_f32 v228, v228
    v_exp_f32 v229, v229
    v_mfma_f32_32x32x16_bf16 v[240:255], a[20:23], v[96:99], 0
    v_xor_b32 v52, 0xf149f2ca, v52
    v_xor_b32 v53, 0xf149f2ca, v53
    v_exp_f32 v230, v230
    v_exp_f32 v231, v231
    buffer_load_dwordx4 a[92:95], v31, s[20:23], s69 offen offset:3072 sc1
    v_mfma_f32_32x32x16_bf16 a[96:111], a[140:143], a[40:43], a[96:111]
    v_cvt_pk_bf16_f32 v224, v224, v225
    v_cvt_pk_bf16_f32 v225, v226, v227
    v_cvt_pk_bf16_f32 v226, v228, v229
    v_cvt_pk_bf16_f32 v227, v230, v231
    ds_read_b64_tr_b16 a[132:133], v4 offset:16384
    ds_read_b64_tr_b16 a[134:135], v4 offset:17408
    v_exp_f32 v232, v232
    v_exp_f32 v233, v233
    v_mfma_f32_32x32x16_bf16 v[208:223], v[152:155], v[224:227], v[208:223]
    v_exp_f32 v234, v234
    v_exp_f32 v235, v235
    s_bfe_u32 s69, s44, 0x30008
    s_lshl_b32 s69, s69, 12
    s_add_u32 s69, s69, s62
    buffer_load_dwordx4 v[32:35], v30, s[20:23], s69 offen offset:0 sc1
    v_mfma_f32_32x32x16_bf16 v[80:95], a[136:139], a[44:47], v[80:95]
    v_exp_f32 v236, v236
    v_exp_f32 v237, v237
    v_exp_f32 v238, v238
    buffer_load_dwordx4 v[36:39], v31, s[20:23], s69 offen offset:0 sc1
    v_mfma_f32_32x32x16_bf16 v[64:79], a[136:139], a[40:43], v[64:79]
    ds_read_b64_tr_b16 a[136:137], v3 offset:18432
    v_exp_f32 v239, v239
    v_cvt_pk_bf16_f32 v232, v232, v233
    v_cvt_pk_bf16_f32 v233, v234, v235
    v_cvt_pk_bf16_f32 v234, v236, v237
    v_cvt_pk_bf16_f32 v235, v238, v239
    v_exp_f32 v240, v240
    v_exp_f32 v241, v241
    v_mfma_f32_32x32x16_bf16 v[208:223], v[156:159], v[232:235], v[208:223]
    v_exp_f32 v242, v242
    v_exp_f32 v243, v243
    buffer_load_dwordx4 v[40:43], v30, s[20:23], s69 offen offset:1024 sc1
    v_exp_f32 v244, v244
    v_exp_f32 v245, v245
    v_mfma_f32_32x32x16_bf16 v[224:239], a[20:23], v[100:103], 0
    v_xor_b32 v54, 0xf149f2ca, v54
    v_xor_b32 v55, 0xf149f2ca, v55
    v_exp_f32 v246, v246
    v_exp_f32 v247, v247
    buffer_load_dwordx4 v[44:47], v31, s[20:23], s69 offen offset:1024 sc1
    s_waitcnt vmcnt(15)
    v_mfma_f32_32x32x16_bf16 a[112:127], a[148:151], a[52:55], a[112:127]
    v_cvt_pk_bf16_f32 v240, v240, v241
    v_cvt_pk_bf16_f32 v241, v242, v243
    v_cvt_pk_bf16_f32 v242, v244, v245
    v_cvt_pk_bf16_f32 v243, v246, v247
    v_permlane16_swap_b32 v144, v148
    v_permlane16_swap_b32 v145, v149
    v_permlane16_swap_b32 v146, v150
    v_permlane16_swap_b32 v147, v151
    v_exp_f32 v248, v248
    v_exp_f32 v249, v249
    v_mfma_f32_32x32x16_bf16 v[192:207], v[144:147], v[240:243], v[192:207]
    v_exp_f32 v250, v250
    v_exp_f32 v251, v251
    buffer_load_dwordx4 a[32:35], v30, s[20:23], s69 offen offset:2048 sc1
    v_mfma_f32_32x32x16_bf16 a[96:111], a[148:151], a[48:51], a[96:111]
    ds_read_b64_tr_b16 a[138:139], v3 offset:19456
    v_exp_f32 v252, v252
    v_exp_f32 v253, v253
    v_exp_f32 v254, v254
    buffer_load_dwordx4 a[36:39], v31, s[20:23], s69 offen offset:2048 sc1
    v_mfma_f32_32x32x16_bf16 v[80:95], a[144:147], a[52:55], v[80:95]
    ds_read_b64_tr_b16 a[140:141], v4 offset:18432
    v_exp_f32 v255, v255
    v_cvt_pk_bf16_f32 v248, v248, v249
    v_cvt_pk_bf16_f32 v249, v250, v251
    v_cvt_pk_bf16_f32 v250, v252, v253
    v_cvt_pk_bf16_f32 v251, v254, v255
    v_exp_f32 v224, v224
    v_exp_f32 v225, v225
    v_mfma_f32_32x32x16_bf16 v[192:207], v[148:151], v[248:251], v[192:207]
    v_exp_f32 v226, v226
    v_exp_f32 v227, v227
    buffer_load_dwordx4 a[28:31], v30, s[20:23], s69 offen offset:3072 sc1
    v_exp_f32 v228, v228
    v_exp_f32 v229, v229
    v_mfma_f32_32x32x16_bf16 v[240:255], a[16:19], v[96:99], 0
    v_xor_b32 v56, 0xf149f2ca, v56
    v_xor_b32 v57, 0xf149f2ca, v57
    v_exp_f32 v230, v230
    v_exp_f32 v231, v231
    buffer_load_dwordx4 a[24:27], v31, s[20:23], s69 offen offset:3072 sc1
    v_mfma_f32_32x32x16_bf16 v[64:79], a[144:147], a[48:51], v[64:79]
    v_cvt_pk_bf16_f32 v224, v224, v225
    v_cvt_pk_bf16_f32 v225, v226, v227
    v_cvt_pk_bf16_f32 v226, v228, v229
    v_cvt_pk_bf16_f32 v227, v230, v231
    ds_read_b64_tr_b16 a[142:143], v4 offset:19456
    ds_read_b64_tr_b16 a[144:145], v3 offset:32768
    v_exp_f32 v232, v232
    v_exp_f32 v233, v233
    v_mfma_f32_32x32x16_bf16 v[208:223], v[144:147], v[224:227], v[208:223]
    v_exp_f32 v234, v234
    v_exp_f32 v235, v235
    buffer_load_dwordx4 v7, s[24:27], s49 offen offset:2048 lds
    s_waitcnt vmcnt(17)
    v_mfma_f32_32x32x16_bf16 a[112:127], a[156:159], a[60:63], a[112:127]
    ds_read_b64_tr_b16 a[146:147], v3 offset:33792
    v_exp_f32 v236, v236
    v_exp_f32 v237, v237
    v_exp_f32 v238, v238
    buffer_load_dwordx4 v8, s[24:27], s49 offen offset:3072 lds
    v_mfma_f32_32x32x16_bf16 a[96:111], a[156:159], a[56:59], a[96:111]
    ds_read_b64_tr_b16 a[148:149], v4 offset:32768
    v_exp_f32 v239, v239
    v_cvt_pk_bf16_f32 v232, v232, v233
    v_cvt_pk_bf16_f32 v233, v234, v235
    v_cvt_pk_bf16_f32 v234, v236, v237
    v_cvt_pk_bf16_f32 v235, v238, v239
    v_exp_f32 v240, v240
    v_exp_f32 v241, v241
    v_mfma_f32_32x32x16_bf16 v[208:223], v[148:151], v[232:235], v[208:223]
    v_exp_f32 v242, v242
    v_exp_f32 v243, v243
    s_mov_b32 s78, 0
    s_mov_b32 s79, 0xff0000
    buffer_load_dword v29, v28, s[20:23], s60 offen sc1
    v_exp_f32 v244, v244
    v_exp_f32 v245, v245
    v_mfma_f32_32x32x16_bf16 v[224:239], a[16:19], v[100:103], 0
    v_xor_b32 v58, 0xf149f2ca, v58
    v_xor_b32 v59, 0xf149f2ca, v59
    v_exp_f32 v246, v246
    v_exp_f32 v247, v247
    s_add_u32 m0, s42, 114688
    s_add_u32 s49, s49, 32768
    buffer_load_dwordx4 v9, s[24:27], s49 offen offset:0 lds
    v_mfma_f32_32x32x16_bf16 v[80:95], a[152:155], a[60:63], v[80:95]
    v_cvt_pk_bf16_f32 v240, v240, v241
    v_cvt_pk_bf16_f32 v241, v242, v243
    v_cvt_pk_bf16_f32 v242, v244, v245
    v_cvt_pk_bf16_f32 v243, v246, v247
    v_permlane16_swap_b32 v136, v140
    v_permlane16_swap_b32 v137, v141
    v_permlane16_swap_b32 v138, v142
    v_permlane16_swap_b32 v139, v143
    v_exp_f32 v248, v248
    v_exp_f32 v249, v249
    v_mfma_f32_32x32x16_bf16 v[192:207], v[136:139], v[240:243], v[192:207]
    v_exp_f32 v250, v250
    v_exp_f32 v251, v251
    buffer_load_dwordx4 v10, s[24:27], s49 offen offset:1024 lds
    v_mfma_f32_32x32x16_bf16 v[64:79], a[152:155], a[56:59], v[64:79]
    ds_read_b64_tr_b16 a[150:151], v4 offset:33792
    v_exp_f32 v252, v252
    v_exp_f32 v253, v253
    v_exp_f32 v254, v254
    buffer_load_dwordx4 v7, s[24:27], s49 offen offset:2048 lds
    s_waitcnt vmcnt(20)
    v_mfma_f32_32x32x16_bf16 a[112:127], a[164:167], a[68:71], a[112:127]
    ds_read_b64_tr_b16 a[152:153], v3 offset:34816
    v_exp_f32 v255, v255
    v_cvt_pk_bf16_f32 v248, v248, v249
    v_cvt_pk_bf16_f32 v249, v250, v251
    v_cvt_pk_bf16_f32 v250, v252, v253
    v_cvt_pk_bf16_f32 v251, v254, v255
    v_exp_f32 v224, v224
    v_exp_f32 v225, v225
    v_mfma_f32_32x32x16_bf16 v[192:207], v[140:143], v[248:251], v[192:207]
    v_exp_f32 v226, v226
    v_exp_f32 v227, v227
    buffer_load_dwordx4 v8, s[24:27], s49 offen offset:3072 lds
    v_exp_f32 v228, v228
    v_exp_f32 v229, v229
    v_mfma_f32_32x32x16_bf16 v[240:255], a[12:15], v[96:99], 0
    v_xor_b32 v60, 0xf149f2ca, v60
    v_xor_b32 v61, 0xf149f2ca, v61
    v_exp_f32 v230, v230
    v_exp_f32 v231, v231
    s_add_u32 m0, s42, 131072
    s_bfe_u32 s49, s44, 0x30018
    s_lshl_b32 s49, s49, 16
    s_add_u32 s49, s49, s59
    buffer_load_dwordx4 v9, s[24:27], s49 offen offset:0 lds
    v_mfma_f32_32x32x16_bf16 a[96:111], a[164:167], a[64:67], a[96:111]
    v_cvt_pk_bf16_f32 v224, v224, v225
    v_cvt_pk_bf16_f32 v225, v226, v227
    v_cvt_pk_bf16_f32 v226, v228, v229
    v_cvt_pk_bf16_f32 v227, v230, v231
    ds_read_b64_tr_b16 a[154:155], v3 offset:35840
    ds_read_b64_tr_b16 a[156:157], v4 offset:34816
    v_exp_f32 v232, v232
    v_exp_f32 v233, v233
    v_mfma_f32_32x32x16_bf16 v[208:223], v[136:139], v[224:227], v[208:223]
    v_exp_f32 v234, v234
    v_exp_f32 v235, v235
    buffer_load_dwordx4 v10, s[24:27], s49 offen offset:1024 lds
    v_mfma_f32_32x32x16_bf16 v[80:95], a[160:163], a[68:71], v[80:95]
    ds_read_b64_tr_b16 a[158:159], v4 offset:35840
    v_exp_f32 v236, v236
    v_exp_f32 v237, v237
    v_exp_f32 v238, v238
    buffer_load_dwordx4 v7, s[24:27], s49 offen offset:2048 lds
    v_mfma_f32_32x32x16_bf16 v[64:79], a[160:163], a[64:67], v[64:79]
    s_waitcnt vmcnt(8)
    ds_read_b64_tr_b16 a[160:161], v3 offset:49152
    v_exp_f32 v239, v239
    v_cvt_pk_bf16_f32 v232, v232, v233
    v_cvt_pk_bf16_f32 v233, v234, v235
    v_cvt_pk_bf16_f32 v234, v236, v237
    v_cvt_pk_bf16_f32 v235, v238, v239
    v_exp_f32 v240, v240
    v_exp_f32 v241, v241
    v_mfma_f32_32x32x16_bf16 v[208:223], v[140:143], v[232:235], v[208:223]
    v_exp_f32 v242, v242
    v_exp_f32 v243, v243
    buffer_load_dwordx4 v8, s[24:27], s49 offen offset:3072 lds
    v_exp_f32 v244, v244
    v_exp_f32 v245, v245
    v_mfma_f32_32x32x16_bf16 v[224:239], a[12:15], v[100:103], 0
    v_xor_b32 v62, 0xf149f2ca, v62
    v_xor_b32 v63, 0xf149f2ca, v63
    s_waitcnt vmcnt(8)
    v_cmp_eq_u32 s[76:77], s45, v29
    s_andn2_b64 s[76:77], s[78:79], s[76:77]
    s_cbranch_scc1 parallel_sum__sliding_block__glu_gated_bilinear__prompt_kernel_pq2
parallel_sum__sliding_block__glu_gated_bilinear__prompt_kernel_pq2r:
    v_exp_f32 v246, v246
    v_exp_f32 v247, v247
    s_bfe_u32 s69, s44, 0x3000c
    s_lshl_b32 s69, s69, 12
    s_add_u32 s69, s69, s62
    buffer_load_dwordx4 v[188:191], v30, s[20:23], s69 offen offset:0 sc1
    v_mfma_f32_32x32x16_bf16 a[112:127], a[172:175], a[76:79], a[112:127]
    v_cvt_pk_bf16_f32 v240, v240, v241
    v_cvt_pk_bf16_f32 v241, v242, v243
    v_cvt_pk_bf16_f32 v242, v244, v245
    v_cvt_pk_bf16_f32 v243, v246, v247
    v_permlane16_swap_b32 v128, v132
    v_permlane16_swap_b32 v129, v133
    v_permlane16_swap_b32 v130, v134
    v_permlane16_swap_b32 v131, v135
    v_exp_f32 v248, v248
    v_exp_f32 v249, v249
    v_mfma_f32_32x32x16_bf16 v[192:207], v[128:131], v[240:243], v[192:207]
    v_exp_f32 v250, v250
    v_exp_f32 v251, v251
    buffer_load_dwordx4 v[184:187], v31, s[20:23], s69 offen offset:0 sc1
    v_mfma_f32_32x32x16_bf16 a[96:111], a[172:175], a[72:75], a[96:111]
    ds_read_b64_tr_b16 a[162:163], v3 offset:50176
    v_exp_f32 v252, v252
    v_exp_f32 v253, v253
    v_exp_f32 v254, v254
    buffer_load_dwordx4 a[44:47], v30, s[20:23], s69 offen offset:1024 sc1
    v_mfma_f32_32x32x16_bf16 v[80:95], a[168:171], a[76:79], v[80:95]
    ds_read_b64_tr_b16 a[164:165], v4 offset:49152
    v_exp_f32 v255, v255
    v_cvt_pk_bf16_f32 v248, v248, v249
    v_cvt_pk_bf16_f32 v249, v250, v251
    v_cvt_pk_bf16_f32 v250, v252, v253
    v_cvt_pk_bf16_f32 v251, v254, v255
    v_exp_f32 v224, v224
    v_exp_f32 v225, v225
    v_mfma_f32_32x32x16_bf16 v[192:207], v[132:135], v[248:251], v[192:207]
    v_exp_f32 v226, v226
    v_exp_f32 v227, v227
    v_and_b32 v23, 0x1f0, v2
    buffer_load_dword v24, v23, s[20:23], s66 offen offset:8 sc1
    v_exp_f32 v228, v228
    v_exp_f32 v229, v229
    v_mfma_f32_32x32x16_bf16 v[240:255], a[8:11], v[96:99], 0
    v_exp_f32 v230, v230
    v_exp_f32 v231, v231
    buffer_load_dword v25, v23, s[20:23], s66 offen offset:520 sc1
    v_mfma_f32_32x32x16_bf16 v[64:79], a[168:171], a[72:75], v[64:79]
    v_cvt_pk_bf16_f32 v224, v224, v225
    v_cvt_pk_bf16_f32 v225, v226, v227
    v_cvt_pk_bf16_f32 v226, v228, v229
    v_cvt_pk_bf16_f32 v227, v230, v231
    ds_read_b64_tr_b16 a[166:167], v4 offset:50176
    ds_read_b64_tr_b16 a[168:169], v3 offset:51200
    v_exp_f32 v232, v232
    v_exp_f32 v233, v233
    v_mfma_f32_32x32x16_bf16 v[208:223], v[128:131], v[224:227], v[208:223]
    v_exp_f32 v234, v234
    v_exp_f32 v235, v235
    buffer_load_dwordx4 a[40:43], v31, s[20:23], s69 offen offset:1024 sc1
    v_mfma_f32_32x32x16_bf16 a[112:127], a[180:183], a[84:87], a[112:127]
    ds_read_b64_tr_b16 a[170:171], v3 offset:52224
    v_exp_f32 v236, v236
    v_exp_f32 v237, v237
    v_exp_f32 v238, v238
    buffer_load_dwordx4 a[20:23], v30, s[20:23], s69 offen offset:2048 sc1
    v_mfma_f32_32x32x16_bf16 a[96:111], a[180:183], a[80:83], a[96:111]
    ds_read_b64_tr_b16 a[172:173], v4 offset:51200
    v_exp_f32 v239, v239
    v_cvt_pk_bf16_f32 v232, v232, v233
    v_cvt_pk_bf16_f32 v233, v234, v235
    v_cvt_pk_bf16_f32 v234, v236, v237
    v_cvt_pk_bf16_f32 v235, v238, v239
    v_exp_f32 v240, v240
    v_exp_f32 v241, v241
    v_mfma_f32_32x32x16_bf16 v[208:223], v[132:135], v[232:235], v[208:223]
    v_exp_f32 v242, v242
    v_exp_f32 v243, v243
    buffer_load_dwordx4 a[52:55], v31, s[20:23], s69 offen offset:2048 sc1
    v_exp_f32 v244, v244
    v_exp_f32 v245, v245
    v_mfma_f32_32x32x16_bf16 v[224:239], a[8:11], v[100:103], 0
    v_exp_f32 v246, v246
    v_exp_f32 v247, v247
    buffer_load_dwordx4 a[48:51], v30, s[20:23], s69 offen offset:3072 sc1
    v_mfma_f32_32x32x16_bf16 v[80:95], a[176:179], a[84:87], v[80:95]
    v_cvt_pk_bf16_f32 v240, v240, v241
    v_cvt_pk_bf16_f32 v241, v242, v243
    v_cvt_pk_bf16_f32 v242, v244, v245
    v_cvt_pk_bf16_f32 v243, v246, v247
    v_permlane16_swap_b32 v120, v124
    v_permlane16_swap_b32 v121, v125
    v_permlane16_swap_b32 v122, v126
    v_permlane16_swap_b32 v123, v127
    v_exp_f32 v248, v248
    v_exp_f32 v249, v249
    v_mfma_f32_32x32x16_bf16 v[192:207], v[120:123], v[240:243], v[192:207]
    v_exp_f32 v250, v250
    v_exp_f32 v251, v251
    buffer_load_dwordx4 a[16:19], v31, s[20:23], s69 offen offset:3072 sc1
    v_mfma_f32_32x32x16_bf16 v[64:79], a[176:179], a[80:83], v[64:79]
    ds_read_b64_tr_b16 a[174:175], v4 offset:52224
    v_exp_f32 v252, v252
    v_exp_f32 v253, v253
    v_exp_f32 v254, v254
    s_bfe_u32 s69, s44, 0x30010
    s_lshl_b32 s69, s69, 12
    s_add_u32 s69, s69, s62
    buffer_load_dwordx4 a[60:63], v30, s[20:23], s69 offen offset:0 sc1
    v_mfma_f32_32x32x16_bf16 a[112:127], a[188:191], a[92:95], a[112:127]
    s_waitcnt vmcnt(15)
    ds_read_b64_tr_b16 a[176:177], v19 offset:0
    v_exp_f32 v255, v255
    v_cvt_pk_bf16_f32 v248, v248, v249
    v_cvt_pk_bf16_f32 v249, v250, v251
    v_cvt_pk_bf16_f32 v250, v252, v253
    v_cvt_pk_bf16_f32 v251, v254, v255
    v_exp_f32 v224, v224
    v_exp_f32 v225, v225
    v_mfma_f32_32x32x16_bf16 v[192:207], v[124:127], v[248:251], v[192:207]
    v_exp_f32 v226, v226
    v_exp_f32 v227, v227
    buffer_load_dwordx4 a[56:59], v31, s[20:23], s69 offen offset:0 sc1
    v_exp_f32 v228, v228
    v_exp_f32 v229, v229
    v_mfma_f32_32x32x16_bf16 v[240:255], a[4:7], v[96:99], 0
    v_exp_f32 v230, v230
    v_exp_f32 v231, v231
    buffer_load_dwordx4 a[68:71], v30, s[20:23], s69 offen offset:1024 sc1
    v_mfma_f32_32x32x16_bf16 a[96:111], a[188:191], a[88:91], a[96:111]
    v_cvt_pk_bf16_f32 v224, v224, v225
    v_cvt_pk_bf16_f32 v225, v226, v227
    v_cvt_pk_bf16_f32 v226, v228, v229
    v_cvt_pk_bf16_f32 v227, v230, v231
    ds_read_b64_tr_b16 a[178:179], v19 offset:1024
    ds_read_b64_tr_b16 a[180:181], v20 offset:0
    v_exp_f32 v232, v232
    v_exp_f32 v233, v233
    v_mfma_f32_32x32x16_bf16 v[208:223], v[120:123], v[224:227], v[208:223]
    v_exp_f32 v234, v234
    v_exp_f32 v235, v235
    buffer_load_dwordx4 a[64:67], v31, s[20:23], s69 offen offset:1024 sc1
    v_mfma_f32_32x32x16_bf16 v[80:95], a[184:187], a[92:95], v[80:95]
    ds_read_b64_tr_b16 a[182:183], v20 offset:1024
    v_exp_f32 v236, v236
    v_exp_f32 v237, v237
    v_exp_f32 v238, v238
    buffer_load_dwordx4 a[12:15], v30, s[20:23], s69 offen offset:2048 sc1
    v_mfma_f32_32x32x16_bf16 v[64:79], a[184:187], a[88:91], v[64:79]
    ds_read_b64_tr_b16 a[184:185], v19 offset:2048
    v_exp_f32 v239, v239
    v_cvt_pk_bf16_f32 v232, v232, v233
    v_cvt_pk_bf16_f32 v233, v234, v235
    v_cvt_pk_bf16_f32 v234, v236, v237
    v_cvt_pk_bf16_f32 v235, v238, v239
    v_exp_f32 v240, v240
    v_exp_f32 v241, v241
    v_mfma_f32_32x32x16_bf16 v[208:223], v[124:127], v[232:235], v[208:223]
    v_exp_f32 v242, v242
    v_exp_f32 v243, v243
    buffer_load_dwordx4 a[76:79], v31, s[20:23], s69 offen offset:2048 sc1
    v_exp_f32 v244, v244
    v_exp_f32 v245, v245
    v_mfma_f32_32x32x16_bf16 v[224:239], a[4:7], v[100:103], v[48:63]
    v_exp_f32 v246, v246
    v_exp_f32 v247, v247
    buffer_load_dwordx4 a[72:75], v30, s[20:23], s69 offen offset:3072 sc1
    v_mfma_f32_32x32x16_bf16 a[112:127], a[196:199], v[36:39], a[112:127]
    v_cvt_pk_bf16_f32 v240, v240, v241
    v_cvt_pk_bf16_f32 v241, v242, v243
    v_cvt_pk_bf16_f32 v242, v244, v245
    v_cvt_pk_bf16_f32 v243, v246, v247
    v_permlane16_swap_b32 v112, v116
    v_permlane16_swap_b32 v113, v117
    v_permlane16_swap_b32 v114, v118
    v_permlane16_swap_b32 v115, v119
    v_exp_f32 v248, v248
    v_exp_f32 v249, v249
    v_mfma_f32_32x32x16_bf16 v[192:207], v[112:115], v[240:243], v[192:207]
    v_exp_f32 v250, v250
    v_exp_f32 v251, v251
    buffer_load_dwordx4 a[8:11], v31, s[20:23], s69 offen offset:3072 sc1
    v_mfma_f32_32x32x16_bf16 a[96:111], a[196:199], v[32:35], a[96:111]
    ds_read_b64_tr_b16 a[186:187], v19 offset:3072
    v_exp_f32 v252, v252
    v_exp_f32 v253, v253
    v_exp_f32 v254, v254
    s_add_u32 m0, s42, 147456
    s_add_u32 s49, s49, 32768
    buffer_load_dwordx4 v9, s[24:27], s49 offen offset:0 lds
    v_mfma_f32_32x32x16_bf16 v[80:95], a[192:195], v[36:39], v[80:95]
    ds_read_b64_tr_b16 a[188:189], v20 offset:2048
    v_exp_f32 v255, v255
    v_cvt_pk_bf16_f32 v248, v248, v249
    v_cvt_pk_bf16_f32 v249, v250, v251
    v_cvt_pk_bf16_f32 v250, v252, v253
    v_cvt_pk_bf16_f32 v251, v254, v255
    v_exp_f32 v224, v224
    v_exp_f32 v225, v225
    v_mfma_f32_32x32x16_bf16 v[192:207], v[116:119], v[248:251], v[192:207]
    v_exp_f32 v226, v226
    v_exp_f32 v227, v227
    buffer_load_dwordx4 v10, s[24:27], s49 offen offset:1024 lds
    v_exp_f32 v228, v228
    v_exp_f32 v229, v229
    v_mfma_f32_32x32x16_bf16 v[240:255], a[0:3], v[96:99], v[48:63]
    v_exp_f32 v230, v230
    v_exp_f32 v231, v231
    buffer_load_dwordx4 v7, s[24:27], s49 offen offset:2048 lds
    v_mfma_f32_32x32x16_bf16 v[64:79], a[192:195], v[32:35], v[64:79]
    v_cvt_pk_bf16_f32 v224, v224, v225
    v_cvt_pk_bf16_f32 v225, v226, v227
    v_cvt_pk_bf16_f32 v226, v228, v229
    v_cvt_pk_bf16_f32 v227, v230, v231
    ds_read_b64_tr_b16 a[190:191], v20 offset:3072
    s_waitcnt vmcnt(21)
    ds_read_b64_tr_b16 a[192:193], v19 offset:16384
    v_exp_f32 v232, v232
    v_exp_f32 v233, v233
    v_mfma_f32_32x32x16_bf16 v[208:223], v[112:115], v[224:227], v[208:223]
    v_exp_f32 v234, v234
    v_exp_f32 v235, v235
    buffer_load_dwordx4 v8, s[24:27], s49 offen offset:3072 lds
    v_mfma_f32_32x32x16_bf16 a[112:127], a[204:207], v[44:47], a[112:127]
    ds_read_b64_tr_b16 a[194:195], v19 offset:17408
    v_exp_f32 v236, v236
    v_exp_f32 v237, v237
    v_exp_f32 v238, v238
    s_bfe_u32 s69, s44, 0x30014
    s_lshl_b32 s69, s69, 12
    s_add_u32 s69, s69, s62
    buffer_load_dwordx4 a[84:87], v30, s[20:23], s69 offen offset:0 sc1
    v_mfma_f32_32x32x16_bf16 a[96:111], a[204:207], v[40:43], a[96:111]
    ds_read_b64_tr_b16 a[196:197], v20 offset:16384
    v_exp_f32 v239, v239
    v_cvt_pk_bf16_f32 v232, v232, v233
    v_cvt_pk_bf16_f32 v233, v234, v235
    v_cvt_pk_bf16_f32 v234, v236, v237
    v_cvt_pk_bf16_f32 v235, v238, v239
    v_exp_f32 v240, v240
    v_exp_f32 v241, v241
    v_mfma_f32_32x32x16_bf16 v[208:223], v[116:119], v[232:235], v[208:223]
    v_exp_f32 v242, v242
    v_exp_f32 v243, v243
    buffer_load_dwordx4 a[80:83], v31, s[20:23], s69 offen offset:0 sc1
    v_exp_f32 v244, v244
    v_exp_f32 v245, v245
    v_exp_f32 v246, v246
    v_exp_f32 v247, v247
    buffer_load_dwordx4 a[92:95], v30, s[20:23], s69 offen offset:1024 sc1
    v_mfma_f32_32x32x16_bf16 v[80:95], a[200:203], v[44:47], v[80:95]
    v_cvt_pk_bf16_f32 v240, v240, v241
    v_cvt_pk_bf16_f32 v241, v242, v243
    v_cvt_pk_bf16_f32 v242, v244, v245
    v_cvt_pk_bf16_f32 v243, v246, v247
    v_permlane16_swap_b32 v104, v108
    v_permlane16_swap_b32 v105, v109
    v_permlane16_swap_b32 v106, v110
    v_permlane16_swap_b32 v107, v111
    v_exp_f32 v248, v248
    v_exp_f32 v249, v249
    v_mfma_f32_32x32x16_bf16 v[192:207], v[104:107], v[240:243], v[192:207]
    v_exp_f32 v250, v250
    v_exp_f32 v251, v251
    buffer_load_dwordx4 a[88:91], v31, s[20:23], s69 offen offset:1024 sc1
    v_mfma_f32_32x32x16_bf16 v[64:79], a[200:203], v[40:43], v[64:79]
    ds_read_b64_tr_b16 a[198:199], v20 offset:17408
    v_exp_f32 v252, v252
    v_exp_f32 v253, v253
    v_exp_f32 v254, v254
    s_add_u32 m0, s42, 0
    s_lshl_b32 s49, s40, 17
    s_waitcnt lgkmcnt(15)
    buffer_load_dwordx4 v9, s[28:31], s49 offen offset:0 lds
    v_mfma_f32_32x32x16_bf16 a[112:127], a[212:215], a[36:39], a[112:127]
    ds_read_b64_tr_b16 a[200:201], v19 offset:18432
    v_exp_f32 v255, v255
    v_cvt_pk_bf16_f32 v248, v248, v249
    v_cvt_pk_bf16_f32 v249, v250, v251
    v_cvt_pk_bf16_f32 v250, v252, v253
    v_cvt_pk_bf16_f32 v251, v254, v255
    s_nop 1
    v_mfma_f32_32x32x16_bf16 v[192:207], v[108:111], v[248:251], v[192:207]
    v_mfma_f32_32x32x16_bf16 a[96:111], a[212:215], a[32:35], a[96:111]
    buffer_load_dwordx4 v10, s[28:31], s49 offen offset:1024 lds
    ds_read_b64_tr_b16 a[202:203], v19 offset:19456
    ds_read_b64_tr_b16 a[204:205], v20 offset:18432
    v_mfma_f32_32x32x16_bf16 v[80:95], a[208:211], a[36:39], v[80:95]
    buffer_load_dwordx4 v7, s[28:31], s49 offen offset:2048 lds
    ds_read_b64_tr_b16 a[206:207], v20 offset:19456
    v_mfma_f32_32x32x16_bf16 v[64:79], a[208:211], a[32:35], v[64:79]
parallel_sum__sliding_block__glu_gated_bilinear__prompt_kernel_oc:
    v_subrev_u32 v217, 562036736, v216
    s_nop 2
    v_subrev_u32 v201, 562036736, v200
    v_max_u32 v23, v201, v217
    v_cmp_lt_u32 vcc, s67, v23
    s_cbranch_vccnz parallel_sum__sliding_block__glu_gated_bilinear__prompt_kernel_fb
    v_mfma_f32_32x32x16_bf16 a[112:127], a[220:223], a[24:27], a[112:127]
    v_rcp_f32 v22, v216
    s_waitcnt vmcnt(24)
    v_mul_f32 v22, v22, v25
    v_mul_f32 v208, v208, v22
    v_mul_f32 v209, v209, v22
    v_mul_f32 v210, v210, v22
    v_mul_f32 v211, v211, v22
    v_mul_f32 v212, v212, v22
    v_mul_f32 v213, v213, v22
    v_mfma_f32_32x32x16_bf16 a[96:111], a[220:223], a[28:31], a[96:111]
    v_mul_f32 v214, v214, v22
    v_mul_f32 v215, v215, v22
    v_cvt_pk_bf16_f32 v208, v208, v209
    v_cvt_pk_bf16_f32 v209, v210, v211
    v_cvt_pk_bf16_f32 v210, v212, v213
    v_cvt_pk_bf16_f32 v211, v214, v215
    s_add_u32 s70, s64, 147456
    buffer_store_dwordx4 v[208:211], v2, s[20:23], s70 offen sc1
    v_rcp_f32 v22, v200
    v_mfma_f32_32x32x16_bf16 v[80:95], a[216:219], a[24:27], v[80:95]
    v_mul_f32 v22, v22, v24
    v_mul_f32 v192, v192, v22
    v_mul_f32 v193, v193, v22
    v_mul_f32 v194, v194, v22
    v_mul_f32 v195, v195, v22
    v_mul_f32 v196, v196, v22
    v_mul_f32 v197, v197, v22
    v_mul_f32 v198, v198, v22
    v_mfma_f32_32x32x16_bf16 v[64:79], a[216:219], a[28:31], v[64:79]
    v_mul_f32 v199, v199, v22
    v_cvt_pk_bf16_f32 v192, v192, v193
    v_cvt_pk_bf16_f32 v193, v194, v195
    v_cvt_pk_bf16_f32 v194, v196, v197
    v_cvt_pk_bf16_f32 v195, v198, v199
    buffer_store_dwordx4 v[192:195], v2, s[20:23], s64 offen sc1
    v_mfma_f32_32x32x16_bf16 a[112:127], a[228:231], v[184:187], a[112:127]
    buffer_load_dwordx4 v8, s[28:31], s49 offen offset:3072 lds
    s_waitcnt vmcnt(10)
    ds_read_b64_tr_b16 a[208:209], v19 offset:32768
    ds_read_b64_tr_b16 a[210:211], v19 offset:33792
    v_mfma_f32_32x32x16_bf16 a[96:111], a[228:231], v[188:191], a[96:111]
    buffer_load_dwordx4 a[4:7], v30, s[20:23], s69 offen offset:2048 sc1
    ds_read_b64_tr_b16 a[212:213], v20 offset:32768
    ds_read_b64_tr_b16 a[214:215], v20 offset:33792
    v_mfma_f32_32x32x16_bf16 v[80:95], a[224:227], v[184:187], v[80:95]
    buffer_load_dwordx4 v[36:39], v31, s[20:23], s69 offen offset:2048 sc1
    ds_read_b64_tr_b16 a[216:217], v19 offset:34816
    ds_read_b64_tr_b16 a[218:219], v19 offset:35840
    v_mfma_f32_32x32x16_bf16 v[64:79], a[224:227], v[188:191], v[64:79]
    buffer_load_dwordx4 v[32:35], v30, s[20:23], s69 offen offset:3072 sc1
    ds_read_b64_tr_b16 a[220:221], v20 offset:34816
    ds_read_b64_tr_b16 a[222:223], v20 offset:35840
    v_mfma_f32_32x32x16_bf16 a[112:127], a[236:239], a[40:43], a[112:127]
    buffer_load_dwordx4 v[44:47], v31, s[20:23], s69 offen offset:3072 sc1
    v_mfma_f32_32x32x16_bf16 a[96:111], a[236:239], a[44:47], a[96:111]
    s_add_u32 m0, s42, 16384
    s_add_u32 s49, s49, 32768
    buffer_load_dwordx4 v9, s[28:31], s49 offen offset:0 lds
    v_mfma_f32_32x32x16_bf16 v[80:95], a[232:235], a[40:43], v[80:95]
    buffer_load_dwordx4 v10, s[28:31], s49 offen offset:1024 lds
    v_mfma_f32_32x32x16_bf16 v[64:79], a[232:235], a[44:47], v[64:79]
    s_branch parallel_sum__sliding_block__glu_gated_bilinear__prompt_kernel_ws8
parallel_sum__sliding_block__glu_gated_bilinear__prompt_kernel_w3G1_0:
    s_branch parallel_sum__sliding_block__glu_gated_bilinear__prompt_kernel_wr3G
parallel_sum__sliding_block__glu_gated_bilinear__prompt_kernel_w3O1_0:
    s_branch parallel_sum__sliding_block__glu_gated_bilinear__prompt_kernel_wr3O
parallel_sum__sliding_block__glu_gated_bilinear__prompt_kernel_ws8:
    buffer_load_dwordx4 v7, s[28:31], s49 offen offset:2048 lds
    v_mfma_f32_32x32x16_bf16 a[112:127], a[244:247], a[52:55], a[112:127]
    buffer_load_dwordx4 v8, s[28:31], s49 offen offset:3072 lds
    s_waitcnt vmcnt(8)
    ds_read_b64_tr_b16 a[224:225], v3 offset:0
    ds_read_b64_tr_b16 a[226:227], v3 offset:1024
    v_mfma_f32_32x32x16_bf16 a[96:111], a[244:247], a[20:23], a[96:111]
    s_bfe_u32 s69, s44, 0x30018
    s_lshl_b32 s69, s69, 12
    s_add_u32 s69, s69, s62
    buffer_load_dwordx4 v[40:43], v30, s[20:23], s69 offen offset:0 sc1
    ds_read_b64_tr_b16 a[228:229], v4 offset:0
    ds_read_b64_tr_b16 a[230:231], v4 offset:1024
    v_mfma_f32_32x32x16_bf16 v[80:95], a[240:243], a[52:55], v[80:95]
    buffer_load_dwordx4 a[0:3], v31, s[20:23], s69 offen offset:0 sc1
    ds_read_b64_tr_b16 a[232:233], v3 offset:2048
    ds_read_b64_tr_b16 a[234:235], v3 offset:3072
    v_mfma_f32_32x32x16_bf16 v[64:79], a[240:243], a[20:23], v[64:79]
    buffer_load_dwordx4 v[112:115], v30, s[20:23], s69 offen offset:1024 sc1
    ds_read_b64_tr_b16 a[236:237], v4 offset:2048
    ds_read_b64_tr_b16 a[238:239], v4 offset:3072
    v_mfma_f32_32x32x16_bf16 a[112:127], a[252:255], a[16:19], a[112:127]
    buffer_load_dwordx4 v[116:119], v31, s[20:23], s69 offen offset:1024 sc1
    v_mfma_f32_32x32x16_bf16 a[96:111], a[252:255], a[48:51], a[96:111]
    s_add_u32 m0, s42, 32768
    s_add_u32 s49, s49, 32768
    buffer_load_dwordx4 v9, s[28:31], s49 offen offset:0 lds
    v_mfma_f32_32x32x16_bf16 v[80:95], a[248:251], a[16:19], v[80:95]
    buffer_load_dwordx4 v10, s[28:31], s49 offen offset:1024 lds
    v_mfma_f32_32x32x16_bf16 v[64:79], a[248:251], a[48:51], v[64:79]
    buffer_load_dwordx4 v7, s[28:31], s49 offen offset:2048 lds
    v_mfma_f32_32x32x16_bf16 a[112:127], a[132:135], a[56:59], a[112:127]
    buffer_load_dwordx4 v8, s[28:31], s49 offen offset:3072 lds
    s_waitcnt vmcnt(8)
    ds_read_b64_tr_b16 a[240:241], v3 offset:16384
    ds_read_b64_tr_b16 a[242:243], v3 offset:17408
    v_mfma_f32_32x32x16_bf16 a[96:111], a[132:135], a[60:63], a[96:111]
    buffer_load_dwordx4 a[36:39], v30, s[20:23], s69 offen offset:2048 sc1
    ds_read_b64_tr_b16 a[244:245], v4 offset:16384
    ds_read_b64_tr_b16 a[246:247], v4 offset:17408
    v_mfma_f32_32x32x16_bf16 v[80:95], a[128:131], a[56:59], v[80:95]
    buffer_load_dwordx4 a[32:35], v31, s[20:23], s69 offen offset:2048 sc1
    ds_read_b64_tr_b16 a[248:249], v3 offset:18432
    ds_read_b64_tr_b16 a[250:251], v3 offset:19456
    v_mfma_f32_32x32x16_bf16 v[64:79], a[128:131], a[60:63], v[64:79]
    buffer_load_dwordx4 a[24:27], v30, s[20:23], s69 offen offset:3072 sc1
    ds_read_b64_tr_b16 a[252:253], v4 offset:18432
    ds_read_b64_tr_b16 a[254:255], v4 offset:19456
    v_mfma_f32_32x32x16_bf16 a[112:127], a[140:143], a[64:67], a[112:127]
    buffer_load_dwordx4 a[28:31], v31, s[20:23], s69 offen offset:3072 sc1
    v_mfma_f32_32x32x16_bf16 a[96:111], a[140:143], a[68:71], a[96:111]
    s_add_u32 m0, s42, 49152
    s_add_u32 s49, s49, 32768
    s_waitcnt lgkmcnt(15)
    buffer_load_dwordx4 v9, s[28:31], s49 offen offset:0 lds
    v_mfma_f32_32x32x16_bf16 v[80:95], a[136:139], a[64:67], v[80:95]
    buffer_load_dwordx4 v10, s[28:31], s49 offen offset:1024 lds
    v_mfma_f32_32x32x16_bf16 v[64:79], a[136:139], a[68:71], v[64:79]
    buffer_load_dwordx4 v7, s[28:31], s49 offen offset:2048 lds
    v_mfma_f32_32x32x16_bf16 a[112:127], a[148:151], a[76:79], a[112:127]
    buffer_load_dwordx4 v8, s[28:31], s49 offen offset:3072 lds
    s_waitcnt vmcnt(8)
    ds_read_b64_tr_b16 a[128:129], v3 offset:32768
    ds_read_b64_tr_b16 a[130:131], v3 offset:33792
    v_mfma_f32_32x32x16_bf16 a[96:111], a[148:151], a[12:15], a[96:111]
    ds_read_b64_tr_b16 a[132:133], v4 offset:32768
    ds_read_b64_tr_b16 a[134:135], v4 offset:33792
    v_mfma_f32_32x32x16_bf16 v[80:95], a[144:147], a[76:79], v[80:95]
    ds_read_b64_tr_b16 a[136:137], v3 offset:34816
    ds_read_b64_tr_b16 a[138:139], v3 offset:35840
    v_mfma_f32_32x32x16_bf16 v[64:79], a[144:147], a[12:15], v[64:79]
    ds_read_b64_tr_b16 a[140:141], v4 offset:34816
    ds_read_b64_tr_b16 a[142:143], v4 offset:35840
    v_mfma_f32_32x32x16_bf16 a[112:127], a[156:159], a[8:11], a[112:127]
    v_mfma_f32_32x32x16_bf16 a[96:111], a[156:159], a[72:75], a[96:111]
    v_mfma_f32_32x32x16_bf16 v[80:95], a[152:155], a[8:11], v[80:95]
    v_mfma_f32_32x32x16_bf16 v[64:79], a[152:155], a[72:75], v[64:79]
    v_mfma_f32_32x32x16_bf16 a[112:127], a[164:167], a[80:83], a[112:127]
    s_waitcnt vmcnt(0)
    ds_read_b64_tr_b16 a[144:145], v3 offset:49152
    ds_read_b64_tr_b16 a[146:147], v3 offset:50176
    v_mfma_f32_32x32x16_bf16 a[96:111], a[164:167], a[84:87], a[96:111]
    ds_read_b64_tr_b16 a[148:149], v4 offset:49152
    ds_read_b64_tr_b16 a[150:151], v4 offset:50176
    v_mfma_f32_32x32x16_bf16 v[80:95], a[160:163], a[80:83], v[80:95]
    ds_read_b64_tr_b16 a[152:153], v3 offset:51200
    ds_read_b64_tr_b16 a[154:155], v3 offset:52224
    v_mfma_f32_32x32x16_bf16 v[64:79], a[160:163], a[84:87], v[64:79]
    ds_read_b64_tr_b16 a[156:157], v4 offset:51200
    ds_read_b64_tr_b16 a[158:159], v4 offset:52224
    v_mfma_f32_32x32x16_bf16 a[112:127], a[172:175], a[88:91], a[112:127]
    s_add_u32 s3, s63, 0
    buffer_load_dwordx4 v[124:127], v31, s[20:23], s3 offen offset:0 sc1
    v_mfma_f32_32x32x16_bf16 a[96:111], a[172:175], a[92:95], a[96:111]
    v_mfma_f32_32x32x16_bf16 v[80:95], a[168:171], a[88:91], v[80:95]
    buffer_load_dwordx4 v[132:135], v31, s[20:23], s3 offen offset:1024 sc1
    v_mfma_f32_32x32x16_bf16 v[64:79], a[168:171], a[92:95], v[64:79]
    v_mfma_f32_32x32x16_bf16 a[112:127], a[180:183], v[36:39], a[112:127]
    buffer_load_dwordx4 v[140:143], v31, s[20:23], s3 offen offset:2048 sc1
    v_mfma_f32_32x32x16_bf16 a[96:111], a[180:183], a[4:7], a[96:111]
    v_mfma_f32_32x32x16_bf16 v[80:95], a[176:179], v[36:39], v[80:95]
    buffer_load_dwordx4 v[148:151], v31, s[20:23], s3 offen offset:3072 sc1
    v_mfma_f32_32x32x16_bf16 v[64:79], a[176:179], a[4:7], v[64:79]
    v_mfma_f32_32x32x16_bf16 a[112:127], a[188:191], v[44:47], a[112:127]
    s_add_u32 s3, s63, 4096
    buffer_load_dwordx4 v[156:159], v31, s[20:23], s3 offen offset:0 sc1
    v_mfma_f32_32x32x16_bf16 a[96:111], a[188:191], v[32:35], a[96:111]
    v_mfma_f32_32x32x16_bf16 v[80:95], a[184:187], v[44:47], v[80:95]
    buffer_load_dwordx4 v[164:167], v31, s[20:23], s3 offen offset:1024 sc1
    v_mfma_f32_32x32x16_bf16 v[64:79], a[184:187], v[32:35], v[64:79]
    v_mfma_f32_32x32x16_bf16 a[112:127], a[196:199], a[0:3], a[112:127]
    buffer_load_dwordx4 v[172:175], v31, s[20:23], s3 offen offset:2048 sc1
    v_mfma_f32_32x32x16_bf16 a[96:111], a[196:199], v[40:43], a[96:111]
    v_mfma_f32_32x32x16_bf16 v[80:95], a[192:195], a[0:3], v[80:95]
    buffer_load_dwordx4 v[180:183], v31, s[20:23], s3 offen offset:3072 sc1
    v_mfma_f32_32x32x16_bf16 v[64:79], a[192:195], v[40:43], v[64:79]
    v_mfma_f32_32x32x16_bf16 a[112:127], a[204:207], v[116:119], a[112:127]
    s_add_u32 s3, s63, 0
    buffer_load_dwordx4 v[120:123], v30, s[20:23], s3 offen offset:0 sc1
    v_mfma_f32_32x32x16_bf16 a[96:111], a[204:207], v[112:115], a[96:111]
    v_mfma_f32_32x32x16_bf16 v[80:95], a[200:203], v[116:119], v[80:95]
    buffer_load_dwordx4 v[128:131], v30, s[20:23], s3 offen offset:1024 sc1
    v_mfma_f32_32x32x16_bf16 v[64:79], a[200:203], v[112:115], v[64:79]
    v_mfma_f32_32x32x16_bf16 a[112:127], a[212:215], a[32:35], a[112:127]
    buffer_load_dwordx4 v[136:139], v30, s[20:23], s3 offen offset:2048 sc1
    s_add_u32 s70, s42, 114688
    v_add_u32 v28, s70, v2
    v_mfma_f32_32x32x16_bf16 a[96:111], a[212:215], a[36:39], a[96:111]
    v_xor_b32 v26, 4096, v28
    v_mfma_f32_32x32x16_bf16 v[80:95], a[208:211], a[32:35], v[80:95]
    buffer_load_dwordx4 v[144:147], v30, s[20:23], s3 offen offset:3072 sc1
    v_xor_b32 v27, 8192, v28
    v_mfma_f32_32x32x16_bf16 v[64:79], a[208:211], a[36:39], v[64:79]
    v_xor_b32 v29, 12288, v28
    v_mfma_f32_32x32x16_bf16 a[112:127], a[220:223], a[28:31], a[112:127]
    s_add_u32 s3, s63, 4096
    buffer_load_dwordx4 v[152:155], v30, s[20:23], s3 offen offset:0 sc1
    v_mfma_f32_32x32x16_bf16 a[96:111], a[220:223], a[24:27], a[96:111]
    v_mfma_f32_32x32x16_bf16 v[80:95], a[216:219], a[28:31], v[80:95]
    buffer_load_dwordx4 v[160:163], v30, s[20:23], s3 offen offset:1024 sc1
    s_waitcnt vmcnt(12)
    v_max3_u32 v22, v124, v125, v126
    v_max3_u32 v22, v22, v127, v132
    v_max3_u32 v22, v22, v133, v134
    v_mfma_f32_32x32x16_bf16 v[64:79], a[216:219], a[24:27], v[64:79]
    v_max_u32 v22, v22, v135
    v_cmp_eq_u32 vcc, -1, v22
    s_cbranch_vccnz parallel_sum__sliding_block__glu_gated_bilinear__prompt_kernel_ro0
parallel_sum__sliding_block__glu_gated_bilinear__prompt_kernel_ror0:
    s_waitcnt lgkmcnt(15)
    v_mfma_f32_32x32x16_bf16 a[112:127], a[228:231], v[124:127], a[112:127]
    buffer_load_dwordx4 v[168:171], v30, s[20:23], s3 offen offset:2048 sc1
    s_waitcnt vmcnt(11)
    v_max3_u32 v22, v140, v141, v142
    v_max3_u32 v22, v22, v143, v148
    v_max3_u32 v22, v22, v149, v150
    v_mfma_f32_32x32x16_bf16 a[112:127], a[236:239], v[132:135], a[112:127]
    v_max_u32 v22, v22, v151
    v_cmp_eq_u32 vcc, -1, v22
    s_cbranch_vccnz parallel_sum__sliding_block__glu_gated_bilinear__prompt_kernel_ro1
parallel_sum__sliding_block__glu_gated_bilinear__prompt_kernel_ror1:
    v_mfma_f32_32x32x16_bf16 a[112:127], a[244:247], v[140:143], a[112:127]
    buffer_load_dwordx4 v[176:179], v30, s[20:23], s3 offen offset:3072 sc1
    s_waitcnt vmcnt(10)
    v_max3_u32 v22, v156, v157, v158
    v_max3_u32 v22, v22, v159, v164
    v_max3_u32 v22, v22, v165, v166
    v_mfma_f32_32x32x16_bf16 a[112:127], a[252:255], v[148:151], a[112:127]
    v_max_u32 v22, v22, v167
    v_cmp_eq_u32 vcc, -1, v22
    s_cbranch_vccnz parallel_sum__sliding_block__glu_gated_bilinear__prompt_kernel_ro2
parallel_sum__sliding_block__glu_gated_bilinear__prompt_kernel_ror2:
    s_waitcnt lgkmcnt(12)
    v_mfma_f32_32x32x16_bf16 a[112:127], a[132:135], v[156:159], a[112:127]
    s_waitcnt vmcnt(8)
    v_max3_u32 v22, v172, v173, v174
    v_max3_u32 v22, v22, v175, v180
    v_max3_u32 v22, v22, v181, v182
    s_waitcnt lgkmcnt(8)
    v_mfma_f32_32x32x16_bf16 a[112:127], a[140:143], v[164:167], a[112:127]
    buffer_load_dwordx4 v[96:99], v0, s[4:7], s65 offen offset:0
    v_max_u32 v22, v22, v183
    v_cmp_eq_u32 vcc, -1, v22
    s_cbranch_vccnz parallel_sum__sliding_block__glu_gated_bilinear__prompt_kernel_ro3
parallel_sum__sliding_block__glu_gated_bilinear__prompt_kernel_ror3:
    s_waitcnt lgkmcnt(4)
    v_mfma_f32_32x32x16_bf16 a[112:127], a[148:151], v[172:175], a[112:127]
    buffer_load_dwordx4 v[100:103], v0, s[4:7], s65 offen offset:32
    s_waitcnt lgkmcnt(0)
    v_mfma_f32_32x32x16_bf16 a[112:127], a[156:159], v[180:183], a[112:127]
    v_and_b32 v23, 0x1f0, v2
    s_and_b32 s71, s40, 1
    s_lshl_b32 s71, s71, 9
    s_add_u32 s71, s71, s66
    buffer_load_dword v24, v23, s[20:23], s71 offen offset:4 sc1
    v_mfma_f32_32x32x16_bf16 v[80:95], a[224:227], v[124:127], v[80:95]
    s_nop 4
    v_mfma_f32_32x32x16_bf16 v[80:95], a[232:235], v[132:135], v[80:95]
    ds_write_b128 v28, a[112:115] offset:32768
    v_mfma_f32_32x32x16_bf16 v[80:95], a[240:243], v[140:143], v[80:95]
    ds_write_b128 v28, a[116:119] offset:33792
    v_mfma_f32_32x32x16_bf16 v[80:95], a[248:251], v[148:151], v[80:95]
    ds_write_b128 v28, a[120:123] offset:34816
    v_mfma_f32_32x32x16_bf16 v[80:95], a[128:131], v[156:159], v[80:95]
    ds_write_b128 v28, a[124:127] offset:35840
    v_mfma_f32_32x32x16_bf16 v[80:95], a[136:139], v[164:167], v[80:95]
    s_waitcnt lgkmcnt(0)
    s_barrier
    ds_read_b128 v[224:227], v29 offset:32768
    ds_read_b128 v[228:231], v29 offset:33792
    v_mfma_f32_32x32x16_bf16 v[80:95], a[144:147], v[172:175], v[80:95]
    s_waitcnt vmcnt(9)
    v_max3_u32 v22, v120, v121, v122
    v_max3_u32 v22, v22, v123, v128
    v_max3_u32 v22, v22, v129, v130
    ds_read_b128 v[232:235], v29 offset:34816
    ds_read_b128 v[236:239], v29 offset:35840
    v_mfma_f32_32x32x16_bf16 v[80:95], a[152:155], v[180:183], v[80:95]
    v_max_u32 v22, v22, v131
    v_cmp_eq_u32 vcc, -1, v22
    s_cbranch_vccnz parallel_sum__sliding_block__glu_gated_bilinear__prompt_kernel_ro4
parallel_sum__sliding_block__glu_gated_bilinear__prompt_kernel_ror4:
    s_nop 1
    v_mfma_f32_32x32x16_bf16 a[96:111], a[228:231], v[120:123], a[96:111]
    s_waitcnt vmcnt(7)
    v_max3_u32 v22, v136, v137, v138
    v_max3_u32 v22, v22, v139, v144
    v_max3_u32 v22, v22, v145, v146
    s_nop 1
    v_mfma_f32_32x32x16_bf16 a[96:111], a[236:239], v[128:131], a[96:111]
    ds_write_b128 v28, v[80:83] offset:0
    v_max_u32 v22, v22, v147
    v_cmp_eq_u32 vcc, -1, v22
    s_cbranch_vccnz parallel_sum__sliding_block__glu_gated_bilinear__prompt_kernel_ro5
parallel_sum__sliding_block__glu_gated_bilinear__prompt_kernel_ror5:
    v_mfma_f32_32x32x16_bf16 a[96:111], a[244:247], v[136:139], a[96:111]
    ds_write_b128 v28, v[84:87] offset:1024
    s_waitcnt vmcnt(5)
    v_max3_u32 v22, v152, v153, v154
    v_max3_u32 v22, v22, v155, v160
    v_max3_u32 v22, v22, v161, v162
    v_mfma_f32_32x32x16_bf16 a[96:111], a[252:255], v[144:147], a[96:111]
    ds_write_b128 v28, v[88:91] offset:2048
    v_max_u32 v22, v22, v163
    v_cmp_eq_u32 vcc, -1, v22
    s_cbranch_vccnz parallel_sum__sliding_block__glu_gated_bilinear__prompt_kernel_ro6
parallel_sum__sliding_block__glu_gated_bilinear__prompt_kernel_ror6:
    v_mfma_f32_32x32x16_bf16 a[96:111], a[132:135], v[152:155], a[96:111]
    ds_write_b128 v28, v[92:95] offset:3072
    s_waitcnt vmcnt(3)
    v_max3_u32 v22, v168, v169, v170
    v_max3_u32 v22, v22, v171, v176
    v_max3_u32 v22, v22, v177, v178
    v_mfma_f32_32x32x16_bf16 a[96:111], a[140:143], v[160:163], a[96:111]
    v_max_u32 v22, v22, v179
    v_cmp_eq_u32 vcc, -1, v22
    s_cbranch_vccnz parallel_sum__sliding_block__glu_gated_bilinear__prompt_kernel_ro7
parallel_sum__sliding_block__glu_gated_bilinear__prompt_kernel_ror7:
    v_mfma_f32_32x32x16_bf16 a[96:111], a[148:151], v[168:171], a[96:111]
    s_waitcnt vmcnt(0)
    v_mul_f32 v25, v24, v24
    v_mul_f32 v24, v24, v24
    v_lshlrev_b32 v104, 16, v96
    v_and_b32 v105, 0xffff0000, v96
    v_lshlrev_b32 v106, 16, v97
    s_waitcnt lgkmcnt(0)
    s_barrier
    ds_read_b128 v[240:243], v26 offset:0
    ds_read_b128 v[244:247], v26 offset:1024
    v_mfma_f32_32x32x16_bf16 a[96:111], a[156:159], v[176:179], a[96:111]
    v_and_b32 v107, 0xffff0000, v97
    v_lshlrev_b32 v108, 16, v98
    v_and_b32 v109, 0xffff0000, v98
    v_lshlrev_b32 v110, 16, v99
    v_and_b32 v111, 0xffff0000, v99
    ds_read_b128 v[248:251], v26 offset:2048
    ds_read_b128 v[252:255], v26 offset:3072
    v_mfma_f32_32x32x16_bf16 v[64:79], a[224:227], v[120:123], v[64:79]
    s_waitcnt lgkmcnt(0)
    v_pk_add_f32 v[240:241], v[240:241], v[224:225]
    v_pk_add_f32 v[242:243], v[242:243], v[226:227]
    s_nop 1
    v_mfma_f32_32x32x16_bf16 v[64:79], a[232:235], v[128:131], v[64:79]
    ds_write_b128 v28, a[96:99] offset:16384
    v_pk_add_f32 v[244:245], v[244:245], v[228:229]
    v_pk_add_f32 v[246:247], v[246:247], v[230:231]
    v_mfma_f32_32x32x16_bf16 v[64:79], a[240:243], v[136:139], v[64:79]
    ds_write_b128 v28, a[100:103] offset:17408
    v_pk_add_f32 v[248:249], v[248:249], v[232:233]
    v_pk_add_f32 v[250:251], v[250:251], v[234:235]
    v_mfma_f32_32x32x16_bf16 v[64:79], a[248:251], v[144:147], v[64:79]
    ds_write_b128 v28, a[104:107] offset:18432
    v_pk_add_f32 v[252:253], v[252:253], v[236:237]
    v_pk_add_f32 v[254:255], v[254:255], v[238:239]
    v_mfma_f32_32x32x16_bf16 v[64:79], a[128:131], v[152:155], v[64:79]
    ds_write_b128 v28, a[108:111] offset:19456
    v_lshlrev_b32 v112, 16, v100
    v_and_b32 v113, 0xffff0000, v100
    v_lshlrev_b32 v114, 16, v101
    v_and_b32 v115, 0xffff0000, v101
    v_lshlrev_b32 v116, 16, v102
    v_mfma_f32_32x32x16_bf16 v[64:79], a[136:139], v[160:163], v[64:79]
    v_and_b32 v117, 0xffff0000, v102
    v_lshlrev_b32 v118, 16, v103
    v_and_b32 v119, 0xffff0000, v103
    s_waitcnt lgkmcnt(0)
    s_barrier
    ds_read_b128 v[192:195], v27 offset:16384
    ds_read_b128 v[196:199], v27 offset:17408
    v_mfma_f32_32x32x16_bf16 v[64:79], a[144:147], v[168:171], v[64:79]
    ds_read_b128 v[200:203], v27 offset:18432
    ds_read_b128 v[204:207], v27 offset:19456
    v_mfma_f32_32x32x16_bf16 v[64:79], a[152:155], v[176:179], v[64:79]
    s_waitcnt lgkmcnt(3)
    v_pk_add_f32 v[240:241], v[240:241], v[192:193]
    v_pk_add_f32 v[242:243], v[242:243], v[194:195]
    v_pk_fma_f32 v[104:105], v[240:241], v[24:25], v[104:105]
    v_pk_fma_f32 v[106:107], v[242:243], v[24:25], v[106:107]
    s_waitcnt lgkmcnt(2)
    v_pk_add_f32 v[244:245], v[244:245], v[196:197]
    v_pk_add_f32 v[246:247], v[246:247], v[198:199]
    v_pk_fma_f32 v[108:109], v[244:245], v[24:25], v[108:109]
    v_pk_fma_f32 v[110:111], v[246:247], v[24:25], v[110:111]
    s_waitcnt lgkmcnt(1)
    v_pk_add_f32 v[248:249], v[248:249], v[200:201]
    v_pk_add_f32 v[250:251], v[250:251], v[202:203]
    v_pk_fma_f32 v[112:113], v[248:249], v[24:25], v[112:113]
    v_pk_fma_f32 v[114:115], v[250:251], v[24:25], v[114:115]
    s_waitcnt lgkmcnt(0)
    v_pk_add_f32 v[252:253], v[252:253], v[204:205]
    v_pk_add_f32 v[254:255], v[254:255], v[206:207]
    v_pk_fma_f32 v[116:117], v[252:253], v[24:25], v[116:117]
    v_pk_fma_f32 v[118:119], v[254:255], v[24:25], v[118:119]
    v_pk_fma_f32 v[64:65], v[64:65], v[24:25], v[104:105]
    v_pk_fma_f32 v[66:67], v[66:67], v[24:25], v[106:107]
    v_cvt_pk_bf16_f32 v96, v64, v65
    v_cvt_pk_bf16_f32 v97, v66, v67
    v_pk_fma_f32 v[68:69], v[68:69], v[24:25], v[108:109]
    v_pk_fma_f32 v[70:71], v[70:71], v[24:25], v[110:111]
    v_cvt_pk_bf16_f32 v98, v68, v69
    v_cvt_pk_bf16_f32 v99, v70, v71
    buffer_store_dwordx4 v[96:99], v0, s[32:35], s65 offen offset:0
    v_pk_fma_f32 v[72:73], v[72:73], v[24:25], v[112:113]
    v_pk_fma_f32 v[74:75], v[74:75], v[24:25], v[114:115]
    v_cvt_pk_bf16_f32 v100, v72, v73
    v_cvt_pk_bf16_f32 v101, v74, v75
    v_pk_fma_f32 v[76:77], v[76:77], v[24:25], v[116:117]
    v_pk_fma_f32 v[78:79], v[78:79], v[24:25], v[118:119]
    v_cvt_pk_bf16_f32 v102, v76, v77
    v_cvt_pk_bf16_f32 v103, v78, v79
    buffer_store_dwordx4 v[100:103], v0, s[32:35], s65 offen offset:32
parallel_sum__sliding_block__glu_gated_bilinear__prompt_kernel_end:
    s_endpgm
parallel_sum__sliding_block__glu_gated_bilinear__prompt_kernel_w3G2_0:
    s_branch parallel_sum__sliding_block__glu_gated_bilinear__prompt_kernel_wr3G
parallel_sum__sliding_block__glu_gated_bilinear__prompt_kernel_w3O2_0:
    s_branch parallel_sum__sliding_block__glu_gated_bilinear__prompt_kernel_wr3O
parallel_sum__sliding_block__glu_gated_bilinear__prompt_kernel_ool:
parallel_sum__sliding_block__glu_gated_bilinear__prompt_kernel_rnG:
    s_mov_b32 s72, 16384
parallel_sum__sliding_block__glu_gated_bilinear__prompt_kernel_rnG_l:
    buffer_load_dword v21, off, s[36:39], 0 sc1
    s_waitcnt vmcnt(0)
    v_readfirstlane_b32 s45, v21
    s_cmp_lg_u32 s45, 0
    s_cbranch_scc1 parallel_sum__sliding_block__glu_gated_bilinear__prompt_kernel_rnrG
    s_sleep 2
    s_sub_u32 s72, s72, 1
    s_cmp_lg_u32 s72, 0
    s_cbranch_scc1 parallel_sum__sliding_block__glu_gated_bilinear__prompt_kernel_rnG_l
    s_branch parallel_sum__sliding_block__glu_gated_bilinear__prompt_kernel_rnrG
parallel_sum__sliding_block__glu_gated_bilinear__prompt_kernel_rgG:
    s_mov_b32 s72, 16384
parallel_sum__sliding_block__glu_gated_bilinear__prompt_kernel_rgG_l:
    s_sleep 2
    buffer_load_dwordx4 v[232:235], v242, s[20:23], s54 offen sc1
    buffer_load_dwordx4 v[192:195], v2, s[20:23], s53 offen offset:0 sc1
    buffer_load_dwordx4 v[196:199], v2, s[20:23], s53 offen offset:1024 sc1
    buffer_load_dwordx4 v[200:203], v2, s[20:23], s53 offen offset:2048 sc1
    buffer_load_dwordx4 v[204:207], v2, s[20:23], s53 offen offset:3072 sc1
    s_waitcnt vmcnt(0)
    v_xor_b32 v235, s45, v235
    v_xor_b32 v195, s45, v195
    v_xor_b32 v199, s45, v199
    v_xor_b32 v203, s45, v203
    v_xor_b32 v207, s45, v207
    v_or3_b32 v235, v235, v195, v199
    v_or3_b32 v235, v235, v203, v207
    v_cmp_ne_u32 s[76:77], 0, v235
    s_cmp_eq_u64 s[76:77], 0
    s_cbranch_scc1 parallel_sum__sliding_block__glu_gated_bilinear__prompt_kernel_rgrG
    s_sub_u32 s72, s72, 1
    s_cmp_lg_u32 s72, 0
    s_cbranch_scc1 parallel_sum__sliding_block__glu_gated_bilinear__prompt_kernel_rgG_l
    s_branch parallel_sum__sliding_block__glu_gated_bilinear__prompt_kernel_rgrG
parallel_sum__sliding_block__glu_gated_bilinear__prompt_kernel_p1G:
    s_mov_b32 s72, 16384
parallel_sum__sliding_block__glu_gated_bilinear__prompt_kernel_p1G_l:
    buffer_load_dword v29, v28, s[20:23], s60 offen sc1
    s_waitcnt vmcnt(0)
    v_cmp_eq_u32 s[76:77], s45, v29
    s_andn2_b64 s[76:77], s[78:79], s[76:77]
    s_cbranch_scc0 parallel_sum__sliding_block__glu_gated_bilinear__prompt_kernel_p1Gr
    s_sleep 1
    s_sub_u32 s72, s72, 1
    s_cmp_lg_u32 s72, 0
    s_cbranch_scc1 parallel_sum__sliding_block__glu_gated_bilinear__prompt_kernel_p1G_l
    s_branch parallel_sum__sliding_block__glu_gated_bilinear__prompt_kernel_p1Gr
parallel_sum__sliding_block__glu_gated_bilinear__prompt_kernel_rnO:
    s_mov_b32 s72, 16384
parallel_sum__sliding_block__glu_gated_bilinear__prompt_kernel_rnO_l:
    buffer_load_dword v21, off, s[36:39], 0 sc1
    s_waitcnt vmcnt(0)
    v_readfirstlane_b32 s45, v21
    s_cmp_lg_u32 s45, 0
    s_cbranch_scc1 parallel_sum__sliding_block__glu_gated_bilinear__prompt_kernel_rnrO
    s_sleep 2
    s_sub_u32 s72, s72, 1
    s_cmp_lg_u32 s72, 0
    s_cbranch_scc1 parallel_sum__sliding_block__glu_gated_bilinear__prompt_kernel_rnO_l
    s_branch parallel_sum__sliding_block__glu_gated_bilinear__prompt_kernel_rnrO
parallel_sum__sliding_block__glu_gated_bilinear__prompt_kernel_rgO:
    s_mov_b32 s72, 16384
parallel_sum__sliding_block__glu_gated_bilinear__prompt_kernel_rgO_l:
    s_sleep 2
    buffer_load_dwordx4 v[232:235], v242, s[20:23], s54 offen sc1
    buffer_load_dwordx4 v[192:195], v2, s[20:23], s53 offen offset:0 sc1
    buffer_load_dwordx4 v[196:199], v2, s[20:23], s53 offen offset:1024 sc1
    buffer_load_dwordx4 v[200:203], v2, s[20:23], s53 offen offset:2048 sc1
    buffer_load_dwordx4 v[204:207], v2, s[20:23], s53 offen offset:3072 sc1
    s_waitcnt vmcnt(0)
    v_xor_b32 v235, s45, v235
    v_xor_b32 v195, s45, v195
    v_xor_b32 v199, s45, v199
    v_xor_b32 v203, s45, v203
    v_xor_b32 v207, s45, v207
    v_or3_b32 v235, v235, v195, v199
    v_or3_b32 v235, v235, v203, v207
    v_cmp_ne_u32 s[76:77], 0, v235
    s_cmp_eq_u64 s[76:77], 0
    s_cbranch_scc1 parallel_sum__sliding_block__glu_gated_bilinear__prompt_kernel_rgrO
    s_sub_u32 s72, s72, 1
    s_cmp_lg_u32 s72, 0
    s_cbranch_scc1 parallel_sum__sliding_block__glu_gated_bilinear__prompt_kernel_rgO_l
    s_branch parallel_sum__sliding_block__glu_gated_bilinear__prompt_kernel_rgrO
parallel_sum__sliding_block__glu_gated_bilinear__prompt_kernel_p1O:
    s_mov_b32 s72, 16384
parallel_sum__sliding_block__glu_gated_bilinear__prompt_kernel_p1O_l:
    buffer_load_dword v29, v28, s[20:23], s60 offen sc1
    s_waitcnt vmcnt(0)
    v_cmp_eq_u32 s[76:77], s45, v29
    s_andn2_b64 s[76:77], s[78:79], s[76:77]
    s_cbranch_scc0 parallel_sum__sliding_block__glu_gated_bilinear__prompt_kernel_p1Or
    s_sleep 1
    s_sub_u32 s72, s72, 1
    s_cmp_lg_u32 s72, 0
    s_cbranch_scc1 parallel_sum__sliding_block__glu_gated_bilinear__prompt_kernel_p1O_l
    s_branch parallel_sum__sliding_block__glu_gated_bilinear__prompt_kernel_p1Or
parallel_sum__sliding_block__glu_gated_bilinear__prompt_kernel_pq1:
    s_mov_b32 s72, 16384
parallel_sum__sliding_block__glu_gated_bilinear__prompt_kernel_pq1_l:
    buffer_load_dword v29, v28, s[20:23], s60 offen sc1
    s_waitcnt vmcnt(0)
    v_cmp_eq_u32 s[76:77], s45, v29
    s_andn2_b64 s[76:77], s[78:79], s[76:77]
    s_cbranch_scc0 parallel_sum__sliding_block__glu_gated_bilinear__prompt_kernel_pq1r
    s_sleep 1
    s_sub_u32 s72, s72, 1
    s_cmp_lg_u32 s72, 0
    s_cbranch_scc1 parallel_sum__sliding_block__glu_gated_bilinear__prompt_kernel_pq1_l
    s_branch parallel_sum__sliding_block__glu_gated_bilinear__prompt_kernel_pq1r
parallel_sum__sliding_block__glu_gated_bilinear__prompt_kernel_pq2:
    s_mov_b32 s72, 16384
parallel_sum__sliding_block__glu_gated_bilinear__prompt_kernel_pq2_l:
    buffer_load_dword v29, v28, s[20:23], s60 offen sc1
    s_waitcnt vmcnt(0)
    v_cmp_eq_u32 s[76:77], s45, v29
    s_andn2_b64 s[76:77], s[78:79], s[76:77]
    s_cbranch_scc0 parallel_sum__sliding_block__glu_gated_bilinear__prompt_kernel_pq2r
    s_sleep 1
    s_sub_u32 s72, s72, 1
    s_cmp_lg_u32 s72, 0
    s_cbranch_scc1 parallel_sum__sliding_block__glu_gated_bilinear__prompt_kernel_pq2_l
    s_branch parallel_sum__sliding_block__glu_gated_bilinear__prompt_kernel_pq2r
parallel_sum__sliding_block__glu_gated_bilinear__prompt_kernel_ro0:
    s_mov_b32 s72, 16384
parallel_sum__sliding_block__glu_gated_bilinear__prompt_kernel_ro0_l:
    s_add_u32 s70, s63, 0
    buffer_load_dwordx4 v[124:127], v31, s[20:23], s70 offen offset:0 sc1
    buffer_load_dwordx4 v[132:135], v31, s[20:23], s70 offen offset:1024 sc1
    buffer_load_dwordx4 v[140:143], v31, s[20:23], s70 offen offset:2048 sc1
    buffer_load_dwordx4 v[148:151], v31, s[20:23], s70 offen offset:3072 sc1
    s_add_u32 s70, s63, 4096
    buffer_load_dwordx4 v[156:159], v31, s[20:23], s70 offen offset:0 sc1
    buffer_load_dwordx4 v[164:167], v31, s[20:23], s70 offen offset:1024 sc1
    buffer_load_dwordx4 v[172:175], v31, s[20:23], s70 offen offset:2048 sc1
    buffer_load_dwordx4 v[180:183], v31, s[20:23], s70 offen offset:3072 sc1
    s_add_u32 s70, s63, 0
    buffer_load_dwordx4 v[120:123], v30, s[20:23], s70 offen offset:0 sc1
    buffer_load_dwordx4 v[128:131], v30, s[20:23], s70 offen offset:1024 sc1
    buffer_load_dwordx4 v[136:139], v30, s[20:23], s70 offen offset:2048 sc1
    buffer_load_dwordx4 v[144:147], v30, s[20:23], s70 offen offset:3072 sc1
    s_add_u32 s70, s63, 4096
    buffer_load_dwordx4 v[152:155], v30, s[20:23], s70 offen offset:0 sc1
    buffer_load_dwordx4 v[160:163], v30, s[20:23], s70 offen offset:1024 sc1
    buffer_load_dwordx4 v[168:171], v30, s[20:23], s70 offen offset:2048 sc1
    buffer_load_dwordx4 v[176:179], v30, s[20:23], s70 offen offset:3072 sc1
    s_waitcnt vmcnt(0)
    v_max3_u32 v22, v124, v125, v126
    v_max3_u32 v22, v22, v127, v132
    v_max3_u32 v22, v22, v133, v134
    v_max_u32 v22, v22, v135
    v_cmp_eq_u32 vcc, -1, v22
    s_cbranch_vccz parallel_sum__sliding_block__glu_gated_bilinear__prompt_kernel_ror0
    s_sub_u32 s72, s72, 1
    s_cmp_lg_u32 s72, 0
    s_cbranch_scc1 parallel_sum__sliding_block__glu_gated_bilinear__prompt_kernel_ro0_l
    s_branch parallel_sum__sliding_block__glu_gated_bilinear__prompt_kernel_ror0
parallel_sum__sliding_block__glu_gated_bilinear__prompt_kernel_ro1:
    s_mov_b32 s72, 16384
parallel_sum__sliding_block__glu_gated_bilinear__prompt_kernel_ro1_l:
    s_add_u32 s70, s63, 0
    buffer_load_dwordx4 v[140:143], v31, s[20:23], s70 offen offset:2048 sc1
    buffer_load_dwordx4 v[148:151], v31, s[20:23], s70 offen offset:3072 sc1
    s_add_u32 s70, s63, 4096
    buffer_load_dwordx4 v[156:159], v31, s[20:23], s70 offen offset:0 sc1
    buffer_load_dwordx4 v[164:167], v31, s[20:23], s70 offen offset:1024 sc1
    buffer_load_dwordx4 v[172:175], v31, s[20:23], s70 offen offset:2048 sc1
    buffer_load_dwordx4 v[180:183], v31, s[20:23], s70 offen offset:3072 sc1
    s_add_u32 s70, s63, 0
    buffer_load_dwordx4 v[120:123], v30, s[20:23], s70 offen offset:0 sc1
    buffer_load_dwordx4 v[128:131], v30, s[20:23], s70 offen offset:1024 sc1
    buffer_load_dwordx4 v[136:139], v30, s[20:23], s70 offen offset:2048 sc1
    buffer_load_dwordx4 v[144:147], v30, s[20:23], s70 offen offset:3072 sc1
    s_add_u32 s70, s63, 4096
    buffer_load_dwordx4 v[152:155], v30, s[20:23], s70 offen offset:0 sc1
    buffer_load_dwordx4 v[160:163], v30, s[20:23], s70 offen offset:1024 sc1
    buffer_load_dwordx4 v[168:171], v30, s[20:23], s70 offen offset:2048 sc1
    buffer_load_dwordx4 v[176:179], v30, s[20:23], s70 offen offset:3072 sc1
    s_waitcnt vmcnt(0)
    v_max3_u32 v22, v140, v141, v142
    v_max3_u32 v22, v22, v143, v148
    v_max3_u32 v22, v22, v149, v150
    v_max_u32 v22, v22, v151
    v_cmp_eq_u32 vcc, -1, v22
    s_cbranch_vccz parallel_sum__sliding_block__glu_gated_bilinear__prompt_kernel_ror1
    s_sub_u32 s72, s72, 1
    s_cmp_lg_u32 s72, 0
    s_cbranch_scc1 parallel_sum__sliding_block__glu_gated_bilinear__prompt_kernel_ro1_l
    s_branch parallel_sum__sliding_block__glu_gated_bilinear__prompt_kernel_ror1
parallel_sum__sliding_block__glu_gated_bilinear__prompt_kernel_ro2:
    s_mov_b32 s72, 16384
parallel_sum__sliding_block__glu_gated_bilinear__prompt_kernel_ro2_l:
    s_add_u32 s70, s63, 4096
    buffer_load_dwordx4 v[156:159], v31, s[20:23], s70 offen offset:0 sc1
    buffer_load_dwordx4 v[164:167], v31, s[20:23], s70 offen offset:1024 sc1
    buffer_load_dwordx4 v[172:175], v31, s[20:23], s70 offen offset:2048 sc1
    buffer_load_dwordx4 v[180:183], v31, s[20:23], s70 offen offset:3072 sc1
    s_add_u32 s70, s63, 0
    buffer_load_dwordx4 v[120:123], v30, s[20:23], s70 offen offset:0 sc1
    buffer_load_dwordx4 v[128:131], v30, s[20:23], s70 offen offset:1024 sc1
    buffer_load_dwordx4 v[136:139], v30, s[20:23], s70 offen offset:2048 sc1
    buffer_load_dwordx4 v[144:147], v30, s[20:23], s70 offen offset:3072 sc1
    s_add_u32 s70, s63, 4096
    buffer_load_dwordx4 v[152:155], v30, s[20:23], s70 offen offset:0 sc1
    buffer_load_dwordx4 v[160:163], v30, s[20:23], s70 offen offset:1024 sc1
    buffer_load_dwordx4 v[168:171], v30, s[20:23], s70 offen offset:2048 sc1
    buffer_load_dwordx4 v[176:179], v30, s[20:23], s70 offen offset:3072 sc1
    s_waitcnt vmcnt(0)
    v_max3_u32 v22, v156, v157, v158
    v_max3_u32 v22, v22, v159, v164
    v_max3_u32 v22, v22, v165, v166
    v_max_u32 v22, v22, v167
    v_cmp_eq_u32 vcc, -1, v22
    s_cbranch_vccz parallel_sum__sliding_block__glu_gated_bilinear__prompt_kernel_ror2
    s_sub_u32 s72, s72, 1
    s_cmp_lg_u32 s72, 0
    s_cbranch_scc1 parallel_sum__sliding_block__glu_gated_bilinear__prompt_kernel_ro2_l
    s_branch parallel_sum__sliding_block__glu_gated_bilinear__prompt_kernel_ror2
parallel_sum__sliding_block__glu_gated_bilinear__prompt_kernel_ro3:
    s_mov_b32 s72, 16384
parallel_sum__sliding_block__glu_gated_bilinear__prompt_kernel_ro3_l:
    s_add_u32 s70, s63, 4096
    buffer_load_dwordx4 v[172:175], v31, s[20:23], s70 offen offset:2048 sc1
    buffer_load_dwordx4 v[180:183], v31, s[20:23], s70 offen offset:3072 sc1
    s_add_u32 s70, s63, 0
    buffer_load_dwordx4 v[120:123], v30, s[20:23], s70 offen offset:0 sc1
    buffer_load_dwordx4 v[128:131], v30, s[20:23], s70 offen offset:1024 sc1
    buffer_load_dwordx4 v[136:139], v30, s[20:23], s70 offen offset:2048 sc1
    buffer_load_dwordx4 v[144:147], v30, s[20:23], s70 offen offset:3072 sc1
    s_add_u32 s70, s63, 4096
    buffer_load_dwordx4 v[152:155], v30, s[20:23], s70 offen offset:0 sc1
    buffer_load_dwordx4 v[160:163], v30, s[20:23], s70 offen offset:1024 sc1
    buffer_load_dwordx4 v[168:171], v30, s[20:23], s70 offen offset:2048 sc1
    buffer_load_dwordx4 v[176:179], v30, s[20:23], s70 offen offset:3072 sc1
    s_waitcnt vmcnt(0)
    v_max3_u32 v22, v172, v173, v174
    v_max3_u32 v22, v22, v175, v180
    v_max3_u32 v22, v22, v181, v182
    v_max_u32 v22, v22, v183
    v_cmp_eq_u32 vcc, -1, v22
    s_cbranch_vccz parallel_sum__sliding_block__glu_gated_bilinear__prompt_kernel_ror3
    s_sub_u32 s72, s72, 1
    s_cmp_lg_u32 s72, 0
    s_cbranch_scc1 parallel_sum__sliding_block__glu_gated_bilinear__prompt_kernel_ro3_l
    s_branch parallel_sum__sliding_block__glu_gated_bilinear__prompt_kernel_ror3
parallel_sum__sliding_block__glu_gated_bilinear__prompt_kernel_ro4:
    s_mov_b32 s72, 16384
parallel_sum__sliding_block__glu_gated_bilinear__prompt_kernel_ro4_l:
    s_add_u32 s70, s63, 0
    buffer_load_dwordx4 v[120:123], v30, s[20:23], s70 offen offset:0 sc1
    buffer_load_dwordx4 v[128:131], v30, s[20:23], s70 offen offset:1024 sc1
    buffer_load_dwordx4 v[136:139], v30, s[20:23], s70 offen offset:2048 sc1
    buffer_load_dwordx4 v[144:147], v30, s[20:23], s70 offen offset:3072 sc1
    s_add_u32 s70, s63, 4096
    buffer_load_dwordx4 v[152:155], v30, s[20:23], s70 offen offset:0 sc1
    buffer_load_dwordx4 v[160:163], v30, s[20:23], s70 offen offset:1024 sc1
    buffer_load_dwordx4 v[168:171], v30, s[20:23], s70 offen offset:2048 sc1
    buffer_load_dwordx4 v[176:179], v30, s[20:23], s70 offen offset:3072 sc1
    s_waitcnt vmcnt(0)
    v_max3_u32 v22, v120, v121, v122
    v_max3_u32 v22, v22, v123, v128
    v_max3_u32 v22, v22, v129, v130
    v_max_u32 v22, v22, v131
    v_cmp_eq_u32 vcc, -1, v22
    s_cbranch_vccz parallel_sum__sliding_block__glu_gated_bilinear__prompt_kernel_ror4
    s_sub_u32 s72, s72, 1
    s_cmp_lg_u32 s72, 0
    s_cbranch_scc1 parallel_sum__sliding_block__glu_gated_bilinear__prompt_kernel_ro4_l
    s_branch parallel_sum__sliding_block__glu_gated_bilinear__prompt_kernel_ror4
parallel_sum__sliding_block__glu_gated_bilinear__prompt_kernel_ro5:
    s_mov_b32 s72, 16384
parallel_sum__sliding_block__glu_gated_bilinear__prompt_kernel_ro5_l:
    s_add_u32 s70, s63, 0
    buffer_load_dwordx4 v[136:139], v30, s[20:23], s70 offen offset:2048 sc1
    buffer_load_dwordx4 v[144:147], v30, s[20:23], s70 offen offset:3072 sc1
    s_add_u32 s70, s63, 4096
    buffer_load_dwordx4 v[152:155], v30, s[20:23], s70 offen offset:0 sc1
    buffer_load_dwordx4 v[160:163], v30, s[20:23], s70 offen offset:1024 sc1
    buffer_load_dwordx4 v[168:171], v30, s[20:23], s70 offen offset:2048 sc1
    buffer_load_dwordx4 v[176:179], v30, s[20:23], s70 offen offset:3072 sc1
    s_waitcnt vmcnt(0)
    v_max3_u32 v22, v136, v137, v138
    v_max3_u32 v22, v22, v139, v144
    v_max3_u32 v22, v22, v145, v146
    v_max_u32 v22, v22, v147
    v_cmp_eq_u32 vcc, -1, v22
    s_cbranch_vccz parallel_sum__sliding_block__glu_gated_bilinear__prompt_kernel_ror5
    s_sub_u32 s72, s72, 1
    s_cmp_lg_u32 s72, 0
    s_cbranch_scc1 parallel_sum__sliding_block__glu_gated_bilinear__prompt_kernel_ro5_l
    s_branch parallel_sum__sliding_block__glu_gated_bilinear__prompt_kernel_ror5
parallel_sum__sliding_block__glu_gated_bilinear__prompt_kernel_ro6:
    s_mov_b32 s72, 16384
parallel_sum__sliding_block__glu_gated_bilinear__prompt_kernel_ro6_l:
    s_add_u32 s70, s63, 4096
    buffer_load_dwordx4 v[152:155], v30, s[20:23], s70 offen offset:0 sc1
    buffer_load_dwordx4 v[160:163], v30, s[20:23], s70 offen offset:1024 sc1
    buffer_load_dwordx4 v[168:171], v30, s[20:23], s70 offen offset:2048 sc1
    buffer_load_dwordx4 v[176:179], v30, s[20:23], s70 offen offset:3072 sc1
    s_waitcnt vmcnt(0)
    v_max3_u32 v22, v152, v153, v154
    v_max3_u32 v22, v22, v155, v160
    v_max3_u32 v22, v22, v161, v162
    v_max_u32 v22, v22, v163
    v_cmp_eq_u32 vcc, -1, v22
    s_cbranch_vccz parallel_sum__sliding_block__glu_gated_bilinear__prompt_kernel_ror6
    s_sub_u32 s72, s72, 1
    s_cmp_lg_u32 s72, 0
    s_cbranch_scc1 parallel_sum__sliding_block__glu_gated_bilinear__prompt_kernel_ro6_l
    s_branch parallel_sum__sliding_block__glu_gated_bilinear__prompt_kernel_ror6
parallel_sum__sliding_block__glu_gated_bilinear__prompt_kernel_ro7:
    s_mov_b32 s72, 16384
parallel_sum__sliding_block__glu_gated_bilinear__prompt_kernel_ro7_l:
    s_add_u32 s70, s63, 4096
    buffer_load_dwordx4 v[168:171], v30, s[20:23], s70 offen offset:2048 sc1
    buffer_load_dwordx4 v[176:179], v30, s[20:23], s70 offen offset:3072 sc1
    s_waitcnt vmcnt(0)
    v_max3_u32 v22, v168, v169, v170
    v_max3_u32 v22, v22, v171, v176
    v_max3_u32 v22, v22, v177, v178
    v_max_u32 v22, v22, v179
    v_cmp_eq_u32 vcc, -1, v22
    s_cbranch_vccz parallel_sum__sliding_block__glu_gated_bilinear__prompt_kernel_ror7
    s_sub_u32 s72, s72, 1
    s_cmp_lg_u32 s72, 0
    s_cbranch_scc1 parallel_sum__sliding_block__glu_gated_bilinear__prompt_kernel_ro7_l
    s_branch parallel_sum__sliding_block__glu_gated_bilinear__prompt_kernel_ror7
parallel_sum__sliding_block__glu_gated_bilinear__prompt_kernel_fb:
    s_mov_b32 s67, -1
    s_nop 7
    s_nop 7
    v_lshrrev_b32 v238, 5, v1
    v_and_b32 v237, 31, v1
    v_lshlrev_b32 v238, 2, v238
    v_sub_u32 v237, v237, v238
    v_mov_b32 v238, 0xf149f2ca
    v_mov_b32 v236, 0xf149f2ca
    s_add_u32 s70, s61, 262144
    buffer_load_dwordx4 v[224:227], v26, s[20:23], s70 offen sc1
    v_cmp_le_i32 vcc, 0, v237
    s_nop 1
    v_cndmask_b32 v240, v238, 0, vcc
    v_cmp_le_i32 vcc, 1, v237
    s_nop 1
    v_cndmask_b32 v241, v238, 0, vcc
    v_cmp_le_i32 vcc, 2, v237
    s_nop 1
    v_cndmask_b32 v242, v238, 0, vcc
    v_cmp_le_i32 vcc, 3, v237
    s_nop 1
    v_cndmask_b32 v243, v238, 0, vcc
    v_cmp_le_i32 vcc, 8, v237
    s_nop 1
    v_cndmask_b32 v244, v238, 0, vcc
    v_cmp_le_i32 vcc, 9, v237
    s_nop 1
    v_cndmask_b32 v245, v238, 0, vcc
    v_cmp_le_i32 vcc, 10, v237
    s_nop 1
    v_cndmask_b32 v246, v238, 0, vcc
    v_cmp_le_i32 vcc, 11, v237
    s_nop 1
    v_cndmask_b32 v247, v238, 0, vcc
    v_cmp_le_i32 vcc, 16, v237
    s_nop 1
    v_cndmask_b32 v248, v238, 0, vcc
    v_cmp_le_i32 vcc, 17, v237
    s_nop 1
    v_cndmask_b32 v249, v238, 0, vcc
    v_cmp_le_i32 vcc, 18, v237
    s_nop 1
    v_cndmask_b32 v250, v238, 0, vcc
    v_cmp_le_i32 vcc, 19, v237
    s_nop 1
    v_cndmask_b32 v251, v238, 0, vcc
    v_cmp_le_i32 vcc, 24, v237
    s_nop 1
    v_cndmask_b32 v252, v238, 0, vcc
    v_cmp_le_i32 vcc, 25, v237
    s_nop 1
    v_cndmask_b32 v253, v238, 0, vcc
    v_cmp_le_i32 vcc, 26, v237
    s_nop 1
    v_cndmask_b32 v254, v238, 0, vcc
    v_cmp_le_i32 vcc, 27, v237
    s_nop 1
    v_cndmask_b32 v255, v238, 0, vcc
    s_waitcnt vmcnt(0)
    s_nop 0
    v_mfma_f32_32x32x16_bf16 v[240:255], v[224:227], v[96:99], v[240:255]
    s_nop 7
    s_nop 7
    v_max3_f32 v236, v236, v240, v241
    v_max3_f32 v236, v236, v242, v243
    v_max3_f32 v236, v236, v244, v245
    v_max3_f32 v236, v236, v246, v247
    v_max3_f32 v236, v236, v248, v249
    v_max3_f32 v236, v236, v250, v251
    v_max3_f32 v236, v236, v252, v253
    v_max3_f32 v236, v236, v254, v255
parallel_sum__sliding_block__glu_gated_bilinear__prompt_kernel_fb000:
    s_cmp_le_u32 s68, 0
    s_cbranch_scc1 parallel_sum__sliding_block__glu_gated_bilinear__prompt_kernel_fb001
    s_add_u32 s70, s61, 229376
    buffer_load_dwordx4 v[224:227], v26, s[20:23], s70 offen sc1
    s_waitcnt vmcnt(0)
    v_mfma_f32_32x32x16_bf16 v[240:255], v[224:227], v[96:99], 0
    s_nop 7
    s_nop 7
    v_max3_f32 v236, v236, v240, v241
    v_max3_f32 v236, v236, v242, v243
    v_max3_f32 v236, v236, v244, v245
    v_max3_f32 v236, v236, v246, v247
    v_max3_f32 v236, v236, v248, v249
    v_max3_f32 v236, v236, v250, v251
    v_max3_f32 v236, v236, v252, v253
    v_max3_f32 v236, v236, v254, v255
parallel_sum__sliding_block__glu_gated_bilinear__prompt_kernel_fb001:
    s_cmp_le_u32 s68, 0
    s_cbranch_scc1 parallel_sum__sliding_block__glu_gated_bilinear__prompt_kernel_fb002
    s_add_u32 s70, s61, 196608
    buffer_load_dwordx4 v[224:227], v26, s[20:23], s70 offen sc1
    s_waitcnt vmcnt(0)
    v_mfma_f32_32x32x16_bf16 v[240:255], v[224:227], v[96:99], 0
    s_nop 7
    s_nop 7
    v_max3_f32 v236, v236, v240, v241
    v_max3_f32 v236, v236, v242, v243
    v_max3_f32 v236, v236, v244, v245
    v_max3_f32 v236, v236, v246, v247
    v_max3_f32 v236, v236, v248, v249
    v_max3_f32 v236, v236, v250, v251
    v_max3_f32 v236, v236, v252, v253
    v_max3_f32 v236, v236, v254, v255
parallel_sum__sliding_block__glu_gated_bilinear__prompt_kernel_fb002:
    s_cmp_le_u32 s68, 1
    s_cbranch_scc1 parallel_sum__sliding_block__glu_gated_bilinear__prompt_kernel_fb003
    s_add_u32 s70, s61, 163840
    buffer_load_dwordx4 v[224:227], v26, s[20:23], s70 offen sc1
    s_waitcnt vmcnt(0)
    v_mfma_f32_32x32x16_bf16 v[240:255], v[224:227], v[96:99], 0
    s_nop 7
    s_nop 7
    v_max3_f32 v236, v236, v240, v241
    v_max3_f32 v236, v236, v242, v243
    v_max3_f32 v236, v236, v244, v245
    v_max3_f32 v236, v236, v246, v247
    v_max3_f32 v236, v236, v248, v249
    v_max3_f32 v236, v236, v250, v251
    v_max3_f32 v236, v236, v252, v253
    v_max3_f32 v236, v236, v254, v255
parallel_sum__sliding_block__glu_gated_bilinear__prompt_kernel_fb003:
    s_cmp_le_u32 s68, 1
    s_cbranch_scc1 parallel_sum__sliding_block__glu_gated_bilinear__prompt_kernel_fb004
    s_add_u32 s70, s61, 131072
    buffer_load_dwordx4 v[224:227], v26, s[20:23], s70 offen sc1
    s_waitcnt vmcnt(0)
    v_mfma_f32_32x32x16_bf16 v[240:255], v[224:227], v[96:99], 0
    s_nop 7
    s_nop 7
    v_max3_f32 v236, v236, v240, v241
    v_max3_f32 v236, v236, v242, v243
    v_max3_f32 v236, v236, v244, v245
    v_max3_f32 v236, v236, v246, v247
    v_max3_f32 v236, v236, v248, v249
    v_max3_f32 v236, v236, v250, v251
    v_max3_f32 v236, v236, v252, v253
    v_max3_f32 v236, v236, v254, v255
parallel_sum__sliding_block__glu_gated_bilinear__prompt_kernel_fb004:
    s_cmp_le_u32 s68, 2
    s_cbranch_scc1 parallel_sum__sliding_block__glu_gated_bilinear__prompt_kernel_fb005
    s_add_u32 s70, s61, 98304
    buffer_load_dwordx4 v[224:227], v26, s[20:23], s70 offen sc1
    s_waitcnt vmcnt(0)
    v_mfma_f32_32x32x16_bf16 v[240:255], v[224:227], v[96:99], 0
    s_nop 7
    s_nop 7
    v_max3_f32 v236, v236, v240, v241
    v_max3_f32 v236, v236, v242, v243
    v_max3_f32 v236, v236, v244, v245
    v_max3_f32 v236, v236, v246, v247
    v_max3_f32 v236, v236, v248, v249
    v_max3_f32 v236, v236, v250, v251
    v_max3_f32 v236, v236, v252, v253
    v_max3_f32 v236, v236, v254, v255
parallel_sum__sliding_block__glu_gated_bilinear__prompt_kernel_fb005:
    s_cmp_le_u32 s68, 2
    s_cbranch_scc1 parallel_sum__sliding_block__glu_gated_bilinear__prompt_kernel_fb006
    s_add_u32 s70, s61, 65536
    buffer_load_dwordx4 v[224:227], v26, s[20:23], s70 offen sc1
    s_waitcnt vmcnt(0)
    v_mfma_f32_32x32x16_bf16 v[240:255], v[224:227], v[96:99], 0
    s_nop 7
    s_nop 7
    v_max3_f32 v236, v236, v240, v241
    v_max3_f32 v236, v236, v242, v243
    v_max3_f32 v236, v236, v244, v245
    v_max3_f32 v236, v236, v246, v247
    v_max3_f32 v236, v236, v248, v249
    v_max3_f32 v236, v236, v250, v251
    v_max3_f32 v236, v236, v252, v253
    v_max3_f32 v236, v236, v254, v255
parallel_sum__sliding_block__glu_gated_bilinear__prompt_kernel_fb006:
    s_cmp_le_u32 s68, 3
    s_cbranch_scc1 parallel_sum__sliding_block__glu_gated_bilinear__prompt_kernel_fb007
    s_add_u32 s70, s61, 32768
    buffer_load_dwordx4 v[224:227], v26, s[20:23], s70 offen sc1
    s_waitcnt vmcnt(0)
    v_mfma_f32_32x32x16_bf16 v[240:255], v[224:227], v[96:99], 0
    s_nop 7
    s_nop 7
    v_max3_f32 v236, v236, v240, v241
    v_max3_f32 v236, v236, v242, v243
    v_max3_f32 v236, v236, v244, v245
    v_max3_f32 v236, v236, v246, v247
    v_max3_f32 v236, v236, v248, v249
    v_max3_f32 v236, v236, v250, v251
    v_max3_f32 v236, v236, v252, v253
    v_max3_f32 v236, v236, v254, v255
parallel_sum__sliding_block__glu_gated_bilinear__prompt_kernel_fb007:
    s_cmp_le_u32 s68, 3
    s_cbranch_scc1 parallel_sum__sliding_block__glu_gated_bilinear__prompt_kernel_fb008
    s_add_u32 s70, s61, 0
    buffer_load_dwordx4 v[224:227], v26, s[20:23], s70 offen sc1
    v_cmp_le_i32 vcc, 0, v237
    s_nop 1
    v_cndmask_b32 v240, 0, v238, vcc
    v_cmp_le_i32 vcc, 1, v237
    s_nop 1
    v_cndmask_b32 v241, 0, v238, vcc
    v_cmp_le_i32 vcc, 2, v237
    s_nop 1
    v_cndmask_b32 v242, 0, v238, vcc
    v_cmp_le_i32 vcc, 3, v237
    s_nop 1
    v_cndmask_b32 v243, 0, v238, vcc
    v_cmp_le_i32 vcc, 8, v237
    s_nop 1
    v_cndmask_b32 v244, 0, v238, vcc
    v_cmp_le_i32 vcc, 9, v237
    s_nop 1
    v_cndmask_b32 v245, 0, v238, vcc
    v_cmp_le_i32 vcc, 10, v237
    s_nop 1
    v_cndmask_b32 v246, 0, v238, vcc
    v_cmp_le_i32 vcc, 11, v237
    s_nop 1
    v_cndmask_b32 v247, 0, v238, vcc
    v_cmp_le_i32 vcc, 16, v237
    s_nop 1
    v_cndmask_b32 v248, 0, v238, vcc
    v_cmp_le_i32 vcc, 17, v237
    s_nop 1
    v_cndmask_b32 v249, 0, v238, vcc
    v_cmp_le_i32 vcc, 18, v237
    s_nop 1
    v_cndmask_b32 v250, 0, v238, vcc
    v_cmp_le_i32 vcc, 19, v237
    s_nop 1
    v_cndmask_b32 v251, 0, v238, vcc
    v_cmp_le_i32 vcc, 24, v237
    s_nop 1
    v_cndmask_b32 v252, 0, v238, vcc
    v_cmp_le_i32 vcc, 25, v237
    s_nop 1
    v_cndmask_b32 v253, 0, v238, vcc
    v_cmp_le_i32 vcc, 26, v237
    s_nop 1
    v_cndmask_b32 v254, 0, v238, vcc
    v_cmp_le_i32 vcc, 27, v237
    s_nop 1
    v_cndmask_b32 v255, 0, v238, vcc
    s_waitcnt vmcnt(0)
    s_nop 0
    v_mfma_f32_32x32x16_bf16 v[240:255], v[224:227], v[96:99], v[240:255]
    s_nop 7
    s_nop 7
    v_max3_f32 v236, v236, v240, v241
    v_max3_f32 v236, v236, v242, v243
    v_max3_f32 v236, v236, v244, v245
    v_max3_f32 v236, v236, v246, v247
    v_max3_f32 v236, v236, v248, v249
    v_max3_f32 v236, v236, v250, v251
    v_max3_f32 v236, v236, v252, v253
    v_max3_f32 v236, v236, v254, v255
parallel_sum__sliding_block__glu_gated_bilinear__prompt_kernel_fb008:
    v_mov_b32 v22, v236
    s_nop 1
    v_permlane32_swap_b32 v236, v22
    v_max_f32 v236, v236, v22
    s_add_u32 s70, s61, 262144
    buffer_load_dwordx4 v[224:227], v26, s[20:23], s70 offen sc1
    buffer_load_dwordx4 v[228:231], v27, s[20:23], s70 offen sc1
    v_mov_b32 v232, 0x3f803f80
    v_mov_b32 v233, 0x3f803f80
    v_mov_b32 v234, 0x3f803f80
    v_mov_b32 v235, 0x3f803f80
    v_cmp_le_i32 vcc, 0, v237
    s_nop 1
    v_cndmask_b32 v240, v238, 0, vcc
    v_cmp_le_i32 vcc, 1, v237
    s_nop 1
    v_cndmask_b32 v241, v238, 0, vcc
    v_cmp_le_i32 vcc, 2, v237
    s_nop 1
    v_cndmask_b32 v242, v238, 0, vcc
    v_cmp_le_i32 vcc, 3, v237
    s_nop 1
    v_cndmask_b32 v243, v238, 0, vcc
    v_cmp_le_i32 vcc, 8, v237
    s_nop 1
    v_cndmask_b32 v244, v238, 0, vcc
    v_cmp_le_i32 vcc, 9, v237
    s_nop 1
    v_cndmask_b32 v245, v238, 0, vcc
    v_cmp_le_i32 vcc, 10, v237
    s_nop 1
    v_cndmask_b32 v246, v238, 0, vcc
    v_cmp_le_i32 vcc, 11, v237
    s_nop 1
    v_cndmask_b32 v247, v238, 0, vcc
    v_cmp_le_i32 vcc, 16, v237
    s_nop 1
    v_cndmask_b32 v248, v238, 0, vcc
    v_cmp_le_i32 vcc, 17, v237
    s_nop 1
    v_cndmask_b32 v249, v238, 0, vcc
    v_cmp_le_i32 vcc, 18, v237
    s_nop 1
    v_cndmask_b32 v250, v238, 0, vcc
    v_cmp_le_i32 vcc, 19, v237
    s_nop 1
    v_cndmask_b32 v251, v238, 0, vcc
    v_cmp_le_i32 vcc, 24, v237
    s_nop 1
    v_cndmask_b32 v252, v238, 0, vcc
    v_cmp_le_i32 vcc, 25, v237
    s_nop 1
    v_cndmask_b32 v253, v238, 0, vcc
    v_cmp_le_i32 vcc, 26, v237
    s_nop 1
    v_cndmask_b32 v254, v238, 0, vcc
    v_cmp_le_i32 vcc, 27, v237
    s_nop 1
    v_cndmask_b32 v255, v238, 0, vcc
    s_waitcnt vmcnt(0)
    s_nop 0
    v_mfma_f32_32x32x16_bf16 v[240:255], v[224:227], v[96:99], v[240:255]
    s_nop 7
    s_nop 7
    v_permlane16_swap_b32 v228, v232
    v_permlane16_swap_b32 v229, v233
    v_permlane16_swap_b32 v230, v234
    v_permlane16_swap_b32 v231, v235
    v_sub_f32 v240, v240, v236
    v_sub_f32 v241, v241, v236
    v_sub_f32 v242, v242, v236
    v_sub_f32 v243, v243, v236
    v_sub_f32 v244, v244, v236
    v_sub_f32 v245, v245, v236
    v_sub_f32 v246, v246, v236
    v_sub_f32 v247, v247, v236
    v_sub_f32 v248, v248, v236
    v_sub_f32 v249, v249, v236
    v_sub_f32 v250, v250, v236
    v_sub_f32 v251, v251, v236
    v_sub_f32 v252, v252, v236
    v_sub_f32 v253, v253, v236
    v_sub_f32 v254, v254, v236
    v_sub_f32 v255, v255, v236
    v_exp_f32 v240, v240
    v_exp_f32 v241, v241
    v_exp_f32 v242, v242
    v_exp_f32 v243, v243
    v_exp_f32 v244, v244
    v_exp_f32 v245, v245
    v_exp_f32 v246, v246
    v_exp_f32 v247, v247
    v_exp_f32 v248, v248
    v_exp_f32 v249, v249
    v_exp_f32 v250, v250
    v_exp_f32 v251, v251
    v_exp_f32 v252, v252
    v_exp_f32 v253, v253
    v_exp_f32 v254, v254
    v_exp_f32 v255, v255
    s_nop 0
    v_cvt_pk_bf16_f32 v240, v240, v241
    v_cvt_pk_bf16_f32 v241, v242, v243
    v_cvt_pk_bf16_f32 v242, v244, v245
    v_cvt_pk_bf16_f32 v243, v246, v247
    v_cvt_pk_bf16_f32 v244, v248, v249
    v_cvt_pk_bf16_f32 v245, v250, v251
    v_cvt_pk_bf16_f32 v246, v252, v253
    v_cvt_pk_bf16_f32 v247, v254, v255
    s_nop 1
    v_mfma_f32_32x32x16_bf16 v[192:207], v[228:231], v[240:243], 0
    v_mfma_f32_32x32x16_bf16 v[192:207], v[232:235], v[244:247], v[192:207]
    s_nop 7
    s_nop 7
    s_nop 7
parallel_sum__sliding_block__glu_gated_bilinear__prompt_kernel_fb010:
    s_cmp_le_u32 s68, 0
    s_cbranch_scc1 parallel_sum__sliding_block__glu_gated_bilinear__prompt_kernel_fb011
    s_add_u32 s70, s61, 229376
    buffer_load_dwordx4 v[224:227], v26, s[20:23], s70 offen sc1
    buffer_load_dwordx4 v[228:231], v27, s[20:23], s70 offen sc1
    v_mov_b32 v232, 0x3f803f80
    v_mov_b32 v233, 0x3f803f80
    v_mov_b32 v234, 0x3f803f80
    v_mov_b32 v235, 0x3f803f80
    s_waitcnt vmcnt(0)
    v_mfma_f32_32x32x16_bf16 v[240:255], v[224:227], v[96:99], 0
    s_nop 7
    s_nop 7
    v_permlane16_swap_b32 v228, v232
    v_permlane16_swap_b32 v229, v233
    v_permlane16_swap_b32 v230, v234
    v_permlane16_swap_b32 v231, v235
    v_sub_f32 v240, v240, v236
    v_sub_f32 v241, v241, v236
    v_sub_f32 v242, v242, v236
    v_sub_f32 v243, v243, v236
    v_sub_f32 v244, v244, v236
    v_sub_f32 v245, v245, v236
    v_sub_f32 v246, v246, v236
    v_sub_f32 v247, v247, v236
    v_sub_f32 v248, v248, v236
    v_sub_f32 v249, v249, v236
    v_sub_f32 v250, v250, v236
    v_sub_f32 v251, v251, v236
    v_sub_f32 v252, v252, v236
    v_sub_f32 v253, v253, v236
    v_sub_f32 v254, v254, v236
    v_sub_f32 v255, v255, v236
    v_exp_f32 v240, v240
    v_exp_f32 v241, v241
    v_exp_f32 v242, v242
    v_exp_f32 v243, v243
    v_exp_f32 v244, v244
    v_exp_f32 v245, v245
    v_exp_f32 v246, v246
    v_exp_f32 v247, v247
    v_exp_f32 v248, v248
    v_exp_f32 v249, v249
    v_exp_f32 v250, v250
    v_exp_f32 v251, v251
    v_exp_f32 v252, v252
    v_exp_f32 v253, v253
    v_exp_f32 v254, v254
    v_exp_f32 v255, v255
    s_nop 0
    v_cvt_pk_bf16_f32 v240, v240, v241
    v_cvt_pk_bf16_f32 v241, v242, v243
    v_cvt_pk_bf16_f32 v242, v244, v245
    v_cvt_pk_bf16_f32 v243, v246, v247
    v_cvt_pk_bf16_f32 v244, v248, v249
    v_cvt_pk_bf16_f32 v245, v250, v251
    v_cvt_pk_bf16_f32 v246, v252, v253
    v_cvt_pk_bf16_f32 v247, v254, v255
    s_nop 1
    v_mfma_f32_32x32x16_bf16 v[192:207], v[228:231], v[240:243], v[192:207]
    v_mfma_f32_32x32x16_bf16 v[192:207], v[232:235], v[244:247], v[192:207]
    s_nop 7
    s_nop 7
    s_nop 7
parallel_sum__sliding_block__glu_gated_bilinear__prompt_kernel_fb011:
    s_cmp_le_u32 s68, 0
    s_cbranch_scc1 parallel_sum__sliding_block__glu_gated_bilinear__prompt_kernel_fb012
    s_add_u32 s70, s61, 196608
    buffer_load_dwordx4 v[224:227], v26, s[20:23], s70 offen sc1
    buffer_load_dwordx4 v[228:231], v27, s[20:23], s70 offen sc1
    v_mov_b32 v232, 0x3f803f80
    v_mov_b32 v233, 0x3f803f80
    v_mov_b32 v234, 0x3f803f80
    v_mov_b32 v235, 0x3f803f80
    s_waitcnt vmcnt(0)
    v_mfma_f32_32x32x16_bf16 v[240:255], v[224:227], v[96:99], 0
    s_nop 7
    s_nop 7
    v_permlane16_swap_b32 v228, v232
    v_permlane16_swap_b32 v229, v233
    v_permlane16_swap_b32 v230, v234
    v_permlane16_swap_b32 v231, v235
    v_sub_f32 v240, v240, v236
    v_sub_f32 v241, v241, v236
    v_sub_f32 v242, v242, v236
    v_sub_f32 v243, v243, v236
    v_sub_f32 v244, v244, v236
    v_sub_f32 v245, v245, v236
    v_sub_f32 v246, v246, v236
    v_sub_f32 v247, v247, v236
    v_sub_f32 v248, v248, v236
    v_sub_f32 v249, v249, v236
    v_sub_f32 v250, v250, v236
    v_sub_f32 v251, v251, v236
    v_sub_f32 v252, v252, v236
    v_sub_f32 v253, v253, v236
    v_sub_f32 v254, v254, v236
    v_sub_f32 v255, v255, v236
    v_exp_f32 v240, v240
    v_exp_f32 v241, v241
    v_exp_f32 v242, v242
    v_exp_f32 v243, v243
    v_exp_f32 v244, v244
    v_exp_f32 v245, v245
    v_exp_f32 v246, v246
    v_exp_f32 v247, v247
    v_exp_f32 v248, v248
    v_exp_f32 v249, v249
    v_exp_f32 v250, v250
    v_exp_f32 v251, v251
    v_exp_f32 v252, v252
    v_exp_f32 v253, v253
    v_exp_f32 v254, v254
    v_exp_f32 v255, v255
    s_nop 0
    v_cvt_pk_bf16_f32 v240, v240, v241
    v_cvt_pk_bf16_f32 v241, v242, v243
    v_cvt_pk_bf16_f32 v242, v244, v245
    v_cvt_pk_bf16_f32 v243, v246, v247
    v_cvt_pk_bf16_f32 v244, v248, v249
    v_cvt_pk_bf16_f32 v245, v250, v251
    v_cvt_pk_bf16_f32 v246, v252, v253
    v_cvt_pk_bf16_f32 v247, v254, v255
    s_nop 1
    v_mfma_f32_32x32x16_bf16 v[192:207], v[228:231], v[240:243], v[192:207]
    v_mfma_f32_32x32x16_bf16 v[192:207], v[232:235], v[244:247], v[192:207]
    s_nop 7
    s_nop 7
    s_nop 7
parallel_sum__sliding_block__glu_gated_bilinear__prompt_kernel_fb012:
    s_cmp_le_u32 s68, 1
    s_cbranch_scc1 parallel_sum__sliding_block__glu_gated_bilinear__prompt_kernel_fb013
    s_add_u32 s70, s61, 163840
    buffer_load_dwordx4 v[224:227], v26, s[20:23], s70 offen sc1
    buffer_load_dwordx4 v[228:231], v27, s[20:23], s70 offen sc1
    v_mov_b32 v232, 0x3f803f80
    v_mov_b32 v233, 0x3f803f80
    v_mov_b32 v234, 0x3f803f80
    v_mov_b32 v235, 0x3f803f80
    s_waitcnt vmcnt(0)
    v_mfma_f32_32x32x16_bf16 v[240:255], v[224:227], v[96:99], 0
    s_nop 7
    s_nop 7
    v_permlane16_swap_b32 v228, v232
    v_permlane16_swap_b32 v229, v233
    v_permlane16_swap_b32 v230, v234
    v_permlane16_swap_b32 v231, v235
    v_sub_f32 v240, v240, v236
    v_sub_f32 v241, v241, v236
    v_sub_f32 v242, v242, v236
    v_sub_f32 v243, v243, v236
    v_sub_f32 v244, v244, v236
    v_sub_f32 v245, v245, v236
    v_sub_f32 v246, v246, v236
    v_sub_f32 v247, v247, v236
    v_sub_f32 v248, v248, v236
    v_sub_f32 v249, v249, v236
    v_sub_f32 v250, v250, v236
    v_sub_f32 v251, v251, v236
    v_sub_f32 v252, v252, v236
    v_sub_f32 v253, v253, v236
    v_sub_f32 v254, v254, v236
    v_sub_f32 v255, v255, v236
    v_exp_f32 v240, v240
    v_exp_f32 v241, v241
    v_exp_f32 v242, v242
    v_exp_f32 v243, v243
    v_exp_f32 v244, v244
    v_exp_f32 v245, v245
    v_exp_f32 v246, v246
    v_exp_f32 v247, v247
    v_exp_f32 v248, v248
    v_exp_f32 v249, v249
    v_exp_f32 v250, v250
    v_exp_f32 v251, v251
    v_exp_f32 v252, v252
    v_exp_f32 v253, v253
    v_exp_f32 v254, v254
    v_exp_f32 v255, v255
    s_nop 0
    v_cvt_pk_bf16_f32 v240, v240, v241
    v_cvt_pk_bf16_f32 v241, v242, v243
    v_cvt_pk_bf16_f32 v242, v244, v245
    v_cvt_pk_bf16_f32 v243, v246, v247
    v_cvt_pk_bf16_f32 v244, v248, v249
    v_cvt_pk_bf16_f32 v245, v250, v251
    v_cvt_pk_bf16_f32 v246, v252, v253
    v_cvt_pk_bf16_f32 v247, v254, v255
    s_nop 1
    v_mfma_f32_32x32x16_bf16 v[192:207], v[228:231], v[240:243], v[192:207]
    v_mfma_f32_32x32x16_bf16 v[192:207], v[232:235], v[244:247], v[192:207]
    s_nop 7
    s_nop 7
    s_nop 7
parallel_sum__sliding_block__glu_gated_bilinear__prompt_kernel_fb013:
    s_cmp_le_u32 s68, 1
    s_cbranch_scc1 parallel_sum__sliding_block__glu_gated_bilinear__prompt_kernel_fb014
    s_add_u32 s70, s61, 131072
    buffer_load_dwordx4 v[224:227], v26, s[20:23], s70 offen sc1
    buffer_load_dwordx4 v[228:231], v27, s[20:23], s70 offen sc1
    v_mov_b32 v232, 0x3f803f80
    v_mov_b32 v233, 0x3f803f80
    v_mov_b32 v234, 0x3f803f80
    v_mov_b32 v235, 0x3f803f80
    s_waitcnt vmcnt(0)
    v_mfma_f32_32x32x16_bf16 v[240:255], v[224:227], v[96:99], 0
    s_nop 7
    s_nop 7
    v_permlane16_swap_b32 v228, v232
    v_permlane16_swap_b32 v229, v233
    v_permlane16_swap_b32 v230, v234
    v_permlane16_swap_b32 v231, v235
    v_sub_f32 v240, v240, v236
    v_sub_f32 v241, v241, v236
    v_sub_f32 v242, v242, v236
    v_sub_f32 v243, v243, v236
    v_sub_f32 v244, v244, v236
    v_sub_f32 v245, v245, v236
    v_sub_f32 v246, v246, v236
    v_sub_f32 v247, v247, v236
    v_sub_f32 v248, v248, v236
    v_sub_f32 v249, v249, v236
    v_sub_f32 v250, v250, v236
    v_sub_f32 v251, v251, v236
    v_sub_f32 v252, v252, v236
    v_sub_f32 v253, v253, v236
    v_sub_f32 v254, v254, v236
    v_sub_f32 v255, v255, v236
    v_exp_f32 v240, v240
    v_exp_f32 v241, v241
    v_exp_f32 v242, v242
    v_exp_f32 v243, v243
    v_exp_f32 v244, v244
    v_exp_f32 v245, v245
    v_exp_f32 v246, v246
    v_exp_f32 v247, v247
    v_exp_f32 v248, v248
    v_exp_f32 v249, v249
    v_exp_f32 v250, v250
    v_exp_f32 v251, v251
    v_exp_f32 v252, v252
    v_exp_f32 v253, v253
    v_exp_f32 v254, v254
    v_exp_f32 v255, v255
    s_nop 0
    v_cvt_pk_bf16_f32 v240, v240, v241
    v_cvt_pk_bf16_f32 v241, v242, v243
    v_cvt_pk_bf16_f32 v242, v244, v245
    v_cvt_pk_bf16_f32 v243, v246, v247
    v_cvt_pk_bf16_f32 v244, v248, v249
    v_cvt_pk_bf16_f32 v245, v250, v251
    v_cvt_pk_bf16_f32 v246, v252, v253
    v_cvt_pk_bf16_f32 v247, v254, v255
    s_nop 1
    v_mfma_f32_32x32x16_bf16 v[192:207], v[228:231], v[240:243], v[192:207]
    v_mfma_f32_32x32x16_bf16 v[192:207], v[232:235], v[244:247], v[192:207]
    s_nop 7
    s_nop 7
    s_nop 7
parallel_sum__sliding_block__glu_gated_bilinear__prompt_kernel_fb014:
    s_cmp_le_u32 s68, 2
    s_cbranch_scc1 parallel_sum__sliding_block__glu_gated_bilinear__prompt_kernel_fb015
    s_add_u32 s70, s61, 98304
    buffer_load_dwordx4 v[224:227], v26, s[20:23], s70 offen sc1
    buffer_load_dwordx4 v[228:231], v27, s[20:23], s70 offen sc1
    v_mov_b32 v232, 0x3f803f80
    v_mov_b32 v233, 0x3f803f80
    v_mov_b32 v234, 0x3f803f80
    v_mov_b32 v235, 0x3f803f80
    s_waitcnt vmcnt(0)
    v_mfma_f32_32x32x16_bf16 v[240:255], v[224:227], v[96:99], 0
    s_nop 7
    s_nop 7
    v_permlane16_swap_b32 v228, v232
    v_permlane16_swap_b32 v229, v233
    v_permlane16_swap_b32 v230, v234
    v_permlane16_swap_b32 v231, v235
    v_sub_f32 v240, v240, v236
    v_sub_f32 v241, v241, v236
    v_sub_f32 v242, v242, v236
    v_sub_f32 v243, v243, v236
    v_sub_f32 v244, v244, v236
    v_sub_f32 v245, v245, v236
    v_sub_f32 v246, v246, v236
    v_sub_f32 v247, v247, v236
    v_sub_f32 v248, v248, v236
    v_sub_f32 v249, v249, v236
    v_sub_f32 v250, v250, v236
    v_sub_f32 v251, v251, v236
    v_sub_f32 v252, v252, v236
    v_sub_f32 v253, v253, v236
    v_sub_f32 v254, v254, v236
    v_sub_f32 v255, v255, v236
    v_exp_f32 v240, v240
    v_exp_f32 v241, v241
    v_exp_f32 v242, v242
    v_exp_f32 v243, v243
    v_exp_f32 v244, v244
    v_exp_f32 v245, v245
    v_exp_f32 v246, v246
    v_exp_f32 v247, v247
    v_exp_f32 v248, v248
    v_exp_f32 v249, v249
    v_exp_f32 v250, v250
    v_exp_f32 v251, v251
    v_exp_f32 v252, v252
    v_exp_f32 v253, v253
    v_exp_f32 v254, v254
    v_exp_f32 v255, v255
    s_nop 0
    v_cvt_pk_bf16_f32 v240, v240, v241
    v_cvt_pk_bf16_f32 v241, v242, v243
    v_cvt_pk_bf16_f32 v242, v244, v245
    v_cvt_pk_bf16_f32 v243, v246, v247
    v_cvt_pk_bf16_f32 v244, v248, v249
    v_cvt_pk_bf16_f32 v245, v250, v251
    v_cvt_pk_bf16_f32 v246, v252, v253
    v_cvt_pk_bf16_f32 v247, v254, v255
    s_nop 1
    v_mfma_f32_32x32x16_bf16 v[192:207], v[228:231], v[240:243], v[192:207]
    v_mfma_f32_32x32x16_bf16 v[192:207], v[232:235], v[244:247], v[192:207]
    s_nop 7
    s_nop 7
    s_nop 7
parallel_sum__sliding_block__glu_gated_bilinear__prompt_kernel_fb015:
    s_cmp_le_u32 s68, 2
    s_cbranch_scc1 parallel_sum__sliding_block__glu_gated_bilinear__prompt_kernel_fb016
    s_add_u32 s70, s61, 65536
    buffer_load_dwordx4 v[224:227], v26, s[20:23], s70 offen sc1
    buffer_load_dwordx4 v[228:231], v27, s[20:23], s70 offen sc1
    v_mov_b32 v232, 0x3f803f80
    v_mov_b32 v233, 0x3f803f80
    v_mov_b32 v234, 0x3f803f80
    v_mov_b32 v235, 0x3f803f80
    s_waitcnt vmcnt(0)
    v_mfma_f32_32x32x16_bf16 v[240:255], v[224:227], v[96:99], 0
    s_nop 7
    s_nop 7
    v_permlane16_swap_b32 v228, v232
    v_permlane16_swap_b32 v229, v233
    v_permlane16_swap_b32 v230, v234
    v_permlane16_swap_b32 v231, v235
    v_sub_f32 v240, v240, v236
    v_sub_f32 v241, v241, v236
    v_sub_f32 v242, v242, v236
    v_sub_f32 v243, v243, v236
    v_sub_f32 v244, v244, v236
    v_sub_f32 v245, v245, v236
    v_sub_f32 v246, v246, v236
    v_sub_f32 v247, v247, v236
    v_sub_f32 v248, v248, v236
    v_sub_f32 v249, v249, v236
    v_sub_f32 v250, v250, v236
    v_sub_f32 v251, v251, v236
    v_sub_f32 v252, v252, v236
    v_sub_f32 v253, v253, v236
    v_sub_f32 v254, v254, v236
    v_sub_f32 v255, v255, v236
    v_exp_f32 v240, v240
    v_exp_f32 v241, v241
    v_exp_f32 v242, v242
    v_exp_f32 v243, v243
    v_exp_f32 v244, v244
    v_exp_f32 v245, v245
    v_exp_f32 v246, v246
    v_exp_f32 v247, v247
    v_exp_f32 v248, v248
    v_exp_f32 v249, v249
    v_exp_f32 v250, v250
    v_exp_f32 v251, v251
    v_exp_f32 v252, v252
    v_exp_f32 v253, v253
    v_exp_f32 v254, v254
    v_exp_f32 v255, v255
    s_nop 0
    v_cvt_pk_bf16_f32 v240, v240, v241
    v_cvt_pk_bf16_f32 v241, v242, v243
    v_cvt_pk_bf16_f32 v242, v244, v245
    v_cvt_pk_bf16_f32 v243, v246, v247
    v_cvt_pk_bf16_f32 v244, v248, v249
    v_cvt_pk_bf16_f32 v245, v250, v251
    v_cvt_pk_bf16_f32 v246, v252, v253
    v_cvt_pk_bf16_f32 v247, v254, v255
    s_nop 1
    v_mfma_f32_32x32x16_bf16 v[192:207], v[228:231], v[240:243], v[192:207]
    v_mfma_f32_32x32x16_bf16 v[192:207], v[232:235], v[244:247], v[192:207]
    s_nop 7
    s_nop 7
    s_nop 7
parallel_sum__sliding_block__glu_gated_bilinear__prompt_kernel_fb016:
    s_cmp_le_u32 s68, 3
    s_cbranch_scc1 parallel_sum__sliding_block__glu_gated_bilinear__prompt_kernel_fb017
    s_add_u32 s70, s61, 32768
    buffer_load_dwordx4 v[224:227], v26, s[20:23], s70 offen sc1
    buffer_load_dwordx4 v[228:231], v27, s[20:23], s70 offen sc1
    v_mov_b32 v232, 0x3f803f80
    v_mov_b32 v233, 0x3f803f80
    v_mov_b32 v234, 0x3f803f80
    v_mov_b32 v235, 0x3f803f80
    s_waitcnt vmcnt(0)
    v_mfma_f32_32x32x16_bf16 v[240:255], v[224:227], v[96:99], 0
    s_nop 7
    s_nop 7
    v_permlane16_swap_b32 v228, v232
    v_permlane16_swap_b32 v229, v233
    v_permlane16_swap_b32 v230, v234
    v_permlane16_swap_b32 v231, v235
    v_sub_f32 v240, v240, v236
    v_sub_f32 v241, v241, v236
    v_sub_f32 v242, v242, v236
    v_sub_f32 v243, v243, v236
    v_sub_f32 v244, v244, v236
    v_sub_f32 v245, v245, v236
    v_sub_f32 v246, v246, v236
    v_sub_f32 v247, v247, v236
    v_sub_f32 v248, v248, v236
    v_sub_f32 v249, v249, v236
    v_sub_f32 v250, v250, v236
    v_sub_f32 v251, v251, v236
    v_sub_f32 v252, v252, v236
    v_sub_f32 v253, v253, v236
    v_sub_f32 v254, v254, v236
    v_sub_f32 v255, v255, v236
    v_exp_f32 v240, v240
    v_exp_f32 v241, v241
    v_exp_f32 v242, v242
    v_exp_f32 v243, v243
    v_exp_f32 v244, v244
    v_exp_f32 v245, v245
    v_exp_f32 v246, v246
    v_exp_f32 v247, v247
    v_exp_f32 v248, v248
    v_exp_f32 v249, v249
    v_exp_f32 v250, v250
    v_exp_f32 v251, v251
    v_exp_f32 v252, v252
    v_exp_f32 v253, v253
    v_exp_f32 v254, v254
    v_exp_f32 v255, v255
    s_nop 0
    v_cvt_pk_bf16_f32 v240, v240, v241
    v_cvt_pk_bf16_f32 v241, v242, v243
    v_cvt_pk_bf16_f32 v242, v244, v245
    v_cvt_pk_bf16_f32 v243, v246, v247
    v_cvt_pk_bf16_f32 v244, v248, v249
    v_cvt_pk_bf16_f32 v245, v250, v251
    v_cvt_pk_bf16_f32 v246, v252, v253
    v_cvt_pk_bf16_f32 v247, v254, v255
    s_nop 1
    v_mfma_f32_32x32x16_bf16 v[192:207], v[228:231], v[240:243], v[192:207]
    v_mfma_f32_32x32x16_bf16 v[192:207], v[232:235], v[244:247], v[192:207]
    s_nop 7
    s_nop 7
    s_nop 7
parallel_sum__sliding_block__glu_gated_bilinear__prompt_kernel_fb017:
    s_cmp_le_u32 s68, 3
    s_cbranch_scc1 parallel_sum__sliding_block__glu_gated_bilinear__prompt_kernel_fb018
    s_add_u32 s70, s61, 0
    buffer_load_dwordx4 v[224:227], v26, s[20:23], s70 offen sc1
    buffer_load_dwordx4 v[228:231], v27, s[20:23], s70 offen sc1
    v_mov_b32 v232, 0x3f803f80
    v_mov_b32 v233, 0x3f803f80
    v_mov_b32 v234, 0x3f803f80
    v_mov_b32 v235, 0x3f803f80
    v_cmp_le_i32 vcc, 0, v237
    s_nop 1
    v_cndmask_b32 v240, 0, v238, vcc
    v_cmp_le_i32 vcc, 1, v237
    s_nop 1
    v_cndmask_b32 v241, 0, v238, vcc
    v_cmp_le_i32 vcc, 2, v237
    s_nop 1
    v_cndmask_b32 v242, 0, v238, vcc
    v_cmp_le_i32 vcc, 3, v237
    s_nop 1
    v_cndmask_b32 v243, 0, v238, vcc
    v_cmp_le_i32 vcc, 8, v237
    s_nop 1
    v_cndmask_b32 v244, 0, v238, vcc
    v_cmp_le_i32 vcc, 9, v237
    s_nop 1
    v_cndmask_b32 v245, 0, v238, vcc
    v_cmp_le_i32 vcc, 10, v237
    s_nop 1
    v_cndmask_b32 v246, 0, v238, vcc
    v_cmp_le_i32 vcc, 11, v237
    s_nop 1
    v_cndmask_b32 v247, 0, v238, vcc
    v_cmp_le_i32 vcc, 16, v237
    s_nop 1
    v_cndmask_b32 v248, 0, v238, vcc
    v_cmp_le_i32 vcc, 17, v237
    s_nop 1
    v_cndmask_b32 v249, 0, v238, vcc
    v_cmp_le_i32 vcc, 18, v237
    s_nop 1
    v_cndmask_b32 v250, 0, v238, vcc
    v_cmp_le_i32 vcc, 19, v237
    s_nop 1
    v_cndmask_b32 v251, 0, v238, vcc
    v_cmp_le_i32 vcc, 24, v237
    s_nop 1
    v_cndmask_b32 v252, 0, v238, vcc
    v_cmp_le_i32 vcc, 25, v237
    s_nop 1
    v_cndmask_b32 v253, 0, v238, vcc
    v_cmp_le_i32 vcc, 26, v237
    s_nop 1
    v_cndmask_b32 v254, 0, v238, vcc
    v_cmp_le_i32 vcc, 27, v237
    s_nop 1
    v_cndmask_b32 v255, 0, v238, vcc
    s_waitcnt vmcnt(0)
    s_nop 0
    v_mfma_f32_32x32x16_bf16 v[240:255], v[224:227], v[96:99], v[240:255]
    s_nop 7
    s_nop 7
    v_permlane16_swap_b32 v228, v232
    v_permlane16_swap_b32 v229, v233
    v_permlane16_swap_b32 v230, v234
    v_permlane16_swap_b32 v231, v235
    v_sub_f32 v240, v240, v236
    v_sub_f32 v241, v241, v236
    v_sub_f32 v242, v242, v236
    v_sub_f32 v243, v243, v236
    v_sub_f32 v244, v244, v236
    v_sub_f32 v245, v245, v236
    v_sub_f32 v246, v246, v236
    v_sub_f32 v247, v247, v236
    v_sub_f32 v248, v248, v236
    v_sub_f32 v249, v249, v236
    v_sub_f32 v250, v250, v236
    v_sub_f32 v251, v251, v236
    v_sub_f32 v252, v252, v236
    v_sub_f32 v253, v253, v236
    v_sub_f32 v254, v254, v236
    v_sub_f32 v255, v255, v236
    v_exp_f32 v240, v240
    v_exp_f32 v241, v241
    v_exp_f32 v242, v242
    v_exp_f32 v243, v243
    v_exp_f32 v244, v244
    v_exp_f32 v245, v245
    v_exp_f32 v246, v246
    v_exp_f32 v247, v247
    v_exp_f32 v248, v248
    v_exp_f32 v249, v249
    v_exp_f32 v250, v250
    v_exp_f32 v251, v251
    v_exp_f32 v252, v252
    v_exp_f32 v253, v253
    v_exp_f32 v254, v254
    v_exp_f32 v255, v255
    s_nop 0
    v_cvt_pk_bf16_f32 v240, v240, v241
    v_cvt_pk_bf16_f32 v241, v242, v243
    v_cvt_pk_bf16_f32 v242, v244, v245
    v_cvt_pk_bf16_f32 v243, v246, v247
    v_cvt_pk_bf16_f32 v244, v248, v249
    v_cvt_pk_bf16_f32 v245, v250, v251
    v_cvt_pk_bf16_f32 v246, v252, v253
    v_cvt_pk_bf16_f32 v247, v254, v255
    s_nop 1
    v_mfma_f32_32x32x16_bf16 v[192:207], v[228:231], v[240:243], v[192:207]
    v_mfma_f32_32x32x16_bf16 v[192:207], v[232:235], v[244:247], v[192:207]
    s_nop 7
    s_nop 7
    s_nop 7
parallel_sum__sliding_block__glu_gated_bilinear__prompt_kernel_fb018:
    v_mov_b32 v236, 0xf149f2ca
    s_add_u32 s70, s61, 294912
    buffer_load_dwordx4 v[224:227], v26, s[20:23], s70 offen sc1
    v_cmp_le_i32 vcc, 0, v237
    s_nop 1
    v_cndmask_b32 v240, v238, 0, vcc
    v_cmp_le_i32 vcc, 1, v237
    s_nop 1
    v_cndmask_b32 v241, v238, 0, vcc
    v_cmp_le_i32 vcc, 2, v237
    s_nop 1
    v_cndmask_b32 v242, v238, 0, vcc
    v_cmp_le_i32 vcc, 3, v237
    s_nop 1
    v_cndmask_b32 v243, v238, 0, vcc
    v_cmp_le_i32 vcc, 8, v237
    s_nop 1
    v_cndmask_b32 v244, v238, 0, vcc
    v_cmp_le_i32 vcc, 9, v237
    s_nop 1
    v_cndmask_b32 v245, v238, 0, vcc
    v_cmp_le_i32 vcc, 10, v237
    s_nop 1
    v_cndmask_b32 v246, v238, 0, vcc
    v_cmp_le_i32 vcc, 11, v237
    s_nop 1
    v_cndmask_b32 v247, v238, 0, vcc
    v_cmp_le_i32 vcc, 16, v237
    s_nop 1
    v_cndmask_b32 v248, v238, 0, vcc
    v_cmp_le_i32 vcc, 17, v237
    s_nop 1
    v_cndmask_b32 v249, v238, 0, vcc
    v_cmp_le_i32 vcc, 18, v237
    s_nop 1
    v_cndmask_b32 v250, v238, 0, vcc
    v_cmp_le_i32 vcc, 19, v237
    s_nop 1
    v_cndmask_b32 v251, v238, 0, vcc
    v_cmp_le_i32 vcc, 24, v237
    s_nop 1
    v_cndmask_b32 v252, v238, 0, vcc
    v_cmp_le_i32 vcc, 25, v237
    s_nop 1
    v_cndmask_b32 v253, v238, 0, vcc
    v_cmp_le_i32 vcc, 26, v237
    s_nop 1
    v_cndmask_b32 v254, v238, 0, vcc
    v_cmp_le_i32 vcc, 27, v237
    s_nop 1
    v_cndmask_b32 v255, v238, 0, vcc
    s_waitcnt vmcnt(0)
    s_nop 0
    v_mfma_f32_32x32x16_bf16 v[240:255], v[224:227], v[100:103], v[240:255]
    s_nop 7
    s_nop 7
    v_max3_f32 v236, v236, v240, v241
    v_max3_f32 v236, v236, v242, v243
    v_max3_f32 v236, v236, v244, v245
    v_max3_f32 v236, v236, v246, v247
    v_max3_f32 v236, v236, v248, v249
    v_max3_f32 v236, v236, v250, v251
    v_max3_f32 v236, v236, v252, v253
    v_max3_f32 v236, v236, v254, v255
parallel_sum__sliding_block__glu_gated_bilinear__prompt_kernel_fb100:
    s_add_u32 s70, s61, 262144
    buffer_load_dwordx4 v[224:227], v26, s[20:23], s70 offen sc1
    s_waitcnt vmcnt(0)
    v_mfma_f32_32x32x16_bf16 v[240:255], v[224:227], v[100:103], 0
    s_nop 7
    s_nop 7
    v_max3_f32 v236, v236, v240, v241
    v_max3_f32 v236, v236, v242, v243
    v_max3_f32 v236, v236, v244, v245
    v_max3_f32 v236, v236, v246, v247
    v_max3_f32 v236, v236, v248, v249
    v_max3_f32 v236, v236, v250, v251
    v_max3_f32 v236, v236, v252, v253
    v_max3_f32 v236, v236, v254, v255
parallel_sum__sliding_block__glu_gated_bilinear__prompt_kernel_fb101:
    s_cmp_le_u32 s68, 0
    s_cbranch_scc1 parallel_sum__sliding_block__glu_gated_bilinear__prompt_kernel_fb102
    s_add_u32 s70, s61, 229376
    buffer_load_dwordx4 v[224:227], v26, s[20:23], s70 offen sc1
    s_waitcnt vmcnt(0)
    v_mfma_f32_32x32x16_bf16 v[240:255], v[224:227], v[100:103], 0
    s_nop 7
    s_nop 7
    v_max3_f32 v236, v236, v240, v241
    v_max3_f32 v236, v236, v242, v243
    v_max3_f32 v236, v236, v244, v245
    v_max3_f32 v236, v236, v246, v247
    v_max3_f32 v236, v236, v248, v249
    v_max3_f32 v236, v236, v250, v251
    v_max3_f32 v236, v236, v252, v253
    v_max3_f32 v236, v236, v254, v255
parallel_sum__sliding_block__glu_gated_bilinear__prompt_kernel_fb102:
    s_cmp_le_u32 s68, 0
    s_cbranch_scc1 parallel_sum__sliding_block__glu_gated_bilinear__prompt_kernel_fb103
    s_add_u32 s70, s61, 196608
    buffer_load_dwordx4 v[224:227], v26, s[20:23], s70 offen sc1
    s_waitcnt vmcnt(0)
    v_mfma_f32_32x32x16_bf16 v[240:255], v[224:227], v[100:103], 0
    s_nop 7
    s_nop 7
    v_max3_f32 v236, v236, v240, v241
    v_max3_f32 v236, v236, v242, v243
    v_max3_f32 v236, v236, v244, v245
    v_max3_f32 v236, v236, v246, v247
    v_max3_f32 v236, v236, v248, v249
    v_max3_f32 v236, v236, v250, v251
    v_max3_f32 v236, v236, v252, v253
    v_max3_f32 v236, v236, v254, v255
parallel_sum__sliding_block__glu_gated_bilinear__prompt_kernel_fb103:
    s_cmp_le_u32 s68, 1
    s_cbranch_scc1 parallel_sum__sliding_block__glu_gated_bilinear__prompt_kernel_fb104
    s_add_u32 s70, s61, 163840
    buffer_load_dwordx4 v[224:227], v26, s[20:23], s70 offen sc1
    s_waitcnt vmcnt(0)
    v_mfma_f32_32x32x16_bf16 v[240:255], v[224:227], v[100:103], 0
    s_nop 7
    s_nop 7
    v_max3_f32 v236, v236, v240, v241
    v_max3_f32 v236, v236, v242, v243
    v_max3_f32 v236, v236, v244, v245
    v_max3_f32 v236, v236, v246, v247
    v_max3_f32 v236, v236, v248, v249
    v_max3_f32 v236, v236, v250, v251
    v_max3_f32 v236, v236, v252, v253
    v_max3_f32 v236, v236, v254, v255
parallel_sum__sliding_block__glu_gated_bilinear__prompt_kernel_fb104:
    s_cmp_le_u32 s68, 1
    s_cbranch_scc1 parallel_sum__sliding_block__glu_gated_bilinear__prompt_kernel_fb105
    s_add_u32 s70, s61, 131072
    buffer_load_dwordx4 v[224:227], v26, s[20:23], s70 offen sc1
    s_waitcnt vmcnt(0)
    v_mfma_f32_32x32x16_bf16 v[240:255], v[224:227], v[100:103], 0
    s_nop 7
    s_nop 7
    v_max3_f32 v236, v236, v240, v241
    v_max3_f32 v236, v236, v242, v243
    v_max3_f32 v236, v236, v244, v245
    v_max3_f32 v236, v236, v246, v247
    v_max3_f32 v236, v236, v248, v249
    v_max3_f32 v236, v236, v250, v251
    v_max3_f32 v236, v236, v252, v253
    v_max3_f32 v236, v236, v254, v255
parallel_sum__sliding_block__glu_gated_bilinear__prompt_kernel_fb105:
    s_cmp_le_u32 s68, 2
    s_cbranch_scc1 parallel_sum__sliding_block__glu_gated_bilinear__prompt_kernel_fb106
    s_add_u32 s70, s61, 98304
    buffer_load_dwordx4 v[224:227], v26, s[20:23], s70 offen sc1
    s_waitcnt vmcnt(0)
    v_mfma_f32_32x32x16_bf16 v[240:255], v[224:227], v[100:103], 0
    s_nop 7
    s_nop 7
    v_max3_f32 v236, v236, v240, v241
    v_max3_f32 v236, v236, v242, v243
    v_max3_f32 v236, v236, v244, v245
    v_max3_f32 v236, v236, v246, v247
    v_max3_f32 v236, v236, v248, v249
    v_max3_f32 v236, v236, v250, v251
    v_max3_f32 v236, v236, v252, v253
    v_max3_f32 v236, v236, v254, v255
parallel_sum__sliding_block__glu_gated_bilinear__prompt_kernel_fb106:
    s_cmp_le_u32 s68, 2
    s_cbranch_scc1 parallel_sum__sliding_block__glu_gated_bilinear__prompt_kernel_fb107
    s_add_u32 s70, s61, 65536
    buffer_load_dwordx4 v[224:227], v26, s[20:23], s70 offen sc1
    s_waitcnt vmcnt(0)
    v_mfma_f32_32x32x16_bf16 v[240:255], v[224:227], v[100:103], 0
    s_nop 7
    s_nop 7
    v_max3_f32 v236, v236, v240, v241
    v_max3_f32 v236, v236, v242, v243
    v_max3_f32 v236, v236, v244, v245
    v_max3_f32 v236, v236, v246, v247
    v_max3_f32 v236, v236, v248, v249
    v_max3_f32 v236, v236, v250, v251
    v_max3_f32 v236, v236, v252, v253
    v_max3_f32 v236, v236, v254, v255
parallel_sum__sliding_block__glu_gated_bilinear__prompt_kernel_fb107:
    s_cmp_le_u32 s68, 3
    s_cbranch_scc1 parallel_sum__sliding_block__glu_gated_bilinear__prompt_kernel_fb108
    s_add_u32 s70, s61, 32768
    buffer_load_dwordx4 v[224:227], v26, s[20:23], s70 offen sc1
    v_cmp_le_i32 vcc, 0, v237
    s_nop 1
    v_cndmask_b32 v240, 0, v238, vcc
    v_cmp_le_i32 vcc, 1, v237
    s_nop 1
    v_cndmask_b32 v241, 0, v238, vcc
    v_cmp_le_i32 vcc, 2, v237
    s_nop 1
    v_cndmask_b32 v242, 0, v238, vcc
    v_cmp_le_i32 vcc, 3, v237
    s_nop 1
    v_cndmask_b32 v243, 0, v238, vcc
    v_cmp_le_i32 vcc, 8, v237
    s_nop 1
    v_cndmask_b32 v244, 0, v238, vcc
    v_cmp_le_i32 vcc, 9, v237
    s_nop 1
    v_cndmask_b32 v245, 0, v238, vcc
    v_cmp_le_i32 vcc, 10, v237
    s_nop 1
    v_cndmask_b32 v246, 0, v238, vcc
    v_cmp_le_i32 vcc, 11, v237
    s_nop 1
    v_cndmask_b32 v247, 0, v238, vcc
    v_cmp_le_i32 vcc, 16, v237
    s_nop 1
    v_cndmask_b32 v248, 0, v238, vcc
    v_cmp_le_i32 vcc, 17, v237
    s_nop 1
    v_cndmask_b32 v249, 0, v238, vcc
    v_cmp_le_i32 vcc, 18, v237
    s_nop 1
    v_cndmask_b32 v250, 0, v238, vcc
    v_cmp_le_i32 vcc, 19, v237
    s_nop 1
    v_cndmask_b32 v251, 0, v238, vcc
    v_cmp_le_i32 vcc, 24, v237
    s_nop 1
    v_cndmask_b32 v252, 0, v238, vcc
    v_cmp_le_i32 vcc, 25, v237
    s_nop 1
    v_cndmask_b32 v253, 0, v238, vcc
    v_cmp_le_i32 vcc, 26, v237
    s_nop 1
    v_cndmask_b32 v254, 0, v238, vcc
    v_cmp_le_i32 vcc, 27, v237
    s_nop 1
    v_cndmask_b32 v255, 0, v238, vcc
    s_waitcnt vmcnt(0)
    s_nop 0
    v_mfma_f32_32x32x16_bf16 v[240:255], v[224:227], v[100:103], v[240:255]
    s_nop 7
    s_nop 7
    v_max3_f32 v236, v236, v240, v241
    v_max3_f32 v236, v236, v242, v243
    v_max3_f32 v236, v236, v244, v245
    v_max3_f32 v236, v236, v246, v247
    v_max3_f32 v236, v236, v248, v249
    v_max3_f32 v236, v236, v250, v251
    v_max3_f32 v236, v236, v252, v253
    v_max3_f32 v236, v236, v254, v255
parallel_sum__sliding_block__glu_gated_bilinear__prompt_kernel_fb108:
    v_mov_b32 v22, v236
    s_nop 1
    v_permlane32_swap_b32 v236, v22
    v_max_f32 v236, v236, v22
    s_add_u32 s70, s61, 294912
    buffer_load_dwordx4 v[224:227], v26, s[20:23], s70 offen sc1
    buffer_load_dwordx4 v[228:231], v27, s[20:23], s70 offen sc1
    v_mov_b32 v232, 0x3f803f80
    v_mov_b32 v233, 0x3f803f80
    v_mov_b32 v234, 0x3f803f80
    v_mov_b32 v235, 0x3f803f80
    v_cmp_le_i32 vcc, 0, v237
    s_nop 1
    v_cndmask_b32 v240, v238, 0, vcc
    v_cmp_le_i32 vcc, 1, v237
    s_nop 1
    v_cndmask_b32 v241, v238, 0, vcc
    v_cmp_le_i32 vcc, 2, v237
    s_nop 1
    v_cndmask_b32 v242, v238, 0, vcc
    v_cmp_le_i32 vcc, 3, v237
    s_nop 1
    v_cndmask_b32 v243, v238, 0, vcc
    v_cmp_le_i32 vcc, 8, v237
    s_nop 1
    v_cndmask_b32 v244, v238, 0, vcc
    v_cmp_le_i32 vcc, 9, v237
    s_nop 1
    v_cndmask_b32 v245, v238, 0, vcc
    v_cmp_le_i32 vcc, 10, v237
    s_nop 1
    v_cndmask_b32 v246, v238, 0, vcc
    v_cmp_le_i32 vcc, 11, v237
    s_nop 1
    v_cndmask_b32 v247, v238, 0, vcc
    v_cmp_le_i32 vcc, 16, v237
    s_nop 1
    v_cndmask_b32 v248, v238, 0, vcc
    v_cmp_le_i32 vcc, 17, v237
    s_nop 1
    v_cndmask_b32 v249, v238, 0, vcc
    v_cmp_le_i32 vcc, 18, v237
    s_nop 1
    v_cndmask_b32 v250, v238, 0, vcc
    v_cmp_le_i32 vcc, 19, v237
    s_nop 1
    v_cndmask_b32 v251, v238, 0, vcc
    v_cmp_le_i32 vcc, 24, v237
    s_nop 1
    v_cndmask_b32 v252, v238, 0, vcc
    v_cmp_le_i32 vcc, 25, v237
    s_nop 1
    v_cndmask_b32 v253, v238, 0, vcc
    v_cmp_le_i32 vcc, 26, v237
    s_nop 1
    v_cndmask_b32 v254, v238, 0, vcc
    v_cmp_le_i32 vcc, 27, v237
    s_nop 1
    v_cndmask_b32 v255, v238, 0, vcc
    s_waitcnt vmcnt(0)
    s_nop 0
    v_mfma_f32_32x32x16_bf16 v[240:255], v[224:227], v[100:103], v[240:255]
    s_nop 7
    s_nop 7
    v_permlane16_swap_b32 v228, v232
    v_permlane16_swap_b32 v229, v233
    v_permlane16_swap_b32 v230, v234
    v_permlane16_swap_b32 v231, v235
    v_sub_f32 v240, v240, v236
    v_sub_f32 v241, v241, v236
    v_sub_f32 v242, v242, v236
    v_sub_f32 v243, v243, v236
    v_sub_f32 v244, v244, v236
    v_sub_f32 v245, v245, v236
    v_sub_f32 v246, v246, v236
    v_sub_f32 v247, v247, v236
    v_sub_f32 v248, v248, v236
    v_sub_f32 v249, v249, v236
    v_sub_f32 v250, v250, v236
    v_sub_f32 v251, v251, v236
    v_sub_f32 v252, v252, v236
    v_sub_f32 v253, v253, v236
    v_sub_f32 v254, v254, v236
    v_sub_f32 v255, v255, v236
    v_exp_f32 v240, v240
    v_exp_f32 v241, v241
    v_exp_f32 v242, v242
    v_exp_f32 v243, v243
    v_exp_f32 v244, v244
    v_exp_f32 v245, v245
    v_exp_f32 v246, v246
    v_exp_f32 v247, v247
    v_exp_f32 v248, v248
    v_exp_f32 v249, v249
    v_exp_f32 v250, v250
    v_exp_f32 v251, v251
    v_exp_f32 v252, v252
    v_exp_f32 v253, v253
    v_exp_f32 v254, v254
    v_exp_f32 v255, v255
    s_nop 0
    v_cvt_pk_bf16_f32 v240, v240, v241
    v_cvt_pk_bf16_f32 v241, v242, v243
    v_cvt_pk_bf16_f32 v242, v244, v245
    v_cvt_pk_bf16_f32 v243, v246, v247
    v_cvt_pk_bf16_f32 v244, v248, v249
    v_cvt_pk_bf16_f32 v245, v250, v251
    v_cvt_pk_bf16_f32 v246, v252, v253
    v_cvt_pk_bf16_f32 v247, v254, v255
    s_nop 1
    v_mfma_f32_32x32x16_bf16 v[208:223], v[228:231], v[240:243], 0
    v_mfma_f32_32x32x16_bf16 v[208:223], v[232:235], v[244:247], v[208:223]
    s_nop 7
    s_nop 7
    s_nop 7
parallel_sum__sliding_block__glu_gated_bilinear__prompt_kernel_fb110:
    s_add_u32 s70, s61, 262144
    buffer_load_dwordx4 v[224:227], v26, s[20:23], s70 offen sc1
    buffer_load_dwordx4 v[228:231], v27, s[20:23], s70 offen sc1
    v_mov_b32 v232, 0x3f803f80
    v_mov_b32 v233, 0x3f803f80
    v_mov_b32 v234, 0x3f803f80
    v_mov_b32 v235, 0x3f803f80
    s_waitcnt vmcnt(0)
    v_mfma_f32_32x32x16_bf16 v[240:255], v[224:227], v[100:103], 0
    s_nop 7
    s_nop 7
    v_permlane16_swap_b32 v228, v232
    v_permlane16_swap_b32 v229, v233
    v_permlane16_swap_b32 v230, v234
    v_permlane16_swap_b32 v231, v235
    v_sub_f32 v240, v240, v236
    v_sub_f32 v241, v241, v236
    v_sub_f32 v242, v242, v236
    v_sub_f32 v243, v243, v236
    v_sub_f32 v244, v244, v236
    v_sub_f32 v245, v245, v236
    v_sub_f32 v246, v246, v236
    v_sub_f32 v247, v247, v236
    v_sub_f32 v248, v248, v236
    v_sub_f32 v249, v249, v236
    v_sub_f32 v250, v250, v236
    v_sub_f32 v251, v251, v236
    v_sub_f32 v252, v252, v236
    v_sub_f32 v253, v253, v236
    v_sub_f32 v254, v254, v236
    v_sub_f32 v255, v255, v236
    v_exp_f32 v240, v240
    v_exp_f32 v241, v241
    v_exp_f32 v242, v242
    v_exp_f32 v243, v243
    v_exp_f32 v244, v244
    v_exp_f32 v245, v245
    v_exp_f32 v246, v246
    v_exp_f32 v247, v247
    v_exp_f32 v248, v248
    v_exp_f32 v249, v249
    v_exp_f32 v250, v250
    v_exp_f32 v251, v251
    v_exp_f32 v252, v252
    v_exp_f32 v253, v253
    v_exp_f32 v254, v254
    v_exp_f32 v255, v255
    s_nop 0
    v_cvt_pk_bf16_f32 v240, v240, v241
    v_cvt_pk_bf16_f32 v241, v242, v243
    v_cvt_pk_bf16_f32 v242, v244, v245
    v_cvt_pk_bf16_f32 v243, v246, v247
    v_cvt_pk_bf16_f32 v244, v248, v249
    v_cvt_pk_bf16_f32 v245, v250, v251
    v_cvt_pk_bf16_f32 v246, v252, v253
    v_cvt_pk_bf16_f32 v247, v254, v255
    s_nop 1
    v_mfma_f32_32x32x16_bf16 v[208:223], v[228:231], v[240:243], v[208:223]
    v_mfma_f32_32x32x16_bf16 v[208:223], v[232:235], v[244:247], v[208:223]
    s_nop 7
    s_nop 7
    s_nop 7
parallel_sum__sliding_block__glu_gated_bilinear__prompt_kernel_fb111:
    s_cmp_le_u32 s68, 0
    s_cbranch_scc1 parallel_sum__sliding_block__glu_gated_bilinear__prompt_kernel_fb112
    s_add_u32 s70, s61, 229376
    buffer_load_dwordx4 v[224:227], v26, s[20:23], s70 offen sc1
    buffer_load_dwordx4 v[228:231], v27, s[20:23], s70 offen sc1
    v_mov_b32 v232, 0x3f803f80
    v_mov_b32 v233, 0x3f803f80
    v_mov_b32 v234, 0x3f803f80
    v_mov_b32 v235, 0x3f803f80
    s_waitcnt vmcnt(0)
    v_mfma_f32_32x32x16_bf16 v[240:255], v[224:227], v[100:103], 0
    s_nop 7
    s_nop 7
    v_permlane16_swap_b32 v228, v232
    v_permlane16_swap_b32 v229, v233
    v_permlane16_swap_b32 v230, v234
    v_permlane16_swap_b32 v231, v235
    v_sub_f32 v240, v240, v236
    v_sub_f32 v241, v241, v236
    v_sub_f32 v242, v242, v236
    v_sub_f32 v243, v243, v236
    v_sub_f32 v244, v244, v236
    v_sub_f32 v245, v245, v236
    v_sub_f32 v246, v246, v236
    v_sub_f32 v247, v247, v236
    v_sub_f32 v248, v248, v236
    v_sub_f32 v249, v249, v236
    v_sub_f32 v250, v250, v236
    v_sub_f32 v251, v251, v236
    v_sub_f32 v252, v252, v236
    v_sub_f32 v253, v253, v236
    v_sub_f32 v254, v254, v236
    v_sub_f32 v255, v255, v236
    v_exp_f32 v240, v240
    v_exp_f32 v241, v241
    v_exp_f32 v242, v242
    v_exp_f32 v243, v243
    v_exp_f32 v244, v244
    v_exp_f32 v245, v245
    v_exp_f32 v246, v246
    v_exp_f32 v247, v247
    v_exp_f32 v248, v248
    v_exp_f32 v249, v249
    v_exp_f32 v250, v250
    v_exp_f32 v251, v251
    v_exp_f32 v252, v252
    v_exp_f32 v253, v253
    v_exp_f32 v254, v254
    v_exp_f32 v255, v255
    s_nop 0
    v_cvt_pk_bf16_f32 v240, v240, v241
    v_cvt_pk_bf16_f32 v241, v242, v243
    v_cvt_pk_bf16_f32 v242, v244, v245
    v_cvt_pk_bf16_f32 v243, v246, v247
    v_cvt_pk_bf16_f32 v244, v248, v249
    v_cvt_pk_bf16_f32 v245, v250, v251
    v_cvt_pk_bf16_f32 v246, v252, v253
    v_cvt_pk_bf16_f32 v247, v254, v255
    s_nop 1
    v_mfma_f32_32x32x16_bf16 v[208:223], v[228:231], v[240:243], v[208:223]
    v_mfma_f32_32x32x16_bf16 v[208:223], v[232:235], v[244:247], v[208:223]
    s_nop 7
    s_nop 7
    s_nop 7
parallel_sum__sliding_block__glu_gated_bilinear__prompt_kernel_fb112:
    s_cmp_le_u32 s68, 0
    s_cbranch_scc1 parallel_sum__sliding_block__glu_gated_bilinear__prompt_kernel_fb113
    s_add_u32 s70, s61, 196608
    buffer_load_dwordx4 v[224:227], v26, s[20:23], s70 offen sc1
    buffer_load_dwordx4 v[228:231], v27, s[20:23], s70 offen sc1
    v_mov_b32 v232, 0x3f803f80
    v_mov_b32 v233, 0x3f803f80
    v_mov_b32 v234, 0x3f803f80
    v_mov_b32 v235, 0x3f803f80
    s_waitcnt vmcnt(0)
    v_mfma_f32_32x32x16_bf16 v[240:255], v[224:227], v[100:103], 0
    s_nop 7
    s_nop 7
    v_permlane16_swap_b32 v228, v232
    v_permlane16_swap_b32 v229, v233
    v_permlane16_swap_b32 v230, v234
    v_permlane16_swap_b32 v231, v235
    v_sub_f32 v240, v240, v236
    v_sub_f32 v241, v241, v236
    v_sub_f32 v242, v242, v236
    v_sub_f32 v243, v243, v236
    v_sub_f32 v244, v244, v236
    v_sub_f32 v245, v245, v236
    v_sub_f32 v246, v246, v236
    v_sub_f32 v247, v247, v236
    v_sub_f32 v248, v248, v236
    v_sub_f32 v249, v249, v236
    v_sub_f32 v250, v250, v236
    v_sub_f32 v251, v251, v236
    v_sub_f32 v252, v252, v236
    v_sub_f32 v253, v253, v236
    v_sub_f32 v254, v254, v236
    v_sub_f32 v255, v255, v236
    v_exp_f32 v240, v240
    v_exp_f32 v241, v241
    v_exp_f32 v242, v242
    v_exp_f32 v243, v243
    v_exp_f32 v244, v244
    v_exp_f32 v245, v245
    v_exp_f32 v246, v246
    v_exp_f32 v247, v247
    v_exp_f32 v248, v248
    v_exp_f32 v249, v249
    v_exp_f32 v250, v250
    v_exp_f32 v251, v251
    v_exp_f32 v252, v252
    v_exp_f32 v253, v253
    v_exp_f32 v254, v254
    v_exp_f32 v255, v255
    s_nop 0
    v_cvt_pk_bf16_f32 v240, v240, v241
    v_cvt_pk_bf16_f32 v241, v242, v243
    v_cvt_pk_bf16_f32 v242, v244, v245
    v_cvt_pk_bf16_f32 v243, v246, v247
    v_cvt_pk_bf16_f32 v244, v248, v249
    v_cvt_pk_bf16_f32 v245, v250, v251
    v_cvt_pk_bf16_f32 v246, v252, v253
    v_cvt_pk_bf16_f32 v247, v254, v255
    s_nop 1
    v_mfma_f32_32x32x16_bf16 v[208:223], v[228:231], v[240:243], v[208:223]
    v_mfma_f32_32x32x16_bf16 v[208:223], v[232:235], v[244:247], v[208:223]
    s_nop 7
    s_nop 7
    s_nop 7
parallel_sum__sliding_block__glu_gated_bilinear__prompt_kernel_fb113:
    s_cmp_le_u32 s68, 1
    s_cbranch_scc1 parallel_sum__sliding_block__glu_gated_bilinear__prompt_kernel_fb114
    s_add_u32 s70, s61, 163840
    buffer_load_dwordx4 v[224:227], v26, s[20:23], s70 offen sc1
    buffer_load_dwordx4 v[228:231], v27, s[20:23], s70 offen sc1
    v_mov_b32 v232, 0x3f803f80
    v_mov_b32 v233, 0x3f803f80
    v_mov_b32 v234, 0x3f803f80
    v_mov_b32 v235, 0x3f803f80
    s_waitcnt vmcnt(0)
    v_mfma_f32_32x32x16_bf16 v[240:255], v[224:227], v[100:103], 0
    s_nop 7
    s_nop 7
    v_permlane16_swap_b32 v228, v232
    v_permlane16_swap_b32 v229, v233
    v_permlane16_swap_b32 v230, v234
    v_permlane16_swap_b32 v231, v235
    v_sub_f32 v240, v240, v236
    v_sub_f32 v241, v241, v236
    v_sub_f32 v242, v242, v236
    v_sub_f32 v243, v243, v236
    v_sub_f32 v244, v244, v236
    v_sub_f32 v245, v245, v236
    v_sub_f32 v246, v246, v236
    v_sub_f32 v247, v247, v236
    v_sub_f32 v248, v248, v236
    v_sub_f32 v249, v249, v236
    v_sub_f32 v250, v250, v236
    v_sub_f32 v251, v251, v236
    v_sub_f32 v252, v252, v236
    v_sub_f32 v253, v253, v236
    v_sub_f32 v254, v254, v236
    v_sub_f32 v255, v255, v236
    v_exp_f32 v240, v240
    v_exp_f32 v241, v241
    v_exp_f32 v242, v242
    v_exp_f32 v243, v243
    v_exp_f32 v244, v244
    v_exp_f32 v245, v245
    v_exp_f32 v246, v246
    v_exp_f32 v247, v247
    v_exp_f32 v248, v248
    v_exp_f32 v249, v249
    v_exp_f32 v250, v250
    v_exp_f32 v251, v251
    v_exp_f32 v252, v252
    v_exp_f32 v253, v253
    v_exp_f32 v254, v254
    v_exp_f32 v255, v255
    s_nop 0
    v_cvt_pk_bf16_f32 v240, v240, v241
    v_cvt_pk_bf16_f32 v241, v242, v243
    v_cvt_pk_bf16_f32 v242, v244, v245
    v_cvt_pk_bf16_f32 v243, v246, v247
    v_cvt_pk_bf16_f32 v244, v248, v249
    v_cvt_pk_bf16_f32 v245, v250, v251
    v_cvt_pk_bf16_f32 v246, v252, v253
    v_cvt_pk_bf16_f32 v247, v254, v255
    s_nop 1
    v_mfma_f32_32x32x16_bf16 v[208:223], v[228:231], v[240:243], v[208:223]
    v_mfma_f32_32x32x16_bf16 v[208:223], v[232:235], v[244:247], v[208:223]
    s_nop 7
    s_nop 7
    s_nop 7
parallel_sum__sliding_block__glu_gated_bilinear__prompt_kernel_fb114:
    s_cmp_le_u32 s68, 1
    s_cbranch_scc1 parallel_sum__sliding_block__glu_gated_bilinear__prompt_kernel_fb115
    s_add_u32 s70, s61, 131072
    buffer_load_dwordx4 v[224:227], v26, s[20:23], s70 offen sc1
    buffer_load_dwordx4 v[228:231], v27, s[20:23], s70 offen sc1
    v_mov_b32 v232, 0x3f803f80
    v_mov_b32 v233, 0x3f803f80
    v_mov_b32 v234, 0x3f803f80
    v_mov_b32 v235, 0x3f803f80
    s_waitcnt vmcnt(0)
    v_mfma_f32_32x32x16_bf16 v[240:255], v[224:227], v[100:103], 0
    s_nop 7
    s_nop 7
    v_permlane16_swap_b32 v228, v232
    v_permlane16_swap_b32 v229, v233
    v_permlane16_swap_b32 v230, v234
    v_permlane16_swap_b32 v231, v235
    v_sub_f32 v240, v240, v236
    v_sub_f32 v241, v241, v236
    v_sub_f32 v242, v242, v236
    v_sub_f32 v243, v243, v236
    v_sub_f32 v244, v244, v236
    v_sub_f32 v245, v245, v236
    v_sub_f32 v246, v246, v236
    v_sub_f32 v247, v247, v236
    v_sub_f32 v248, v248, v236
    v_sub_f32 v249, v249, v236
    v_sub_f32 v250, v250, v236
    v_sub_f32 v251, v251, v236
    v_sub_f32 v252, v252, v236
    v_sub_f32 v253, v253, v236
    v_sub_f32 v254, v254, v236
    v_sub_f32 v255, v255, v236
    v_exp_f32 v240, v240
    v_exp_f32 v241, v241
    v_exp_f32 v242, v242
    v_exp_f32 v243, v243
    v_exp_f32 v244, v244
    v_exp_f32 v245, v245
    v_exp_f32 v246, v246
    v_exp_f32 v247, v247
    v_exp_f32 v248, v248
    v_exp_f32 v249, v249
    v_exp_f32 v250, v250
    v_exp_f32 v251, v251
    v_exp_f32 v252, v252
    v_exp_f32 v253, v253
    v_exp_f32 v254, v254
    v_exp_f32 v255, v255
    s_nop 0
    v_cvt_pk_bf16_f32 v240, v240, v241
    v_cvt_pk_bf16_f32 v241, v242, v243
    v_cvt_pk_bf16_f32 v242, v244, v245
    v_cvt_pk_bf16_f32 v243, v246, v247
    v_cvt_pk_bf16_f32 v244, v248, v249
    v_cvt_pk_bf16_f32 v245, v250, v251
    v_cvt_pk_bf16_f32 v246, v252, v253
    v_cvt_pk_bf16_f32 v247, v254, v255
    s_nop 1
    v_mfma_f32_32x32x16_bf16 v[208:223], v[228:231], v[240:243], v[208:223]
    v_mfma_f32_32x32x16_bf16 v[208:223], v[232:235], v[244:247], v[208:223]
    s_nop 7
    s_nop 7
    s_nop 7
parallel_sum__sliding_block__glu_gated_bilinear__prompt_kernel_fb115:
    s_cmp_le_u32 s68, 2
    s_cbranch_scc1 parallel_sum__sliding_block__glu_gated_bilinear__prompt_kernel_fb116
    s_add_u32 s70, s61, 98304
    buffer_load_dwordx4 v[224:227], v26, s[20:23], s70 offen sc1
    buffer_load_dwordx4 v[228:231], v27, s[20:23], s70 offen sc1
    v_mov_b32 v232, 0x3f803f80
    v_mov_b32 v233, 0x3f803f80
    v_mov_b32 v234, 0x3f803f80
    v_mov_b32 v235, 0x3f803f80
    s_waitcnt vmcnt(0)
    v_mfma_f32_32x32x16_bf16 v[240:255], v[224:227], v[100:103], 0
    s_nop 7
    s_nop 7
    v_permlane16_swap_b32 v228, v232
    v_permlane16_swap_b32 v229, v233
    v_permlane16_swap_b32 v230, v234
    v_permlane16_swap_b32 v231, v235
    v_sub_f32 v240, v240, v236
    v_sub_f32 v241, v241, v236
    v_sub_f32 v242, v242, v236
    v_sub_f32 v243, v243, v236
    v_sub_f32 v244, v244, v236
    v_sub_f32 v245, v245, v236
    v_sub_f32 v246, v246, v236
    v_sub_f32 v247, v247, v236
    v_sub_f32 v248, v248, v236
    v_sub_f32 v249, v249, v236
    v_sub_f32 v250, v250, v236
    v_sub_f32 v251, v251, v236
    v_sub_f32 v252, v252, v236
    v_sub_f32 v253, v253, v236
    v_sub_f32 v254, v254, v236
    v_sub_f32 v255, v255, v236
    v_exp_f32 v240, v240
    v_exp_f32 v241, v241
    v_exp_f32 v242, v242
    v_exp_f32 v243, v243
    v_exp_f32 v244, v244
    v_exp_f32 v245, v245
    v_exp_f32 v246, v246
    v_exp_f32 v247, v247
    v_exp_f32 v248, v248
    v_exp_f32 v249, v249
    v_exp_f32 v250, v250
    v_exp_f32 v251, v251
    v_exp_f32 v252, v252
    v_exp_f32 v253, v253
    v_exp_f32 v254, v254
    v_exp_f32 v255, v255
    s_nop 0
    v_cvt_pk_bf16_f32 v240, v240, v241
    v_cvt_pk_bf16_f32 v241, v242, v243
    v_cvt_pk_bf16_f32 v242, v244, v245
    v_cvt_pk_bf16_f32 v243, v246, v247
    v_cvt_pk_bf16_f32 v244, v248, v249
    v_cvt_pk_bf16_f32 v245, v250, v251
    v_cvt_pk_bf16_f32 v246, v252, v253
    v_cvt_pk_bf16_f32 v247, v254, v255
    s_nop 1
    v_mfma_f32_32x32x16_bf16 v[208:223], v[228:231], v[240:243], v[208:223]
    v_mfma_f32_32x32x16_bf16 v[208:223], v[232:235], v[244:247], v[208:223]
    s_nop 7
    s_nop 7
    s_nop 7
parallel_sum__sliding_block__glu_gated_bilinear__prompt_kernel_fb116:
    s_cmp_le_u32 s68, 2
    s_cbranch_scc1 parallel_sum__sliding_block__glu_gated_bilinear__prompt_kernel_fb117
    s_add_u32 s70, s61, 65536
    buffer_load_dwordx4 v[224:227], v26, s[20:23], s70 offen sc1
    buffer_load_dwordx4 v[228:231], v27, s[20:23], s70 offen sc1
    v_mov_b32 v232, 0x3f803f80
    v_mov_b32 v233, 0x3f803f80
    v_mov_b32 v234, 0x3f803f80
    v_mov_b32 v235, 0x3f803f80
    s_waitcnt vmcnt(0)
    v_mfma_f32_32x32x16_bf16 v[240:255], v[224:227], v[100:103], 0
    s_nop 7
    s_nop 7
    v_permlane16_swap_b32 v228, v232
    v_permlane16_swap_b32 v229, v233
    v_permlane16_swap_b32 v230, v234
    v_permlane16_swap_b32 v231, v235
    v_sub_f32 v240, v240, v236
    v_sub_f32 v241, v241, v236
    v_sub_f32 v242, v242, v236
    v_sub_f32 v243, v243, v236
    v_sub_f32 v244, v244, v236
    v_sub_f32 v245, v245, v236
    v_sub_f32 v246, v246, v236
    v_sub_f32 v247, v247, v236
    v_sub_f32 v248, v248, v236
    v_sub_f32 v249, v249, v236
    v_sub_f32 v250, v250, v236
    v_sub_f32 v251, v251, v236
    v_sub_f32 v252, v252, v236
    v_sub_f32 v253, v253, v236
    v_sub_f32 v254, v254, v236
    v_sub_f32 v255, v255, v236
    v_exp_f32 v240, v240
    v_exp_f32 v241, v241
    v_exp_f32 v242, v242
    v_exp_f32 v243, v243
    v_exp_f32 v244, v244
    v_exp_f32 v245, v245
    v_exp_f32 v246, v246
    v_exp_f32 v247, v247
    v_exp_f32 v248, v248
    v_exp_f32 v249, v249
    v_exp_f32 v250, v250
    v_exp_f32 v251, v251
    v_exp_f32 v252, v252
    v_exp_f32 v253, v253
    v_exp_f32 v254, v254
    v_exp_f32 v255, v255
    s_nop 0
    v_cvt_pk_bf16_f32 v240, v240, v241
    v_cvt_pk_bf16_f32 v241, v242, v243
    v_cvt_pk_bf16_f32 v242, v244, v245
    v_cvt_pk_bf16_f32 v243, v246, v247
    v_cvt_pk_bf16_f32 v244, v248, v249
    v_cvt_pk_bf16_f32 v245, v250, v251
    v_cvt_pk_bf16_f32 v246, v252, v253
    v_cvt_pk_bf16_f32 v247, v254, v255
    s_nop 1
    v_mfma_f32_32x32x16_bf16 v[208:223], v[228:231], v[240:243], v[208:223]
    v_mfma_f32_32x32x16_bf16 v[208:223], v[232:235], v[244:247], v[208:223]
    s_nop 7
    s_nop 7
    s_nop 7
parallel_sum__sliding_block__glu_gated_bilinear__prompt_kernel_fb117:
    s_cmp_le_u32 s68, 3
    s_cbranch_scc1 parallel_sum__sliding_block__glu_gated_bilinear__prompt_kernel_fb118
    s_add_u32 s70, s61, 32768
    buffer_load_dwordx4 v[224:227], v26, s[20:23], s70 offen sc1
    buffer_load_dwordx4 v[228:231], v27, s[20:23], s70 offen sc1
    v_mov_b32 v232, 0x3f803f80
    v_mov_b32 v233, 0x3f803f80
    v_mov_b32 v234, 0x3f803f80
    v_mov_b32 v235, 0x3f803f80
    v_cmp_le_i32 vcc, 0, v237
    s_nop 1
    v_cndmask_b32 v240, 0, v238, vcc
    v_cmp_le_i32 vcc, 1, v237
    s_nop 1
    v_cndmask_b32 v241, 0, v238, vcc
    v_cmp_le_i32 vcc, 2, v237
    s_nop 1
    v_cndmask_b32 v242, 0, v238, vcc
    v_cmp_le_i32 vcc, 3, v237
    s_nop 1
    v_cndmask_b32 v243, 0, v238, vcc
    v_cmp_le_i32 vcc, 8, v237
    s_nop 1
    v_cndmask_b32 v244, 0, v238, vcc
    v_cmp_le_i32 vcc, 9, v237
    s_nop 1
    v_cndmask_b32 v245, 0, v238, vcc
    v_cmp_le_i32 vcc, 10, v237
    s_nop 1
    v_cndmask_b32 v246, 0, v238, vcc
    v_cmp_le_i32 vcc, 11, v237
    s_nop 1
    v_cndmask_b32 v247, 0, v238, vcc
    v_cmp_le_i32 vcc, 16, v237
    s_nop 1
    v_cndmask_b32 v248, 0, v238, vcc
    v_cmp_le_i32 vcc, 17, v237
    s_nop 1
    v_cndmask_b32 v249, 0, v238, vcc
    v_cmp_le_i32 vcc, 18, v237
    s_nop 1
    v_cndmask_b32 v250, 0, v238, vcc
    v_cmp_le_i32 vcc, 19, v237
    s_nop 1
    v_cndmask_b32 v251, 0, v238, vcc
    v_cmp_le_i32 vcc, 24, v237
    s_nop 1
    v_cndmask_b32 v252, 0, v238, vcc
    v_cmp_le_i32 vcc, 25, v237
    s_nop 1
    v_cndmask_b32 v253, 0, v238, vcc
    v_cmp_le_i32 vcc, 26, v237
    s_nop 1
    v_cndmask_b32 v254, 0, v238, vcc
    v_cmp_le_i32 vcc, 27, v237
    s_nop 1
    v_cndmask_b32 v255, 0, v238, vcc
    s_waitcnt vmcnt(0)
    s_nop 0
    v_mfma_f32_32x32x16_bf16 v[240:255], v[224:227], v[100:103], v[240:255]
    s_nop 7
    s_nop 7
    v_permlane16_swap_b32 v228, v232
    v_permlane16_swap_b32 v229, v233
    v_permlane16_swap_b32 v230, v234
    v_permlane16_swap_b32 v231, v235
    v_sub_f32 v240, v240, v236
    v_sub_f32 v241, v241, v236
    v_sub_f32 v242, v242, v236
    v_sub_f32 v243, v243, v236
    v_sub_f32 v244, v244, v236
    v_sub_f32 v245, v245, v236
    v_sub_f32 v246, v246, v236
    v_sub_f32 v247, v247, v236
    v_sub_f32 v248, v248, v236
    v_sub_f32 v249, v249, v236
    v_sub_f32 v250, v250, v236
    v_sub_f32 v251, v251, v236
    v_sub_f32 v252, v252, v236
    v_sub_f32 v253, v253, v236
    v_sub_f32 v254, v254, v236
    v_sub_f32 v255, v255, v236
    v_exp_f32 v240, v240
    v_exp_f32 v241, v241
    v_exp_f32 v242, v242
    v_exp_f32 v243, v243
    v_exp_f32 v244, v244
    v_exp_f32 v245, v245
    v_exp_f32 v246, v246
    v_exp_f32 v247, v247
    v_exp_f32 v248, v248
    v_exp_f32 v249, v249
    v_exp_f32 v250, v250
    v_exp_f32 v251, v251
    v_exp_f32 v252, v252
    v_exp_f32 v253, v253
    v_exp_f32 v254, v254
    v_exp_f32 v255, v255
    s_nop 0
    v_cvt_pk_bf16_f32 v240, v240, v241
    v_cvt_pk_bf16_f32 v241, v242, v243
    v_cvt_pk_bf16_f32 v242, v244, v245
    v_cvt_pk_bf16_f32 v243, v246, v247
    v_cvt_pk_bf16_f32 v244, v248, v249
    v_cvt_pk_bf16_f32 v245, v250, v251
    v_cvt_pk_bf16_f32 v246, v252, v253
    v_cvt_pk_bf16_f32 v247, v254, v255
    s_nop 1
    v_mfma_f32_32x32x16_bf16 v[208:223], v[228:231], v[240:243], v[208:223]
    v_mfma_f32_32x32x16_bf16 v[208:223], v[232:235], v[244:247], v[208:223]
    s_nop 7
    s_nop 7
    s_nop 7
parallel_sum__sliding_block__glu_gated_bilinear__prompt_kernel_fb118:
    s_branch parallel_sum__sliding_block__glu_gated_bilinear__prompt_kernel_oc
.section .rodata,"a"
.p2align 6
.amdhsa_kernel parallel_sum__sliding_block__glu_gated_bilinear__prompt_kernel
  .amdhsa_next_free_vgpr 512
  .amdhsa_next_free_sgpr 102
  .amdhsa_accum_offset 256
  .amdhsa_group_segment_fixed_size 0
  .amdhsa_kernarg_size 80
  .amdhsa_user_sgpr_count 2
  .amdhsa_user_sgpr_kernarg_segment_ptr 1
  .amdhsa_system_sgpr_workgroup_id_x 1
.end_amdhsa_kernel
```
